```python
import torch

def _softmax(x, axis=-1):
    return torch.softmax(x, dim=axis)

def _gelu(x):
    return torch.nn.functional.gelu(x, approximate='tanh')

def _silu(x):
    return torch.nn.functional.silu(x)

def _sigmoid(x):
    return torch.sigmoid(x)

def _layernorm(x, axis=-1, eps=1e-05):
    m = x.mean(dim=axis, keepdim=True)
    v = x.var(dim=axis, keepdim=True, unbiased=False)
    return (x - m) / torch.sqrt(v + eps)

def _scatter_add(tgt, idx, src, axis=0):
    return tgt.clone().index_add_(axis, idx, src)

def _segment_sum(src, seg, n):
    out = torch.zeros((n,) + src.shape[1:], dtype=src.dtype)
    return out.index_add_(0, seg, src)

def _pad(x, pw):
    flat = tuple((v for pair in reversed(pw) for v in pair))
    return torch.nn.functional.pad(x, flat)
kernel_name = 'recurrent_scan__spectral_gfnet__mixer_gmlp__prompt'

def setup_inputs():

    _w = lambda a: (lambda t: t.to(torch.bfloat16) if t.is_floating_point() else t)(torch.as_tensor(a))

    def _A_setup():
        B, S, D = (1, 2048, 448)
        Df = D // 2 + 1
        return {'x': _w((lambda *s: torch.randn(*s, dtype=torch.bfloat16) * 0.05)(B, S, D)), 'w_r': _w((lambda *s: torch.randn(*s, dtype=torch.bfloat16) * 0.2)(S, Df) * 0.02), 'w_i': _w((lambda *s: torch.randn(*s, dtype=torch.bfloat16) * 0.2)(S, Df) * 0.02)}
    _A_in = _A_setup()

    def _B_setup():
        B, S, D, F = (1, 2048, 448, 1792)
        Fh = F // 2
        return {'x': _w((lambda *s: torch.randn(*s, dtype=torch.bfloat16) * 0.05)(B, S, D)), 'w_in': _w((lambda *s: torch.randn(*s, dtype=torch.bfloat16) * 0.4)(D, 2 * Fh)), 'w_sp': _w(0.01 * (lambda *s: torch.randn(*s, dtype=torch.bfloat16) * 0.4)(S, S)), 'b_sp': _w(1.0 + 0.01 * (lambda *s: torch.randn(*s, dtype=torch.bfloat16) * 0.1)(S)), 'w_out': _w((lambda *s: torch.randn(*s, dtype=torch.bfloat16) * 0.1)(Fh, D))}
    _B_in = _B_setup()
    return {'A_x': _A_in['x'], 'A_w_r': _A_in['w_r'], 'A_w_i': _A_in['w_i'], 'B_x': _B_in['x'], 'B_w_in': _B_in['w_in'], 'B_w_sp': _B_in['w_sp'], 'B_b_sp': _B_in['b_sp'], 'B_w_out': _B_in['w_out']}

def reference(A_x, A_w_r, A_w_i, B_x, B_w_in, B_w_sp, B_b_sp, B_w_out):

    def _A_ref(x, w_r, w_i):
        B, S, D = x.shape
        X = (lambda x, axes=(-2, -1): torch.fft.rfft2(x.float(), dim=axes))(x, axes=(-2, -1))
        W = w_r + 1j * w_i
        X = X * W
        y = (lambda x, s, axes=(-2, -1): torch.fft.irfft2(x, s=s, dim=axes).to(torch.bfloat16))(X, (S, D), axes=(-2, -1))
        return y

    def _B_ref(x, w_in, w_sp, b_sp, w_out):
        B, S, D = x.shape
        F = w_in.shape[-1]
        Fh = F // 2
        z = _gelu(torch.einsum('bsd,df->bsf', x, w_in))
        z1 = z[..., :Fh].clone()
        z2 = _layernorm(z[..., Fh:], axis=-1)
        g = torch.einsum('ts,bsf->btf', w_sp, z2) + b_sp[None, :, None]
        return torch.einsum('bsf,fd->bsd', z1 * g, w_out)
    x = A_x
    xn = _layernorm(x, axis=-1)
    s = _A_ref(xn, A_w_r, A_w_i)
    g = _silu(_B_ref(xn, B_w_in, B_w_sp, B_b_sp, B_w_out))
    return x + s * g
```

```asm
; @launch grid=(256,1,1) block=(512,1,1) lds=163840
.amdgcn_target "amdgcn-amd-amdhsa--gfx950"
.text
.globl recurrent_scan__spectral_gfnet__mixer_gmlp__prompt_kernel
.p2align 8
.type recurrent_scan__spectral_gfnet__mixer_gmlp__prompt_kernel,@function
recurrent_scan__spectral_gfnet__mixer_gmlp__prompt_kernel:
  s_cmp_ge_u32 s2, 256
  s_cbranch_scc1 L_END
  s_load_dwordx2 s[76:77], s[0:1], 0
  s_load_dwordx4 s[28:31], s[0:1], 8
  s_load_dwordx4 s[32:35], s[0:1], 32
  s_load_dwordx4 s[36:39], s[0:1], 72
  s_load_dwordx4 s[80:83], s[0:1], 48
  s_load_dwordx2 s[78:79], s[0:1], 64
  s_and_b32 s40, s2, 7
  s_lshr_b32 s41, s2, 3
  v_lshrrev_b32 v2, 6, v0
  v_and_b32 v1, 63, v0
  v_readfirstlane_b32 s42, v2
  s_getpc_b64 s[16:17]
  s_add_u32 s16, s16, TAB_FT@rel32@lo+4
  s_addc_u32 s17, s17, TAB_FT@rel32@hi+12
  s_and_b32 s17, s17, 0xffff
  s_mov_b32 s18, 802816
  s_mov_b32 s19, 0x20000
  s_and_b32 s62, s40, 1
  s_mul_i32 s43, s62, 28
  s_add_u32 s43, s43, s41
  s_lshr_b32 s44, s43, 3
  s_and_b32 s43, s43, 7
  s_lshr_b32 s45, s40, 1
  s_lshl_b32 s45, s45, 3
  s_add_u32 s43, s43, s45
  s_lshr_b32 s45, s43, 4
  s_lshl_b32 s45, s45, 4
  s_lshr_b32 s46, s42, 2
  s_lshl_b32 s46, s46, 3
  s_add_u32 s45, s45, s46
  s_bfe_u32 s46, s43, 0x10003
  s_lshl_b32 s46, s46, 2
  s_add_u32 s45, s45, s46
  s_and_b32 s46, s42, 3
  s_add_u32 s45, s45, s46
  s_lshl_b32 s45, s45, 6
  s_and_b32 s46, s43, 7
  s_lshl_b32 s46, s46, 3
  s_add_u32 s45, s45, s46
  s_lshl_b32 s87, s45, 12
  s_mul_i32 s45, s45, 896
  v_lshrrev_b32 v200, 3, v1
  v_and_b32 v201, 7, v1
  v_mul_u32_u24 v2, 896, v200
  v_lshl_add_u32 v2, v201, 4, v2
  v_mov_b32 v248, 0
  v_lshlrev_b32 v4, 4, v1
  s_waitcnt lgkmcnt(0)
  s_mov_b32 s4, s76
  s_and_b32 s5, s77, 0xffff
  s_mov_b32 s6, 1835008
  s_mov_b32 s7, 0x20000
  s_cmp_ge_u32 s41, 28
  s_cbranch_scc1 L_AUX0
  buffer_load_dwordx4 v[128:131], v2, s[4:7], s45 offen offset:0
  buffer_load_dwordx4 v[132:135], v2, s[4:7], s45 offen offset:128
  buffer_load_dwordx4 v[136:139], v2, s[4:7], s45 offen offset:256
  buffer_load_dwordx4 v[140:143], v2, s[4:7], s45 offen offset:384
  buffer_load_dwordx4 v[144:147], v2, s[4:7], s45 offen offset:512
  buffer_load_dwordx4 v[148:151], v2, s[4:7], s45 offen offset:640
  buffer_load_dwordx4 v[152:155], v2, s[4:7], s45 offen offset:768
L_AUX0:
  s_mov_b32 s8, s32
  s_and_b32 s9, s33, 0xffff
  s_mov_b32 s10, 1605632
  s_mov_b32 s11, 0x20000
  s_mov_b32 s12, s38
  s_and_b32 s13, s39, 0xffff
  s_mov_b32 s14, 268435456
  s_mov_b32 s15, 0x20000
  s_mov_b32 s20, s36
  s_and_b32 s21, s37, 0xffff
  s_mov_b32 s22, 256
  s_mov_b32 s23, 0x20000
  s_mov_b32 s24, s34
  s_and_b32 s25, s35, 0xffff
  s_mov_b32 s26, 8388608
  s_mov_b32 s27, 0x20000
  s_mov_b32 s64, s78
  s_and_b32 s65, s79, 0xffff
  s_mov_b32 s66, 1835008
  s_mov_b32 s67, 0x20000
  s_mov_b32 s68, s80
  s_and_b32 s69, s81, 0xffff
  s_mov_b32 s70, 4096
  s_mov_b32 s71, 0x20000
  s_cmp_ge_u32 s41, 28
  s_cbranch_scc1 L_AUX
  s_add_u32 s49, s2, s42
  s_cmp_lg_u32 s49, 0
  s_cbranch_scc1 L_NN
  s_memrealtime s[50:51]
  s_waitcnt lgkmcnt(0)
  s_or_b32 s50, s50, 1
  v_mov_b32 v249, s50
  s_mov_b64 exec, 1
  buffer_store_dword v249, v248, s[20:23], 0 offen sc1
  s_mov_b64 exec, -1
L_NN:
  s_mul_i32 s46, s62, 28
  s_lshr_b32 s46, s46, 3
  s_mul_i32 s47, s62, 28
  s_add_u32 s47, s47, 27
  s_lshr_b32 s47, s47, 3
  s_lshl_b32 s48, s41, 4
  s_lshl_b32 s49, s42, 1
  s_add_u32 s48, s48, s49
  s_mul_i32 s48, s48, 3584
  s_lshl_b32 s49, s46, 8
  s_add_u32 s48, s48, s49
  s_add_u32 s48, s48, 1792
  v_and_b32 v208, 127, v0
  v_lshrrev_b32 v209, 5, v208
  v_add_u32 v209, s46, v209
  v_cmp_lt_u32 vcc, s47, v209
  v_mov_b32 v213, 0x8000
  s_nop 0
  v_cndmask_b32 v209, v209, v213, vcc
  s_lshl_b32 s48, s41, 5
  v_and_b32 v210, 31, v0
  v_add_u32 v210, s48, v210
  v_lshrrev_b32 v252, 1, v210
  v_mul_u32_u24 v252, 3584, v252
  v_lshl_add_u32 v252, v209, 8, v252
  v_and_b32 v211, 1, v210
  v_lshl_add_u32 v252, v211, 7, v252
  s_mov_b32 s48, 114688
  v_mul_lo_u32 v253, v209, s48
  v_lshl_add_u32 v253, v210, 7, v253
  s_barrier
  s_cmp_ge_u32 s42, 2
  s_cselect_b32 s49, 0x10000000, 0
  buffer_load_dword v255, v252, s[8:11], s49 offen offset:1792
  v_lshrrev_b32 v202, 4, v1
  v_and_b32 v203, 15, v1
  v_lshlrev_b32 v204, 2, v202
  v_xor_b32 v203, v203, v204
  v_mul_u32_u24 v3, 3584, v202
  v_lshl_add_u32 v3, v203, 4, v3
  s_mul_i32 s46, s42, 14336
  s_lshl_b32 s47, s44, 8
  s_add_u32 s46, s46, s47
  s_mul_i32 s47, s44, 114688
  s_lshl_b32 s48, s42, 10
  s_add_u32 s47, s47, s48
  s_lshl_b32 s49, s42, 3
  v_add_u32 v202, s49, v200
  v_bfe_u32 v203, v202, 1, 3
  v_xor_b32 v203, v203, v201
  v_mul_u32_u24 v5, 896, v202
  v_lshl_add_u32 v5, v203, 4, v5
  v_add_u32 v5, 98304, v5
  v_lshrrev_b32 v202, 1, v200
  s_and_b32 s88, s42, 1
  s_lshl_b32 s88, s88, 2
  v_add_u32 v202, s88, v202
  v_xor_b32 v202, v201, v202
  v_lshlrev_b32 v244, 12, v200
  v_lshl_add_u32 v244, v202, 4, v244
  v_lshrrev_b32 v202, 5, v1
  v_lshlrev_b32 v245, 14, v202
  v_and_b32 v202, 31, v1
  v_lshl_add_u32 v245, v202, 4, v245
  s_lshl_b32 s88, s44, 19
  s_add_u32 s88, s88, s48
  s_add_u32 s88, s88, 4194304
  s_lshr_b32 s86, s43, 4
  s_lshl_b32 s86, s86, 4
  s_bfe_u32 s49, s43, 0x10003
  s_lshl_b32 s49, s49, 2
  s_add_u32 s86, s86, s49
  s_and_b32 s49, s42, 1
  s_lshl_b32 s49, s49, 3
  s_add_u32 s86, s86, s49
  s_and_b32 s49, s42, 1
  s_lshl_b32 s49, s49, 5
  v_and_b32 v202, 31, v1
  v_add_u32 v202, s49, v202
  v_bfe_u32 v203, v202, 1, 3
  v_lshrrev_b32 v204, 5, v1
  v_xor_b32 v203, v203, v204
  v_mul_u32_u24 v202, 896, v202
  v_add_u32 v202, 98304, v202
  v_xor_b32 v204, 0, v203
  v_lshl_add_u32 v12, v204, 4, v202
  v_xor_b32 v204, 2, v203
  v_lshl_add_u32 v13, v204, 4, v202
  v_xor_b32 v204, 4, v203
  v_lshl_add_u32 v14, v204, 4, v202
  v_xor_b32 v204, 6, v203
  v_lshl_add_u32 v15, v204, 4, v202
  v_lshrrev_b32 v202, 5, v1
  v_bfe_u32 v203, v1, 2, 2
  v_lshl_add_u32 v202, v202, 3, v203
  v_and_b32 v206, 1, v1
  v_lshlrev_b32 v206, 3, v206
  v_bfe_u32 v204, v1, 4, 1
  v_bfe_u32 v205, v1, 1, 1
  v_lshl_add_u32 v204, v204, 1, v205
  v_lshlrev_b32 v205, 2, v203
  v_xor_b32 v205, v204, v205
  s_lshr_b32 s51, s42, 1
  s_lshl_b32 s51, s51, 2
  s_and_b32 s49, s42, 2
  s_lshl_b32 s49, s49, 2
  s_add_u32 s50, s49, 4
  v_xor_b32 v207, s51, v205
  v_lshl_add_u32 v6, v202, 8, v206
  v_lshl_add_u32 v6, v207, 4, v6
  v_add_u32 v7, 0x10000, v6
  s_mov_b32 s52, 0xbdd2d3e8
  s_mov_b32 s54, 0x3f803f80
  v_mov_b32 v226, 0xc0135761
  s_lshl_b32 s55, s43, 1
  s_and_b32 s57, s42, 1
  s_add_u32 s55, s55, s57
  s_mul_i32 s55, s55, 3584
  s_add_u32 s55, s55, 18874368
  s_lshl_b32 s61, s44, 9
  s_add_u32 s61, s61, s55
  s_lshl_b32 s56, s57, 10
  s_lshr_b32 s57, s42, 1
  s_lshl_b32 s57, s57, 3
  s_add_u32 s56, s56, s57
  s_add_u32 s56, s56, 156672
  s_and_b32 s49, s42, 6
  s_cmp_eq_u32 s49, 4
  s_cselect_b32 s55, s55, 0x20000000
  s_lshl_b32 s72, s43, 1
  s_and_b32 s49, s42, 1
  s_add_u32 s72, s72, s49
  s_mul_i32 s72, s72, 56
  s_lshl_b32 s49, s44, 3
  s_add_u32 s72, s72, s49
  s_and_b32 s49, s42, 6
  s_add_u32 s72, s72, s49
  s_lshl_b32 s72, s72, 10
  s_add_u32 s72, s72, 12582912
  s_lshl_b32 s74, s43, 3
  s_add_u32 s74, s74, s44
  s_lshl_b32 s74, s74, 7
  s_add_u32 s74, s74, 20086784
  s_lshl_b32 s75, s44, 18
  s_lshl_b32 s49, s43, 7
  s_add_u32 s75, s75, s49
  s_add_u32 s75, s75, 8388608
  s_lshl_b32 s73, s86, 6
  s_and_b32 s49, s43, 7
  s_lshl_b32 s49, s49, 3
  s_add_u32 s73, s73, s49
  s_lshl_b32 s73, s73, 1
  s_lshl_b32 s58, s44, 5
  s_add_u32 s58, s58, s86
  s_lshl_b32 s58, s58, 14
  s_bfe_u32 s49, s43, 0x20001
  s_lshl_b32 s49, s49, 12
  s_add_u32 s58, s58, s49
  s_and_b32 s49, s43, 1
  s_lshl_b32 s49, s49, 9
  s_add_u32 s58, s58, s49
  s_lshr_b32 s49, s42, 1
  s_lshl_b32 s49, s49, 10
  s_add_u32 s58, s58, s49
  s_add_u32 s58, s58, 4194304
  s_lshl_b32 s59, s44, 5
  s_add_u32 s59, s59, s43
  s_lshl_b32 s59, s59, 7
  s_add_u32 s60, s59, 20021248
  s_add_u32 s59, s59, 19988480
  s_lshl_b32 s89, s44, 12
  s_add_u32 s89, s89, 19988480
  v_and_b32 v250, 31, v1
  v_lshlrev_b32 v250, 7, v250
  s_waitcnt vmcnt(1)
  s_mov_b32 s50, 0x00003f80
  s_mov_b32 s51, 0x3f800000
  v_mov_b32 v200, 0
  v_mov_b32 v201, 0
  v_mov_b32 v202, 0
  v_mov_b32 v203, 0
  v_dot2_f32_bf16 v200, v128, s54, v200
  v_dot2_f32_bf16 v201, v129, s54, v201
  v_dot2_f32_bf16 v202, v130, s54, v202
  v_dot2_f32_bf16 v203, v131, s54, v203
  v_dot2_f32_bf16 v200, v132, s54, v200
  v_dot2_f32_bf16 v201, v133, s54, v201
  v_dot2_f32_bf16 v202, v134, s54, v202
  v_dot2_f32_bf16 v203, v135, s54, v203
  v_dot2_f32_bf16 v200, v136, s54, v200
  v_dot2_f32_bf16 v201, v137, s54, v201
  v_dot2_f32_bf16 v202, v138, s54, v202
  v_dot2_f32_bf16 v203, v139, s54, v203
  v_dot2_f32_bf16 v200, v140, s54, v200
  v_dot2_f32_bf16 v201, v141, s54, v201
  v_dot2_f32_bf16 v202, v142, s54, v202
  v_dot2_f32_bf16 v203, v143, s54, v203
  v_dot2_f32_bf16 v200, v144, s54, v200
  v_dot2_f32_bf16 v201, v145, s54, v201
  v_dot2_f32_bf16 v202, v146, s54, v202
  v_dot2_f32_bf16 v203, v147, s54, v203
  v_dot2_f32_bf16 v200, v148, s54, v200
  v_dot2_f32_bf16 v201, v149, s54, v201
  v_dot2_f32_bf16 v202, v150, s54, v202
  v_dot2_f32_bf16 v203, v151, s54, v203
  v_dot2_f32_bf16 v200, v152, s54, v200
  v_dot2_f32_bf16 v201, v153, s54, v201
  v_dot2_f32_bf16 v202, v154, s54, v202
  v_dot2_f32_bf16 v203, v155, s54, v203
  s_add_u32 m0, s48, 0
  s_add_u32 s49, s46, 1792
  buffer_load_dwordx4 v3, s[8:11], s49 offen lds
  s_add_u32 m0, s48, 8192
  s_add_u32 s49, s46, 116480
  buffer_load_dwordx4 v3, s[8:11], s49 offen lds
  v_add_f32 v200, v200, v201
  v_add_f32 v202, v202, v203
  v_add_f32 v200, v200, v202
  s_nop 1
  v_add_f32_dpp v200, v200, v200 quad_perm:[1,0,3,2] row_mask:0xf bank_mask:0xf
  s_nop 1
  v_add_f32_dpp v200, v200, v200 quad_perm:[2,3,0,1] row_mask:0xf bank_mask:0xf
  s_nop 1
  v_add_f32_dpp v200, v200, v200 row_half_mirror row_mask:0xf bank_mask:0xf
  v_mul_f32 v204, 0x3b124925, v200
  v_cvt_pk_bf16_f32 v205, 0, v204
  v_sub_f32 v206, 0, v205
  v_mov_b32 v200, 0
  v_mov_b32 v201, 0
  v_mov_b32 v202, 0
  v_mov_b32 v203, 0
  v_dot2_f32_bf16 v16, v128, s50, v206
  v_dot2_f32_bf16 v17, v128, s51, v206
  v_dot2_f32_bf16 v18, v129, s50, v206
  v_dot2_f32_bf16 v19, v129, s51, v206
  v_dot2_f32_bf16 v20, v130, s50, v206
  v_dot2_f32_bf16 v21, v130, s51, v206
  v_dot2_f32_bf16 v22, v131, s50, v206
  v_dot2_f32_bf16 v23, v131, s51, v206
  v_dot2_f32_bf16 v24, v132, s50, v206
  v_dot2_f32_bf16 v25, v132, s51, v206
  v_dot2_f32_bf16 v26, v133, s50, v206
  v_dot2_f32_bf16 v27, v133, s51, v206
  v_dot2_f32_bf16 v28, v134, s50, v206
  v_dot2_f32_bf16 v29, v134, s51, v206
  v_dot2_f32_bf16 v30, v135, s50, v206
  v_dot2_f32_bf16 v31, v135, s51, v206
  v_pk_fma_f32 v[200:201], v[16:17], v[16:17], v[200:201]
  v_pk_fma_f32 v[202:203], v[18:19], v[18:19], v[202:203]
  v_pk_fma_f32 v[200:201], v[20:21], v[20:21], v[200:201]
  v_pk_fma_f32 v[202:203], v[22:23], v[22:23], v[202:203]
  v_dot2_f32_bf16 v32, v136, s50, v206
  v_dot2_f32_bf16 v33, v136, s51, v206
  v_dot2_f32_bf16 v34, v137, s50, v206
  v_dot2_f32_bf16 v35, v137, s51, v206
  v_dot2_f32_bf16 v36, v138, s50, v206
  v_dot2_f32_bf16 v37, v138, s51, v206
  v_dot2_f32_bf16 v38, v139, s50, v206
  v_dot2_f32_bf16 v39, v139, s51, v206
  v_pk_fma_f32 v[200:201], v[24:25], v[24:25], v[200:201]
  v_pk_fma_f32 v[202:203], v[26:27], v[26:27], v[202:203]
  v_pk_fma_f32 v[200:201], v[28:29], v[28:29], v[200:201]
  v_pk_fma_f32 v[202:203], v[30:31], v[30:31], v[202:203]
  s_add_u32 m0, s48, 16384
  s_add_u32 s49, s46, 231168
  buffer_load_dwordx4 v3, s[8:11], s49 offen lds
  s_add_u32 m0, s48, 24576
  s_add_u32 s49, s46, 345856
  buffer_load_dwordx4 v3, s[8:11], s49 offen lds
  v_dot2_f32_bf16 v40, v140, s50, v206
  v_dot2_f32_bf16 v41, v140, s51, v206
  v_dot2_f32_bf16 v42, v141, s50, v206
  v_dot2_f32_bf16 v43, v141, s51, v206
  v_dot2_f32_bf16 v44, v142, s50, v206
  v_dot2_f32_bf16 v45, v142, s51, v206
  v_dot2_f32_bf16 v46, v143, s50, v206
  v_dot2_f32_bf16 v47, v143, s51, v206
  v_pk_fma_f32 v[200:201], v[32:33], v[32:33], v[200:201]
  v_pk_fma_f32 v[202:203], v[34:35], v[34:35], v[202:203]
  v_pk_fma_f32 v[200:201], v[36:37], v[36:37], v[200:201]
  v_pk_fma_f32 v[202:203], v[38:39], v[38:39], v[202:203]
  v_dot2_f32_bf16 v48, v144, s50, v206
  v_dot2_f32_bf16 v49, v144, s51, v206
  v_dot2_f32_bf16 v50, v145, s50, v206
  v_dot2_f32_bf16 v51, v145, s51, v206
  v_dot2_f32_bf16 v52, v146, s50, v206
  v_dot2_f32_bf16 v53, v146, s51, v206
  v_dot2_f32_bf16 v54, v147, s50, v206
  v_dot2_f32_bf16 v55, v147, s51, v206
  v_pk_fma_f32 v[200:201], v[40:41], v[40:41], v[200:201]
  v_pk_fma_f32 v[202:203], v[42:43], v[42:43], v[202:203]
  v_pk_fma_f32 v[200:201], v[44:45], v[44:45], v[200:201]
  v_pk_fma_f32 v[202:203], v[46:47], v[46:47], v[202:203]
  v_dot2_f32_bf16 v56, v148, s50, v206
  v_dot2_f32_bf16 v57, v148, s51, v206
  v_dot2_f32_bf16 v58, v149, s50, v206
  v_dot2_f32_bf16 v59, v149, s51, v206
  v_dot2_f32_bf16 v60, v150, s50, v206
  v_dot2_f32_bf16 v61, v150, s51, v206
  v_dot2_f32_bf16 v62, v151, s50, v206
  v_dot2_f32_bf16 v63, v151, s51, v206
  v_pk_fma_f32 v[200:201], v[48:49], v[48:49], v[200:201]
  v_pk_fma_f32 v[202:203], v[50:51], v[50:51], v[202:203]
  v_pk_fma_f32 v[200:201], v[52:53], v[52:53], v[200:201]
  v_pk_fma_f32 v[202:203], v[54:55], v[54:55], v[202:203]
  s_add_u32 m0, s48, 32768
  s_add_u32 s49, s46, 460544
  buffer_load_dwordx4 v3, s[8:11], s49 offen lds
  s_add_u32 m0, s48, 40960
  s_add_u32 s49, s46, 575232
  buffer_load_dwordx4 v3, s[8:11], s49 offen lds
  v_dot2_f32_bf16 v64, v152, s50, v206
  v_dot2_f32_bf16 v65, v152, s51, v206
  v_dot2_f32_bf16 v66, v153, s50, v206
  v_dot2_f32_bf16 v67, v153, s51, v206
  v_dot2_f32_bf16 v68, v154, s50, v206
  v_dot2_f32_bf16 v69, v154, s51, v206
  v_dot2_f32_bf16 v70, v155, s50, v206
  v_dot2_f32_bf16 v71, v155, s51, v206
  v_pk_fma_f32 v[200:201], v[56:57], v[56:57], v[200:201]
  v_pk_fma_f32 v[202:203], v[58:59], v[58:59], v[202:203]
  v_pk_fma_f32 v[200:201], v[60:61], v[60:61], v[200:201]
  v_pk_fma_f32 v[202:203], v[62:63], v[62:63], v[202:203]
  v_pk_fma_f32 v[200:201], v[64:65], v[64:65], v[200:201]
  v_pk_fma_f32 v[202:203], v[66:67], v[66:67], v[202:203]
  v_pk_fma_f32 v[200:201], v[68:69], v[68:69], v[200:201]
  v_pk_fma_f32 v[202:203], v[70:71], v[70:71], v[202:203]
  v_add_f32 v200, v200, v201
  v_add_f32 v202, v202, v203
  v_add_f32 v200, v200, v202
  v_cvt_pk_bf16_f32 v16, 0, v16
  v_cvt_pk_bf16_f32 v17, 0, v17
  v_cvt_pk_bf16_f32 v18, 0, v18
  v_cvt_pk_bf16_f32 v19, 0, v19
  v_cvt_pk_bf16_f32 v20, 0, v20
  v_cvt_pk_bf16_f32 v21, 0, v21
  v_cvt_pk_bf16_f32 v22, 0, v22
  v_cvt_pk_bf16_f32 v23, 0, v23
  v_cvt_pk_bf16_f32 v24, 0, v24
  v_cvt_pk_bf16_f32 v25, 0, v25
  v_cvt_pk_bf16_f32 v26, 0, v26
  v_cvt_pk_bf16_f32 v27, 0, v27
  v_cvt_pk_bf16_f32 v28, 0, v28
  v_cvt_pk_bf16_f32 v29, 0, v29
  v_cvt_pk_bf16_f32 v30, 0, v30
  v_cvt_pk_bf16_f32 v31, 0, v31
  v_add_f32_dpp v200, v200, v200 quad_perm:[1,0,3,2] row_mask:0xf bank_mask:0xf
  s_nop 1
  v_add_f32_dpp v200, v200, v200 quad_perm:[2,3,0,1] row_mask:0xf bank_mask:0xf
  s_nop 1
  v_add_f32_dpp v200, v200, v200 row_half_mirror row_mask:0xf bank_mask:0xf
  v_sub_f32 v202, v204, v205
  v_mul_f32 v202, v202, v202
  v_mov_b32 v203, 0x3b124925
  v_fma_f32 v202, v200, v203, -v202
  v_max_f32 v202, 0, v202
  v_cvt_pk_bf16_f32 v32, 0, v32
  v_cvt_pk_bf16_f32 v33, 0, v33
  v_cvt_pk_bf16_f32 v34, 0, v34
  v_cvt_pk_bf16_f32 v202, v202, v202
  v_cvt_pk_bf16_f32 v35, 0, v35
  v_cvt_pk_bf16_f32 v36, 0, v36
  v_cvt_pk_bf16_f32 v37, 0, v37
  v_lshlrev_b32 v202, 16, v202
  v_cvt_pk_bf16_f32 v38, 0, v38
  v_cvt_pk_bf16_f32 v39, 0, v39
  v_cvt_pk_bf16_f32 v40, 0, v40
  v_add_f32 v202, 0x3727c5ac, v202
  v_cvt_pk_bf16_f32 v41, 0, v41
  v_cvt_pk_bf16_f32 v42, 0, v42
  v_cvt_pk_bf16_f32 v43, 0, v43
  v_cvt_pk_bf16_f32 v202, v202, v202
  v_cvt_pk_bf16_f32 v44, 0, v44
  v_cvt_pk_bf16_f32 v45, 0, v45
  v_cvt_pk_bf16_f32 v46, 0, v46
  v_lshlrev_b32 v202, 16, v202
  v_cvt_pk_bf16_f32 v47, 0, v47
  v_cvt_pk_bf16_f32 v48, 0, v48
  v_cvt_pk_bf16_f32 v49, 0, v49
  v_sqrt_f32 v202, v202
  v_cvt_pk_bf16_f32 v50, 0, v50
  v_cvt_pk_bf16_f32 v51, 0, v51
  v_cvt_pk_bf16_f32 v52, 0, v52
  v_cvt_pk_bf16_f32 v202, v202, v202
  v_cvt_pk_bf16_f32 v53, 0, v53
  v_cvt_pk_bf16_f32 v54, 0, v54
  v_cvt_pk_bf16_f32 v55, 0, v55
  v_lshlrev_b32 v202, 16, v202
  v_cvt_pk_bf16_f32 v56, 0, v56
  v_cvt_pk_bf16_f32 v57, 0, v57
  v_cvt_pk_bf16_f32 v58, 0, v58
  v_rcp_f32 v206, v202
  v_cvt_pk_bf16_f32 v59, 0, v59
  v_cvt_pk_bf16_f32 v60, 0, v60
  v_cvt_pk_bf16_f32 v61, 0, v61
  v_mov_b32 v207, v206
  v_cvt_pk_bf16_f32 v62, 0, v62
  v_cvt_pk_bf16_f32 v63, 0, v63
  v_cvt_pk_bf16_f32 v64, 0, v64
  v_cvt_pk_bf16_f32 v65, 0, v65
  v_cvt_pk_bf16_f32 v66, 0, v66
  v_cvt_pk_bf16_f32 v67, 0, v67
  v_cvt_pk_bf16_f32 v68, 0, v68
  v_cvt_pk_bf16_f32 v69, 0, v69
  v_cvt_pk_bf16_f32 v70, 0, v70
  v_cvt_pk_bf16_f32 v71, 0, v71
  s_add_u32 m0, s48, 49152
  s_add_u32 s49, s46, 689920
  buffer_load_dwordx4 v3, s[8:11], s49 offen lds
  s_add_u32 m0, s48, 57344
  s_add_u32 s49, s46, 804608
  buffer_load_dwordx4 v3, s[8:11], s49 offen lds
  v_pk_mul_f32 v[16:17], v[16:17], v[206:207]
  v_pk_mul_f32 v[18:19], v[18:19], v[206:207]
  v_pk_mul_f32 v[20:21], v[20:21], v[206:207]
  v_pk_mul_f32 v[22:23], v[22:23], v[206:207]
  v_cvt_pk_bf16_f32 v128, v16, v17
  v_cvt_pk_bf16_f32 v129, v18, v19
  v_cvt_pk_bf16_f32 v130, v20, v21
  v_cvt_pk_bf16_f32 v131, v22, v23
  ds_write_b128 v5, v[128:131] offset:0
  v_pk_mul_f32 v[24:25], v[24:25], v[206:207]
  v_pk_mul_f32 v[26:27], v[26:27], v[206:207]
  v_pk_mul_f32 v[28:29], v[28:29], v[206:207]
  v_pk_mul_f32 v[30:31], v[30:31], v[206:207]
  v_cvt_pk_bf16_f32 v132, v24, v25
  v_cvt_pk_bf16_f32 v133, v26, v27
  v_cvt_pk_bf16_f32 v134, v28, v29
  v_cvt_pk_bf16_f32 v135, v30, v31
  ds_write_b128 v5, v[132:135] offset:128
  v_pk_mul_f32 v[32:33], v[32:33], v[206:207]
  v_pk_mul_f32 v[34:35], v[34:35], v[206:207]
  v_pk_mul_f32 v[36:37], v[36:37], v[206:207]
  v_pk_mul_f32 v[38:39], v[38:39], v[206:207]
  v_cvt_pk_bf16_f32 v136, v32, v33
  v_cvt_pk_bf16_f32 v137, v34, v35
  v_cvt_pk_bf16_f32 v138, v36, v37
  v_cvt_pk_bf16_f32 v139, v38, v39
  ds_write_b128 v5, v[136:139] offset:256
  v_pk_mul_f32 v[40:41], v[40:41], v[206:207]
  v_pk_mul_f32 v[42:43], v[42:43], v[206:207]
  v_pk_mul_f32 v[44:45], v[44:45], v[206:207]
  v_pk_mul_f32 v[46:47], v[46:47], v[206:207]
  v_cvt_pk_bf16_f32 v140, v40, v41
  v_cvt_pk_bf16_f32 v141, v42, v43
  v_cvt_pk_bf16_f32 v142, v44, v45
  v_cvt_pk_bf16_f32 v143, v46, v47
  ds_write_b128 v5, v[140:143] offset:384
  v_pk_mul_f32 v[48:49], v[48:49], v[206:207]
  v_pk_mul_f32 v[50:51], v[50:51], v[206:207]
  v_pk_mul_f32 v[52:53], v[52:53], v[206:207]
  v_pk_mul_f32 v[54:55], v[54:55], v[206:207]
  v_cvt_pk_bf16_f32 v144, v48, v49
  v_cvt_pk_bf16_f32 v145, v50, v51
  v_cvt_pk_bf16_f32 v146, v52, v53
  v_cvt_pk_bf16_f32 v147, v54, v55
  ds_write_b128 v5, v[144:147] offset:512
  v_pk_mul_f32 v[56:57], v[56:57], v[206:207]
  v_pk_mul_f32 v[58:59], v[58:59], v[206:207]
  v_pk_mul_f32 v[60:61], v[60:61], v[206:207]
  v_pk_mul_f32 v[62:63], v[62:63], v[206:207]
  v_cvt_pk_bf16_f32 v148, v56, v57
  v_cvt_pk_bf16_f32 v149, v58, v59
  v_cvt_pk_bf16_f32 v150, v60, v61
  v_cvt_pk_bf16_f32 v151, v62, v63
  ds_write_b128 v5, v[148:151] offset:640
  v_pk_mul_f32 v[64:65], v[64:65], v[206:207]
  v_pk_mul_f32 v[66:67], v[66:67], v[206:207]
  v_pk_mul_f32 v[68:69], v[68:69], v[206:207]
  v_pk_mul_f32 v[70:71], v[70:71], v[206:207]
  v_cvt_pk_bf16_f32 v152, v64, v65
  v_cvt_pk_bf16_f32 v153, v66, v67
  v_cvt_pk_bf16_f32 v154, v68, v69
  v_cvt_pk_bf16_f32 v155, v70, v71
  ds_write_b128 v5, v[152:155] offset:768
  s_add_u32 m0, s48, 65536
  s_add_u32 s49, s46, 919296
  buffer_load_dwordx4 v3, s[8:11], s49 offen lds
  s_add_u32 m0, s48, 73728
  s_add_u32 s49, s46, 1033984
  buffer_load_dwordx4 v3, s[8:11], s49 offen lds
  s_cmp_ge_u32 s42, 2
  s_cbranch_scc1 L_PFB
  buffer_load_dword v254, v252, s[8:11], 0 offen
  s_branch L_PFD
L_PFB:
  s_cmp_ge_u32 s42, 4
  s_cselect_b32 s49, 0x10000000, 0
  buffer_load_dword v254, v253, s[16:19], s49 offen
L_PFD:
  s_waitcnt lgkmcnt(0)
  s_waitcnt vmcnt(9)
  s_barrier
  buffer_load_dword v249, v248, s[20:23], 0 offen sc1
  ds_read_b128 v[16:19], v12 offset:0
  ds_read_b64_tr_b16 v[128:129], v6 offset:0
  ds_read_b64_tr_b16 v[130:131], v6 offset:1024
  ds_read_b128 v[20:23], v13 offset:0
  ds_read_b64_tr_b16 v[132:133], v6 offset:4096
  ds_read_b64_tr_b16 v[134:135], v6 offset:5120
  ds_read_b128 v[24:27], v14 offset:0
  ds_read_b64_tr_b16 v[136:137], v6 offset:8192
  ds_read_b64_tr_b16 v[138:139], v6 offset:9216
  ds_read_b128 v[28:31], v15 offset:0
  ds_read_b64_tr_b16 v[140:141], v6 offset:12288
  ds_read_b64_tr_b16 v[142:143], v6 offset:13312
  s_add_u32 m0, s48, 81920
  s_add_u32 s49, s46, 1148672
  buffer_load_dwordx4 v3, s[8:11], s49 offen lds
  s_add_u32 m0, s48, 90112
  s_add_u32 s49, s46, 1263360
  buffer_load_dwordx4 v3, s[8:11], s49 offen lds
  s_waitcnt lgkmcnt(0)
  s_waitcnt vmcnt(10)
  s_barrier
  v_mfma_f32_32x32x16_bf16 v[160:175], v[128:131], v[16:19], 0
  ds_read_b128 v[32:35], v12 offset:128
  ds_read_b64_tr_b16 v[144:145], v6 offset:16384
  ds_read_b64_tr_b16 v[146:147], v6 offset:17408
  ds_read_b128 v[36:39], v13 offset:128
  ds_read_b64_tr_b16 v[148:149], v6 offset:20480
  ds_read_b64_tr_b16 v[150:151], v6 offset:21504
  v_mfma_f32_32x32x16_bf16 v[160:175], v[132:135], v[20:23], v[160:175]
  ds_read_b128 v[40:43], v14 offset:128
  ds_read_b64_tr_b16 v[152:153], v6 offset:24576
  ds_read_b64_tr_b16 v[154:155], v6 offset:25600
  ds_read_b128 v[44:47], v15 offset:128
  ds_read_b64_tr_b16 v[156:157], v6 offset:28672
  ds_read_b64_tr_b16 v[158:159], v6 offset:29696
  v_mfma_f32_32x32x16_bf16 v[160:175], v[136:139], v[24:27], v[160:175]
  s_add_u32 m0, s48, 0
  s_add_u32 s49, s46, 1378048
  buffer_load_dwordx4 v3, s[8:11], s49 offen lds
  s_add_u32 m0, s48, 8192
  s_add_u32 s49, s46, 1492736
  buffer_load_dwordx4 v3, s[8:11], s49 offen lds
  v_mfma_f32_32x32x16_bf16 v[160:175], v[140:143], v[28:31], v[160:175]
  s_waitcnt lgkmcnt(0)
  s_waitcnt vmcnt(10)
  s_barrier
  v_mfma_f32_32x32x16_bf16 v[160:175], v[144:147], v[32:35], v[160:175]
  ds_read_b128 v[48:51], v12 offset:256
  ds_read_b64_tr_b16 v[128:129], v6 offset:32768
  ds_read_b64_tr_b16 v[130:131], v6 offset:33792
  ds_read_b128 v[52:55], v13 offset:256
  ds_read_b64_tr_b16 v[132:133], v6 offset:36864
  ds_read_b64_tr_b16 v[134:135], v6 offset:37888
  v_mfma_f32_32x32x16_bf16 v[160:175], v[148:151], v[36:39], v[160:175]
  ds_read_b128 v[56:59], v14 offset:256
  ds_read_b64_tr_b16 v[136:137], v6 offset:40960
  ds_read_b64_tr_b16 v[138:139], v6 offset:41984
  ds_read_b128 v[60:63], v15 offset:256
  ds_read_b64_tr_b16 v[140:141], v6 offset:45056
  ds_read_b64_tr_b16 v[142:143], v6 offset:46080
  v_mfma_f32_32x32x16_bf16 v[160:175], v[152:155], v[40:43], v[160:175]
  s_add_u32 m0, s48, 16384
  s_add_u32 s49, s47, 0
  buffer_load_dwordx4 v4, s[16:19], s49 offen lds
  s_add_u32 m0, s48, 24576
  s_add_u32 s49, s47, 8192
  buffer_load_dwordx4 v4, s[16:19], s49 offen lds
  v_mfma_f32_32x32x16_bf16 v[160:175], v[156:159], v[44:47], v[160:175]
  s_waitcnt lgkmcnt(0)
  s_waitcnt vmcnt(10)
  s_barrier
  v_mfma_f32_32x32x16_bf16 v[160:175], v[128:131], v[48:51], v[160:175]
  ds_read_b128 v[64:67], v12 offset:384
  ds_read_b64_tr_b16 v[144:145], v6 offset:49152
  ds_read_b64_tr_b16 v[146:147], v6 offset:50176
  ds_read_b128 v[68:71], v13 offset:384
  ds_read_b64_tr_b16 v[148:149], v6 offset:53248
  ds_read_b64_tr_b16 v[150:151], v6 offset:54272
  v_mfma_f32_32x32x16_bf16 v[160:175], v[132:135], v[52:55], v[160:175]
  ds_read_b128 v[72:75], v14 offset:384
  ds_read_b64_tr_b16 v[152:153], v6 offset:57344
  ds_read_b64_tr_b16 v[154:155], v6 offset:58368
  ds_read_b128 v[76:79], v15 offset:384
  ds_read_b64_tr_b16 v[156:157], v6 offset:61440
  ds_read_b64_tr_b16 v[158:159], v6 offset:62464
  v_mfma_f32_32x32x16_bf16 v[160:175], v[136:139], v[56:59], v[160:175]
  s_add_u32 m0, s48, 32768
  s_add_u32 s49, s47, 16384
  buffer_load_dwordx4 v4, s[16:19], s49 offen lds
  s_add_u32 m0, s48, 40960
  s_add_u32 s49, s47, 24576
  buffer_load_dwordx4 v4, s[16:19], s49 offen lds
  v_mfma_f32_32x32x16_bf16 v[160:175], v[140:143], v[60:63], v[160:175]
  s_waitcnt lgkmcnt(0)
  s_waitcnt vmcnt(10)
  s_barrier
  v_mfma_f32_32x32x16_bf16 v[160:175], v[144:147], v[64:67], v[160:175]
  ds_read_b128 v[80:83], v12 offset:512
  ds_read_b64_tr_b16 v[128:129], v7 offset:0
  ds_read_b64_tr_b16 v[130:131], v7 offset:1024
  ds_read_b128 v[84:87], v13 offset:512
  ds_read_b64_tr_b16 v[132:133], v7 offset:4096
  ds_read_b64_tr_b16 v[134:135], v7 offset:5120
  v_mfma_f32_32x32x16_bf16 v[160:175], v[148:151], v[68:71], v[160:175]
  ds_read_b128 v[88:91], v14 offset:512
  ds_read_b64_tr_b16 v[136:137], v7 offset:8192
  ds_read_b64_tr_b16 v[138:139], v7 offset:9216
  ds_read_b128 v[92:95], v15 offset:512
  ds_read_b64_tr_b16 v[140:141], v7 offset:12288
  ds_read_b64_tr_b16 v[142:143], v7 offset:13312
  v_mfma_f32_32x32x16_bf16 v[160:175], v[152:155], v[72:75], v[160:175]
  s_add_u32 m0, s48, 49152
  s_add_u32 s49, s47, 32768
  buffer_load_dwordx4 v4, s[16:19], s49 offen lds
  s_add_u32 m0, s48, 57344
  s_add_u32 s49, s47, 40960
  buffer_load_dwordx4 v4, s[16:19], s49 offen lds
  v_mfma_f32_32x32x16_bf16 v[160:175], v[156:159], v[76:79], v[160:175]
  s_waitcnt lgkmcnt(0)
  s_waitcnt vmcnt(8)
  s_barrier
  v_mfma_f32_32x32x16_bf16 v[160:175], v[128:131], v[80:83], v[160:175]
  ds_read_b128 v[96:99], v12 offset:640
  ds_read_b64_tr_b16 v[144:145], v7 offset:16384
  ds_read_b64_tr_b16 v[146:147], v7 offset:17408
  ds_read_b128 v[100:103], v13 offset:640
  ds_read_b64_tr_b16 v[148:149], v7 offset:20480
  ds_read_b64_tr_b16 v[150:151], v7 offset:21504
  v_mfma_f32_32x32x16_bf16 v[160:175], v[132:135], v[84:87], v[160:175]
  ds_read_b128 v[104:107], v14 offset:640
  ds_read_b64_tr_b16 v[152:153], v7 offset:24576
  ds_read_b64_tr_b16 v[154:155], v7 offset:25600
  ds_read_b128 v[108:111], v15 offset:640
  ds_read_b64_tr_b16 v[156:157], v7 offset:28672
  ds_read_b64_tr_b16 v[158:159], v7 offset:29696
  v_mfma_f32_32x32x16_bf16 v[160:175], v[136:139], v[88:91], v[160:175]
  s_add_u32 m0, s48, 65536
  s_add_u32 s49, s47, 49152
  buffer_load_dwordx4 v4, s[16:19], s49 offen lds
  s_add_u32 m0, s48, 73728
  s_add_u32 s49, s47, 57344
  buffer_load_dwordx4 v4, s[16:19], s49 offen lds
  v_mfma_f32_32x32x16_bf16 v[160:175], v[140:143], v[92:95], v[160:175]
  s_waitcnt lgkmcnt(0)
  s_waitcnt vmcnt(8)
  s_barrier
  s_mov_b32 s50, 0
L_NON:
  v_readfirstlane_b32 s63, v249
  s_add_u32 s50, s50, 1
  s_cmp_lg_u32 s63, 0
  s_cbranch_scc1 L_NON_OK
  s_cmp_ge_u32 s50, 16384
  s_cbranch_scc1 L_NON_OK
  s_sleep 4
  buffer_load_dword v249, v248, s[20:23], 0 offen sc1
  s_waitcnt vmcnt(0)
  s_branch L_NON
L_NON_OK:
  v_mfma_f32_32x32x16_bf16 v[160:175], v[144:147], v[96:99], v[160:175]
  ds_read_b128 v[112:115], v12 offset:768
  ds_read_b64_tr_b16 v[128:129], v6 offset:0
  ds_read_b64_tr_b16 v[130:131], v6 offset:1024
  ds_read_b128 v[116:119], v13 offset:768
  ds_read_b64_tr_b16 v[132:133], v6 offset:4096
  ds_read_b64_tr_b16 v[134:135], v6 offset:5120
  v_mfma_f32_32x32x16_bf16 v[160:175], v[148:151], v[100:103], v[160:175]
  ds_read_b128 v[120:123], v14 offset:768
  ds_read_b64_tr_b16 v[136:137], v6 offset:8192
  ds_read_b64_tr_b16 v[138:139], v6 offset:9216
  ds_read_b128 v[124:127], v15 offset:768
  ds_read_b64_tr_b16 v[140:141], v6 offset:12288
  ds_read_b64_tr_b16 v[142:143], v6 offset:13312
  v_mfma_f32_32x32x16_bf16 v[160:175], v[152:155], v[104:107], v[160:175]
  s_add_u32 m0, s48, 81920
  s_add_u32 s49, s47, 65536
  buffer_load_dwordx4 v4, s[16:19], s49 offen lds
  s_add_u32 m0, s48, 90112
  s_add_u32 s49, s47, 73728
  buffer_load_dwordx4 v4, s[16:19], s49 offen lds
  v_mfma_f32_32x32x16_bf16 v[160:175], v[156:159], v[108:111], v[160:175]
  s_waitcnt lgkmcnt(0)
  v_mfma_f32_32x32x16_bf16 v[160:175], v[128:131], v[112:115], v[160:175]
  v_mfma_f32_32x32x16_bf16 v[160:175], v[132:135], v[116:119], v[160:175]
  v_mfma_f32_32x32x16_bf16 v[160:175], v[136:139], v[120:123], v[160:175]
  v_mfma_f32_32x32x16_bf16 v[160:175], v[140:143], v[124:127], v[160:175]
  v_mov_b32 v202, 0x10000000
  s_and_b32 s49, s40, 4
  s_and_b32 s50, s40, 1
  s_lshl_b32 s50, s50, 1
  s_add_u32 s49, s49, s50
  s_bfe_u32 s50, s40, 0x10001
  s_add_u32 s49, s49, s50
  s_lshl_b32 s49, s49, 20
  s_mul_i32 s50, s41, 128
  v_add_u32 v200, s50, v0
  s_mov_b32 s50, 306783379
  v_mul_hi_u32 v201, v200, s50
  v_mul_u32_u24 v203, 14, v201
  v_sub_u32 v203, v200, v203
  v_lshlrev_b32 v201, 12, v201
  v_lshl_add_u32 v201, v203, 7, v201
  v_cmp_gt_u32 vcc, 128, v0
  s_nop 1
  v_cndmask_b32 v201, v202, v201, vcc
  buffer_load_dword v254, v201, s[24:27], s49 offen offset:1024
  s_mov_b32 s92, s82
  s_and_b32 s93, s83, 0xffff
  s_mov_b32 s94, 802816
  s_mov_b32 s95, 0x20000
  s_cmp_lg_u32 s42, 7
  s_cbranch_scc1 L_WO1
  s_getpc_b64 s[92:93]
  s_add_u32 s92, s92, TAB_TT@rel32@lo+4
  s_addc_u32 s93, s93, TAB_TT@rel32@hi+12
  s_and_b32 s93, s93, 0xffff
  s_mov_b32 s94, 401408
  s_mov_b32 s95, 0x20000
L_WO1:
  s_mul_i32 s49, s40, 28
  s_add_u32 s49, s49, s41
  s_cmp_eq_u32 s42, 7
  s_cselect_b32 s50, 14, 28
  s_mul_i32 s49, s49, s50
  s_lshl_b32 s49, s49, 7
  s_cmp_lt_u32 s42, 6
  s_cselect_b32 s50, 0, s50
  v_lshlrev_b32 v201, 7, v1
  v_cmp_gt_u32 vcc, s50, v1
  s_nop 1
  v_cndmask_b32 v201, v202, v201, vcc
  buffer_load_dword v255, v201, s[92:95], s49 offen
  s_getpc_b64 s[92:93]
  s_add_u32 s92, s92, TAB_TT@rel32@lo+4
  s_addc_u32 s93, s93, TAB_TT@rel32@hi+12
  s_and_b32 s93, s93, 0xffff
  s_mov_b32 s94, 401408
  s_mov_b32 s95, 0x20000
  s_mov_b32 s53, s52
  v_mov_b32 v227, v226
  v_cvt_pk_bf16_f32 v160, 0, v160
  v_cvt_pk_bf16_f32 v161, 0, v161
  v_cvt_pk_bf16_f32 v162, 0, v162
  v_cvt_pk_bf16_f32 v163, 0, v163
  v_cvt_pk_bf16_f32 v164, 0, v164
  v_cvt_pk_bf16_f32 v165, 0, v165
  v_cvt_pk_bf16_f32 v166, 0, v166
  v_cvt_pk_bf16_f32 v167, 0, v167
  v_cvt_pk_bf16_f32 v168, 0, v168
  v_cvt_pk_bf16_f32 v169, 0, v169
  v_cvt_pk_bf16_f32 v170, 0, v170
  v_cvt_pk_bf16_f32 v171, 0, v171
  v_cvt_pk_bf16_f32 v172, 0, v172
  v_cvt_pk_bf16_f32 v173, 0, v173
  v_cvt_pk_bf16_f32 v174, 0, v174
  v_cvt_pk_bf16_f32 v175, 0, v175
  v_pk_mul_f32 v[200:201], v[160:161], v[160:161]
  v_pk_mul_f32 v[202:203], v[162:163], v[162:163]
  v_pk_mul_f32 v[204:205], v[164:165], v[164:165]
  v_pk_mul_f32 v[206:207], v[166:167], v[166:167]
  v_pk_mul_f32 v[208:209], v[168:169], v[168:169]
  v_pk_mul_f32 v[210:211], v[170:171], v[170:171]
  v_pk_mul_f32 v[212:213], v[172:173], v[172:173]
  v_pk_mul_f32 v[214:215], v[174:175], v[174:175]
  v_pk_fma_f32 v[200:201], v[200:201], s[52:53], v[226:227]
  v_pk_fma_f32 v[202:203], v[202:203], s[52:53], v[226:227]
  v_pk_fma_f32 v[204:205], v[204:205], s[52:53], v[226:227]
  v_pk_fma_f32 v[206:207], v[206:207], s[52:53], v[226:227]
  v_pk_fma_f32 v[208:209], v[208:209], s[52:53], v[226:227]
  v_pk_fma_f32 v[210:211], v[210:211], s[52:53], v[226:227]
  v_pk_fma_f32 v[212:213], v[212:213], s[52:53], v[226:227]
  v_pk_fma_f32 v[214:215], v[214:215], s[52:53], v[226:227]
  v_pk_mul_f32 v[200:201], v[200:201], v[160:161]
  v_pk_mul_f32 v[202:203], v[202:203], v[162:163]
  v_pk_mul_f32 v[204:205], v[204:205], v[164:165]
  v_pk_mul_f32 v[206:207], v[206:207], v[166:167]
  v_pk_mul_f32 v[208:209], v[208:209], v[168:169]
  v_pk_mul_f32 v[210:211], v[210:211], v[170:171]
  v_pk_mul_f32 v[212:213], v[212:213], v[172:173]
  v_pk_mul_f32 v[214:215], v[214:215], v[174:175]
  v_exp_f32 v200, v200
  v_exp_f32 v201, v201
  v_exp_f32 v202, v202
  v_exp_f32 v203, v203
  v_exp_f32 v204, v204
  v_exp_f32 v205, v205
  v_exp_f32 v206, v206
  v_exp_f32 v207, v207
  v_exp_f32 v208, v208
  v_exp_f32 v209, v209
  v_exp_f32 v210, v210
  v_exp_f32 v211, v211
  v_exp_f32 v212, v212
  v_exp_f32 v213, v213
  v_exp_f32 v214, v214
  v_exp_f32 v215, v215
  v_pk_add_f32 v[200:201], v[200:201], 1.0 op_sel_hi:[1,0]
  v_pk_add_f32 v[202:203], v[202:203], 1.0 op_sel_hi:[1,0]
  v_pk_add_f32 v[204:205], v[204:205], 1.0 op_sel_hi:[1,0]
  v_pk_add_f32 v[206:207], v[206:207], 1.0 op_sel_hi:[1,0]
  v_pk_add_f32 v[208:209], v[208:209], 1.0 op_sel_hi:[1,0]
  v_pk_add_f32 v[210:211], v[210:211], 1.0 op_sel_hi:[1,0]
  v_pk_add_f32 v[212:213], v[212:213], 1.0 op_sel_hi:[1,0]
  v_pk_add_f32 v[214:215], v[214:215], 1.0 op_sel_hi:[1,0]
  v_rcp_f32 v200, v200
  v_rcp_f32 v201, v201
  v_rcp_f32 v202, v202
  v_rcp_f32 v203, v203
  v_rcp_f32 v204, v204
  v_rcp_f32 v205, v205
  v_rcp_f32 v206, v206
  v_rcp_f32 v207, v207
  v_rcp_f32 v208, v208
  v_rcp_f32 v209, v209
  v_rcp_f32 v210, v210
  v_rcp_f32 v211, v211
  v_rcp_f32 v212, v212
  v_rcp_f32 v213, v213
  v_rcp_f32 v214, v214
  v_rcp_f32 v215, v215
  v_pk_mul_f32 v[200:201], v[200:201], v[160:161]
  v_pk_mul_f32 v[202:203], v[202:203], v[162:163]
  v_pk_mul_f32 v[204:205], v[204:205], v[164:165]
  v_pk_mul_f32 v[206:207], v[206:207], v[166:167]
  v_pk_mul_f32 v[208:209], v[208:209], v[168:169]
  v_pk_mul_f32 v[210:211], v[210:211], v[170:171]
  v_pk_mul_f32 v[212:213], v[212:213], v[172:173]
  v_pk_mul_f32 v[214:215], v[214:215], v[174:175]
  v_cvt_pk_bf16_f32 v160, 0, v200
  v_cvt_pk_bf16_f32 v161, 0, v201
  v_cvt_pk_bf16_f32 v162, 0, v202
  v_cvt_pk_bf16_f32 v163, 0, v203
  v_cvt_pk_bf16_f32 v164, 0, v204
  v_cvt_pk_bf16_f32 v165, 0, v205
  v_cvt_pk_bf16_f32 v166, 0, v206
  v_cvt_pk_bf16_f32 v167, 0, v207
  v_cvt_pk_bf16_f32 v168, 0, v208
  v_cvt_pk_bf16_f32 v169, 0, v209
  v_cvt_pk_bf16_f32 v170, 0, v210
  v_cvt_pk_bf16_f32 v171, 0, v211
  v_cvt_pk_bf16_f32 v172, 0, v212
  v_cvt_pk_bf16_f32 v173, 0, v213
  v_cvt_pk_bf16_f32 v174, 0, v214
  v_cvt_pk_bf16_f32 v175, 0, v215
  v_pk_add_f32 v[200:201], v[160:161], v[168:169]
  v_pk_add_f32 v[202:203], v[162:163], v[170:171]
  v_pk_add_f32 v[204:205], v[164:165], v[172:173]
  v_pk_add_f32 v[206:207], v[166:167], v[174:175]
  v_pk_add_f32 v[200:201], v[200:201], v[204:205]
  v_pk_add_f32 v[202:203], v[202:203], v[206:207]
  v_pk_add_f32 v[200:201], v[200:201], v[202:203]
  v_add_f32 v200, v200, v201
  v_mov_b32 v201, v200
  s_nop 1
  v_permlane32_swap_b32 v200, v201
  v_add_f32 v200, v200, v201
  v_mul_f32 v218, 0xbd000000, v200
  v_pk_add_f32 v[200:201], v[160:161], v[218:219] op_sel_hi:[1,0]
  v_pk_add_f32 v[202:203], v[162:163], v[218:219] op_sel_hi:[1,0]
  v_pk_add_f32 v[204:205], v[164:165], v[218:219] op_sel_hi:[1,0]
  v_pk_add_f32 v[206:207], v[166:167], v[218:219] op_sel_hi:[1,0]
  v_pk_add_f32 v[208:209], v[168:169], v[218:219] op_sel_hi:[1,0]
  v_pk_add_f32 v[210:211], v[170:171], v[218:219] op_sel_hi:[1,0]
  v_pk_add_f32 v[212:213], v[172:173], v[218:219] op_sel_hi:[1,0]
  v_pk_add_f32 v[214:215], v[174:175], v[218:219] op_sel_hi:[1,0]
  v_pk_mul_f32 v[228:229], v[200:201], v[200:201]
  v_pk_mul_f32 v[230:231], v[202:203], v[202:203]
  v_pk_fma_f32 v[228:229], v[204:205], v[204:205], v[228:229]
  v_pk_fma_f32 v[230:231], v[206:207], v[206:207], v[230:231]
  v_pk_fma_f32 v[228:229], v[208:209], v[208:209], v[228:229]
  v_pk_fma_f32 v[230:231], v[210:211], v[210:211], v[230:231]
  v_pk_fma_f32 v[228:229], v[212:213], v[212:213], v[228:229]
  v_pk_fma_f32 v[230:231], v[214:215], v[214:215], v[230:231]
  v_pk_add_f32 v[228:229], v[228:229], v[230:231]
  v_add_f32 v209, v228, v229
  v_sub_f32 v208, 0, v218
  v_mov_b32 v201, v209
  s_nop 1
  v_permlane32_swap_b32 v209, v201
  v_add_f32 v209, v209, v201
  v_and_b32 v210, 31, v1
  v_lshlrev_b32 v210, 5, v210
  v_add_u32 v210, s56, v210
  ds_write_b64 v210, v[208:209]
  v_and_b32 v221, 31, v1
  v_lshlrev_b32 v221, 4, v221
  v_lshrrev_b32 v220, 5, v1
  v_mul_u32_u24 v220, 1536, v220
  v_add_u32 v220, v220, v221
  v_add_u32 v221, 3072, v221
  s_waitcnt lgkmcnt(0)
  s_cmp_ge_u32 s42, 4
  s_cbranch_scc1 L_P2Z
  s_lshr_b32 s49, s42, 1
  s_lshl_b32 s49, s49, 12
  v_add_u32 v8, s49, v4
  v_add_u32 v9, 0x10000, v8
  s_waitcnt vmcnt(10)
  s_barrier
  ds_read_b128 v[144:147], v8 offset:16384
  ds_read_b128 v[148:151], v8 offset:17408
  ds_read_b128 v[152:155], v8 offset:18432
  ds_read_b128 v[156:159], v8 offset:19456
  ds_read_b128 v[228:231], v8 offset:24576
  ds_read_b128 v[232:235], v8 offset:25600
  ds_read_b128 v[236:239], v8 offset:26624
  ds_read_b128 v[240:243], v8 offset:27648
  s_add_u32 m0, s48, 0
  s_add_u32 s49, s47, 81920
  buffer_load_dwordx4 v4, s[16:19], s49 offen lds
  s_add_u32 m0, s48, 8192
  s_add_u32 s49, s47, 90112
  buffer_load_dwordx4 v4, s[16:19], s49 offen lds
  s_waitcnt lgkmcnt(4)
  v_mfma_f32_32x32x16_bf16 v[176:191], v[16:19], v[144:147], 0
  v_mfma_f32_32x32x16_bf16 v[176:191], v[16:19], v[148:151], v[176:191]
  v_mfma_f32_32x32x16_bf16 v[176:191], v[20:23], v[152:155], v[176:191]
  v_mfma_f32_32x32x16_bf16 v[176:191], v[20:23], v[156:159], v[176:191]
  s_waitcnt lgkmcnt(0)
  s_waitcnt vmcnt(10)
  s_barrier
  v_mfma_f32_32x32x16_bf16 v[176:191], v[24:27], v[228:231], v[176:191]
  ds_read_b128 v[128:131], v8 offset:32768
  ds_read_b128 v[132:135], v8 offset:33792
  ds_read_b128 v[136:139], v8 offset:34816
  ds_read_b128 v[140:143], v8 offset:35840
  v_mfma_f32_32x32x16_bf16 v[176:191], v[24:27], v[232:235], v[176:191]
  ds_read_b128 v[144:147], v8 offset:40960
  ds_read_b128 v[148:151], v8 offset:41984
  ds_read_b128 v[152:155], v8 offset:43008
  ds_read_b128 v[156:159], v8 offset:44032
  v_mfma_f32_32x32x16_bf16 v[176:191], v[28:31], v[236:239], v[176:191]
  s_add_u32 m0, s48, 16384
  s_add_u32 s49, s47, 98304
  buffer_load_dwordx4 v4, s[16:19], s49 offen lds
  s_add_u32 m0, s48, 24576
  s_add_u32 s49, s47, 106496
  buffer_load_dwordx4 v4, s[16:19], s49 offen lds
  v_mfma_f32_32x32x16_bf16 v[176:191], v[28:31], v[240:243], v[176:191]
  s_waitcnt lgkmcnt(4)
  v_mfma_f32_32x32x16_bf16 v[176:191], v[32:35], v[128:131], v[176:191]
  v_mfma_f32_32x32x16_bf16 v[176:191], v[32:35], v[132:135], v[176:191]
  v_mfma_f32_32x32x16_bf16 v[176:191], v[36:39], v[136:139], v[176:191]
  v_mfma_f32_32x32x16_bf16 v[176:191], v[36:39], v[140:143], v[176:191]
  s_waitcnt lgkmcnt(0)
  s_waitcnt vmcnt(10)
  s_barrier
  v_mfma_f32_32x32x16_bf16 v[176:191], v[40:43], v[144:147], v[176:191]
  ds_read_b128 v[228:231], v8 offset:49152
  ds_read_b128 v[232:235], v8 offset:50176
  ds_read_b128 v[236:239], v8 offset:51200
  ds_read_b128 v[240:243], v8 offset:52224
  v_mfma_f32_32x32x16_bf16 v[176:191], v[40:43], v[148:151], v[176:191]
  ds_read_b128 v[128:131], v8 offset:57344
  ds_read_b128 v[132:135], v8 offset:58368
  ds_read_b128 v[136:139], v8 offset:59392
  ds_read_b128 v[140:143], v8 offset:60416
  v_mfma_f32_32x32x16_bf16 v[176:191], v[44:47], v[152:155], v[176:191]
  s_add_u32 m0, s48, 32768
  s_add_u32 s49, s46, 0
  buffer_load_dwordx4 v3, s[8:11], s49 offen lds
  s_add_u32 m0, s48, 40960
  s_add_u32 s49, s46, 114688
  buffer_load_dwordx4 v3, s[8:11], s49 offen lds
  v_mfma_f32_32x32x16_bf16 v[176:191], v[44:47], v[156:159], v[176:191]
  s_waitcnt lgkmcnt(4)
  v_mfma_f32_32x32x16_bf16 v[176:191], v[48:51], v[228:231], v[176:191]
  v_mfma_f32_32x32x16_bf16 v[176:191], v[48:51], v[232:235], v[176:191]
  v_mfma_f32_32x32x16_bf16 v[176:191], v[52:55], v[236:239], v[176:191]
  v_mfma_f32_32x32x16_bf16 v[176:191], v[52:55], v[240:243], v[176:191]
  s_waitcnt lgkmcnt(0)
  s_waitcnt vmcnt(10)
  s_barrier
  v_mfma_f32_32x32x16_bf16 v[176:191], v[56:59], v[128:131], v[176:191]
  ds_read_b128 v[144:147], v9 offset:0
  ds_read_b128 v[148:151], v9 offset:1024
  ds_read_b128 v[152:155], v9 offset:2048
  ds_read_b128 v[156:159], v9 offset:3072
  v_mfma_f32_32x32x16_bf16 v[176:191], v[56:59], v[132:135], v[176:191]
  ds_read_b128 v[228:231], v9 offset:8192
  ds_read_b128 v[232:235], v9 offset:9216
  ds_read_b128 v[236:239], v9 offset:10240
  ds_read_b128 v[240:243], v9 offset:11264
  v_mfma_f32_32x32x16_bf16 v[176:191], v[60:63], v[136:139], v[176:191]
  s_add_u32 m0, s48, 49152
  s_add_u32 s49, s46, 229376
  buffer_load_dwordx4 v3, s[8:11], s49 offen lds
  s_add_u32 m0, s48, 57344
  s_add_u32 s49, s46, 344064
  buffer_load_dwordx4 v3, s[8:11], s49 offen lds
  v_mfma_f32_32x32x16_bf16 v[176:191], v[60:63], v[140:143], v[176:191]
  s_waitcnt lgkmcnt(4)
  v_mfma_f32_32x32x16_bf16 v[176:191], v[64:67], v[144:147], v[176:191]
  v_mfma_f32_32x32x16_bf16 v[176:191], v[64:67], v[148:151], v[176:191]
  v_mfma_f32_32x32x16_bf16 v[176:191], v[68:71], v[152:155], v[176:191]
  v_mfma_f32_32x32x16_bf16 v[176:191], v[68:71], v[156:159], v[176:191]
  s_waitcnt lgkmcnt(0)
  s_waitcnt vmcnt(10)
  s_barrier
  v_mfma_f32_32x32x16_bf16 v[176:191], v[72:75], v[228:231], v[176:191]
  ds_read_b128 v[128:131], v9 offset:16384
  ds_read_b128 v[132:135], v9 offset:17408
  ds_read_b128 v[136:139], v9 offset:18432
  ds_read_b128 v[140:143], v9 offset:19456
  v_mfma_f32_32x32x16_bf16 v[176:191], v[72:75], v[232:235], v[176:191]
  ds_read_b128 v[144:147], v9 offset:24576
  ds_read_b128 v[148:151], v9 offset:25600
  ds_read_b128 v[152:155], v9 offset:26624
  ds_read_b128 v[156:159], v9 offset:27648
  v_mfma_f32_32x32x16_bf16 v[176:191], v[76:79], v[236:239], v[176:191]
  s_add_u32 m0, s48, 65536
  s_add_u32 s49, s46, 458752
  buffer_load_dwordx4 v3, s[8:11], s49 offen lds
  s_add_u32 m0, s48, 73728
  s_add_u32 s49, s46, 573440
  buffer_load_dwordx4 v3, s[8:11], s49 offen lds
  v_mfma_f32_32x32x16_bf16 v[176:191], v[76:79], v[240:243], v[176:191]
  s_waitcnt lgkmcnt(4)
  v_mfma_f32_32x32x16_bf16 v[176:191], v[80:83], v[128:131], v[176:191]
  v_mfma_f32_32x32x16_bf16 v[176:191], v[80:83], v[132:135], v[176:191]
  v_mfma_f32_32x32x16_bf16 v[176:191], v[84:87], v[136:139], v[176:191]
  v_mfma_f32_32x32x16_bf16 v[176:191], v[84:87], v[140:143], v[176:191]
  s_waitcnt lgkmcnt(0)
  s_waitcnt vmcnt(8)
  s_barrier
  v_mfma_f32_32x32x16_bf16 v[176:191], v[88:91], v[144:147], v[176:191]
  ds_read_b128 v[228:231], v8 offset:0
  ds_read_b128 v[232:235], v8 offset:1024
  ds_read_b128 v[236:239], v8 offset:2048
  ds_read_b128 v[240:243], v8 offset:3072
  v_mfma_f32_32x32x16_bf16 v[176:191], v[88:91], v[148:151], v[176:191]
  ds_read_b128 v[128:131], v8 offset:8192
  ds_read_b128 v[132:135], v8 offset:9216
  ds_read_b128 v[136:139], v8 offset:10240
  ds_read_b128 v[140:143], v8 offset:11264
  v_mfma_f32_32x32x16_bf16 v[176:191], v[92:95], v[152:155], v[176:191]
  s_add_u32 m0, s48, 81920
  s_add_u32 s49, s46, 688128
  buffer_load_dwordx4 v3, s[8:11], s49 offen lds
  s_add_u32 m0, s48, 90112
  s_add_u32 s49, s46, 802816
  buffer_load_dwordx4 v3, s[8:11], s49 offen lds
  v_mfma_f32_32x32x16_bf16 v[176:191], v[92:95], v[156:159], v[176:191]
  s_waitcnt lgkmcnt(4)
  v_mfma_f32_32x32x16_bf16 v[176:191], v[96:99], v[228:231], v[176:191]
  v_mfma_f32_32x32x16_bf16 v[176:191], v[96:99], v[232:235], v[176:191]
  v_mfma_f32_32x32x16_bf16 v[176:191], v[100:103], v[236:239], v[176:191]
  v_mfma_f32_32x32x16_bf16 v[176:191], v[100:103], v[240:243], v[176:191]
  s_waitcnt lgkmcnt(0)
  s_waitcnt vmcnt(8)
  s_barrier
  s_and_b32 s29, s42, 1
  s_lshl_b32 s29, s29, 8
  s_add_u32 s29, s29, 158720
  v_and_b32 v200, 31, v1
  v_lshlrev_b32 v200, 3, v200
  v_add_u32 v200, s29, v200
  ds_read_b64 v[202:203], v200
  s_waitcnt lgkmcnt(0)
  v_pk_add_f32 v[160:161], v[160:161], v[202:203] op_sel_hi:[1,0]
  v_pk_add_f32 v[162:163], v[162:163], v[202:203] op_sel_hi:[1,0]
  v_pk_add_f32 v[164:165], v[164:165], v[202:203] op_sel_hi:[1,0]
  v_pk_add_f32 v[166:167], v[166:167], v[202:203] op_sel_hi:[1,0]
  v_pk_add_f32 v[168:169], v[168:169], v[202:203] op_sel_hi:[1,0]
  v_pk_add_f32 v[170:171], v[170:171], v[202:203] op_sel_hi:[1,0]
  v_pk_add_f32 v[172:173], v[172:173], v[202:203] op_sel_hi:[1,0]
  v_pk_add_f32 v[174:175], v[174:175], v[202:203] op_sel_hi:[1,0]
  v_cvt_pk_bf16_f32 v160, 0, v160
  v_cvt_pk_bf16_f32 v161, 0, v161
  v_cvt_pk_bf16_f32 v162, 0, v162
  v_cvt_pk_bf16_f32 v163, 0, v163
  v_cvt_pk_bf16_f32 v164, 0, v164
  v_cvt_pk_bf16_f32 v165, 0, v165
  v_cvt_pk_bf16_f32 v166, 0, v166
  v_cvt_pk_bf16_f32 v167, 0, v167
  v_cvt_pk_bf16_f32 v168, 0, v168
  v_cvt_pk_bf16_f32 v169, 0, v169
  v_cvt_pk_bf16_f32 v170, 0, v170
  v_cvt_pk_bf16_f32 v171, 0, v171
  v_cvt_pk_bf16_f32 v172, 0, v172
  v_cvt_pk_bf16_f32 v173, 0, v173
  v_cvt_pk_bf16_f32 v174, 0, v174
  v_cvt_pk_bf16_f32 v175, 0, v175
  v_pk_mul_f32 v[160:161], v[160:161], v[202:203] op_sel:[0,1]
  v_pk_mul_f32 v[162:163], v[162:163], v[202:203] op_sel:[0,1]
  v_pk_mul_f32 v[164:165], v[164:165], v[202:203] op_sel:[0,1]
  v_pk_mul_f32 v[166:167], v[166:167], v[202:203] op_sel:[0,1]
  v_pk_mul_f32 v[168:169], v[168:169], v[202:203] op_sel:[0,1]
  v_pk_mul_f32 v[170:171], v[170:171], v[202:203] op_sel:[0,1]
  v_pk_mul_f32 v[172:173], v[172:173], v[202:203] op_sel:[0,1]
  v_pk_mul_f32 v[174:175], v[174:175], v[202:203] op_sel:[0,1]
  v_cvt_pk_bf16_f32 v192, v160, v161
  v_cvt_pk_bf16_f32 v193, v162, v163
  v_cvt_pk_bf16_f32 v194, v164, v165
  v_cvt_pk_bf16_f32 v195, v166, v167
  v_cvt_pk_bf16_f32 v196, v168, v169
  v_cvt_pk_bf16_f32 v197, v170, v171
  v_cvt_pk_bf16_f32 v198, v172, v173
  v_cvt_pk_bf16_f32 v199, v174, v175
  s_lshl_b32 s29, s42, 11
  s_add_u32 s29, s29, 98304
  v_and_b32 v200, 31, v1
  v_lshlrev_b32 v200, 6, v200
  v_lshrrev_b32 v201, 5, v1
  v_lshl_add_u32 v200, v201, 3, v200
  v_add_u32 v200, s29, v200
  v_bfe_u32 v202, v1, 1, 2
  v_lshlrev_b32 v202, 4, v202
  v_xor_b32 v204, 0, v202
  v_add_u32 v204, v204, v200
  v_xor_b32 v205, 16, v202
  v_add_u32 v205, v205, v200
  v_xor_b32 v206, 32, v202
  v_add_u32 v206, v206, v200
  v_xor_b32 v207, 48, v202
  v_add_u32 v207, v207, v200
  ds_write_b64 v204, v[192:193]
  ds_write_b64 v205, v[194:195]
  ds_write_b64 v206, v[196:197]
  ds_write_b64 v207, v[198:199]
  v_bfe_u32 v202, v1, 2, 2
  v_lshl_add_u32 v201, v201, 3, v202
  v_lshlrev_b32 v201, 6, v201
  v_and_b32 v203, 1, v1
  v_lshl_add_u32 v201, v203, 3, v201
  v_add_u32 v201, s29, v201
  v_bfe_u32 v203, v1, 4, 1
  v_bfe_u32 v208, v1, 1, 1
  v_lshl_add_u32 v203, v203, 1, v208
  v_lshrrev_b32 v202, 1, v202
  v_xor_b32 v203, v203, v202
  v_lshl_add_u32 v208, v203, 4, v201
  v_xor_b32 v203, 2, v203
  v_lshl_add_u32 v209, v203, 4, v201
  ds_read_b64_tr_b16 v[228:229], v208 offset:0
  ds_read_b64_tr_b16 v[230:231], v209 offset:256
  ds_read_b64_tr_b16 v[232:233], v208 offset:1024
  ds_read_b64_tr_b16 v[234:235], v209 offset:1280
  s_add_u32 s28, s58, 32768
  s_waitcnt lgkmcnt(0)
  buffer_store_dwordx4 v[228:231], v245, s[12:15], s58 offen sc1
  buffer_store_dwordx4 v[232:235], v245, s[12:15], s28 offen sc1
  v_mfma_f32_32x32x16_bf16 v[176:191], v[104:107], v[128:131], v[176:191]
  ds_read_b128 v[144:147], v8 offset:16384
  ds_read_b128 v[148:151], v8 offset:17408
  ds_read_b128 v[152:155], v8 offset:18432
  ds_read_b128 v[156:159], v8 offset:19456
  v_mfma_f32_32x32x16_bf16 v[176:191], v[104:107], v[132:135], v[176:191]
  ds_read_b128 v[228:231], v8 offset:24576
  ds_read_b128 v[232:235], v8 offset:25600
  ds_read_b128 v[236:239], v8 offset:26624
  ds_read_b128 v[240:243], v8 offset:27648
  v_mfma_f32_32x32x16_bf16 v[176:191], v[108:111], v[136:139], v[176:191]
  s_add_u32 m0, s48, 0
  s_add_u32 s49, s46, 917504
  buffer_load_dwordx4 v3, s[8:11], s49 offen lds
  s_add_u32 m0, s48, 8192
  s_add_u32 s49, s46, 1032192
  buffer_load_dwordx4 v3, s[8:11], s49 offen lds
  v_mfma_f32_32x32x16_bf16 v[176:191], v[108:111], v[140:143], v[176:191]
  s_waitcnt lgkmcnt(4)
  v_mfma_f32_32x32x16_bf16 v[176:191], v[112:115], v[144:147], v[176:191]
  v_mfma_f32_32x32x16_bf16 v[176:191], v[112:115], v[148:151], v[176:191]
  v_mfma_f32_32x32x16_bf16 v[176:191], v[116:119], v[152:155], v[176:191]
  v_mfma_f32_32x32x16_bf16 v[176:191], v[116:119], v[156:159], v[176:191]
  s_waitcnt lgkmcnt(0)
  v_mfma_f32_32x32x16_bf16 v[176:191], v[120:123], v[228:231], v[176:191]
  v_mfma_f32_32x32x16_bf16 v[176:191], v[120:123], v[232:235], v[176:191]
  v_mfma_f32_32x32x16_bf16 v[176:191], v[124:127], v[236:239], v[176:191]
  v_mfma_f32_32x32x16_bf16 v[176:191], v[124:127], v[240:243], v[176:191]
  v_and_b32 v200, 31, v1
  s_lshr_b32 s49, s42, 1
  s_lshl_b32 s49, s49, 5
  v_add_u32 v200, s49, v200
  v_mul_u32_u24 v200, 144, v200
  v_lshrrev_b32 v201, 5, v1
  v_lshl_add_u32 v200, v201, 6, v200
  s_and_b32 s49, s42, 1
  s_lshl_b32 s49, s49, 3
  s_add_u32 s49, s49, 147456
  v_add_u32 v200, s49, v200
  s_branch L_J1
L_P2Z:
  s_waitcnt vmcnt(10)
  s_barrier
  s_and_b32 s49, s42, 6
  s_cmp_lg_u32 s49, 4
  s_cbranch_scc1 L_NOSIG
  v_and_b32 v210, 31, v1
  v_lshlrev_b32 v211, 5, v210
  s_sub_u32 s49, s56, 16
  v_add_u32 v211, s49, v211
  ds_read_b128 v[200:203], v211
  ds_read_b128 v[204:207], v211 offset:16
  s_waitcnt lgkmcnt(0)
  v_add_f32 v208, v200, v202
  v_add_f32 v209, v204, v206
  v_add_f32 v208, v208, v209
  v_mul_f32 v212, 0.25, v208
  v_add_f32 v214, v201, v203
  v_add_f32 v209, v205, v207
  v_add_f32 v214, v214, v209
  v_mov_b32 v208, 0
  v_sub_f32 v209, v200, v212
  v_fmac_f32 v208, v209, v209
  v_sub_f32 v209, v202, v212
  v_fmac_f32 v208, v209, v209
  v_sub_f32 v209, v204, v212
  v_fmac_f32 v208, v209, v209
  v_sub_f32 v209, v206, v212
  v_fmac_f32 v208, v209, v209
  v_mov_b32 v209, 0x42000000
  v_fma_f32 v214, v208, v209, v214
  v_mov_b32 v213, s63
  v_mov_b32 v215, s63
  v_lshlrev_b32 v210, 4, v210
  buffer_store_dwordx4 v[212:215], v210, s[12:15], s61 offen sc1
  s_nop 1
L_NOSIG:
  s_add_u32 m0, s48, 0
  s_add_u32 s49, s47, 81920
  buffer_load_dwordx4 v4, s[16:19], s49 offen lds
  s_add_u32 m0, s48, 8192
  s_add_u32 s49, s47, 90112
  buffer_load_dwordx4 v4, s[16:19], s49 offen lds
  s_waitcnt vmcnt(10)
  s_barrier
  s_add_u32 m0, s48, 16384
  s_add_u32 s49, s47, 98304
  buffer_load_dwordx4 v4, s[16:19], s49 offen lds
  s_add_u32 m0, s48, 24576
  s_add_u32 s49, s47, 106496
  buffer_load_dwordx4 v4, s[16:19], s49 offen lds
  s_waitcnt vmcnt(10)
  s_barrier
  s_add_u32 m0, s48, 32768
  s_add_u32 s49, s46, 0
  buffer_load_dwordx4 v3, s[8:11], s49 offen lds
  s_add_u32 m0, s48, 40960
  s_add_u32 s49, s46, 114688
  buffer_load_dwordx4 v3, s[8:11], s49 offen lds
  s_waitcnt vmcnt(10)
  s_barrier
  buffer_load_dwordx4 v[228:231], v220, s[12:15], s55 offen offset:0 sc1
  buffer_load_dwordx4 v[232:235], v220, s[12:15], s55 offen offset:512 sc1
  buffer_load_dwordx4 v[236:239], v220, s[12:15], s55 offen offset:1024 sc1
  buffer_load_dwordx4 v[240:243], v221, s[12:15], s55 offen offset:0 sc1
  s_add_u32 m0, s48, 49152
  s_add_u32 s49, s46, 229376
  buffer_load_dwordx4 v3, s[8:11], s49 offen lds
  s_add_u32 m0, s48, 57344
  s_add_u32 s49, s46, 344064
  buffer_load_dwordx4 v3, s[8:11], s49 offen lds
  s_waitcnt vmcnt(14)
  s_barrier
  s_add_u32 m0, s48, 65536
  s_add_u32 s49, s46, 458752
  buffer_load_dwordx4 v3, s[8:11], s49 offen lds
  s_add_u32 m0, s48, 73728
  s_add_u32 s49, s46, 573440
  buffer_load_dwordx4 v3, s[8:11], s49 offen lds
  s_waitcnt vmcnt(12)
  s_barrier
  s_add_u32 m0, s48, 81920
  s_add_u32 s49, s46, 688128
  buffer_load_dwordx4 v3, s[8:11], s49 offen lds
  s_add_u32 m0, s48, 90112
  s_add_u32 s49, s46, 802816
  buffer_load_dwordx4 v3, s[8:11], s49 offen lds
  s_waitcnt vmcnt(6)
  s_and_b32 s49, s42, 6
  s_cmp_lg_u32 s49, 4
  s_cbranch_scc1 L_NOCHK
  s_mov_b32 s50, 0
L_CHK:
  v_cmp_eq_u32 vcc, s63, v229
  v_cmp_eq_u32 s[30:31], s63, v231
  s_nop 0
  s_and_b64 vcc, vcc, s[30:31]
  v_cmp_eq_u32 s[30:31], s63, v233
  s_nop 0
  s_and_b64 vcc, vcc, s[30:31]
  v_cmp_eq_u32 s[30:31], s63, v235
  s_nop 0
  s_and_b64 vcc, vcc, s[30:31]
  v_cmp_eq_u32 s[30:31], s63, v237
  s_nop 0
  s_and_b64 vcc, vcc, s[30:31]
  v_cmp_eq_u32 s[30:31], s63, v239
  s_nop 0
  s_and_b64 vcc, vcc, s[30:31]
  v_cmp_eq_u32 s[30:31], s63, v241
  s_nop 0
  s_and_b64 vcc, vcc, s[30:31]
  v_cmp_eq_u32 s[30:31], s63, v243
  s_nop 0
  s_and_b64 vcc, vcc, s[30:31]
  s_add_u32 s50, s50, 1
  s_cmp_eq_u64 vcc, exec
  s_cbranch_scc1 L_CHKOK
  s_cmp_ge_u32 s50, 16384
  s_cbranch_scc1 L_CHKOK
  s_sleep 2
  buffer_load_dwordx4 v[228:231], v220, s[12:15], s55 offen offset:0 sc1
  buffer_load_dwordx4 v[232:235], v220, s[12:15], s55 offen offset:512 sc1
  buffer_load_dwordx4 v[236:239], v220, s[12:15], s55 offen offset:1024 sc1
  buffer_load_dwordx4 v[240:243], v221, s[12:15], s55 offen offset:0 sc1
  s_waitcnt vmcnt(0)
  s_branch L_CHK
L_CHKOK:
  v_mul_f32 v200, 0.5, v240
  v_mul_f32 v201, 0.5, v242
  v_add_f32 v200, v200, v228
  v_add_f32 v201, v201, v230
  v_add_f32 v200, v200, v232
  v_add_f32 v201, v201, v234
  v_add_f32 v200, v200, v236
  v_add_f32 v201, v201, v238
  v_mov_b32 v202, v200
  s_nop 1
  v_permlane32_swap_b32 v200, v202
  v_add_f32 v200, v200, v202
  v_mov_b32 v202, v201
  s_nop 1
  v_permlane32_swap_b32 v201, v202
  v_add_f32 v201, v201, v202
  v_mul_f32 v200, 0x3e124925, v200
  v_sub_f32 v204, v240, v200
  v_mul_f32 v203, v204, v204
  v_mul_f32 v203, 0.5, v203
  v_sub_f32 v204, v228, v200
  v_fmac_f32 v203, v204, v204
  v_sub_f32 v204, v232, v200
  v_fmac_f32 v203, v204, v204
  v_sub_f32 v204, v236, v200
  v_fmac_f32 v203, v204, v204
  v_mov_b32 v202, v203
  s_nop 1
  v_permlane32_swap_b32 v203, v202
  v_add_f32 v203, v203, v202
  v_mov_b32 v202, 0x43000000
  v_fma_f32 v201, v203, v202, v201
  v_mul_f32 v201, 0x3a924925, v201
  v_cvt_pk_bf16_f32 v201, v201, v201
  v_lshlrev_b32 v201, 16, v201
  v_add_f32 v201, 0x3727c5ac, v201
  v_cvt_pk_bf16_f32 v201, v201, v201
  v_lshlrev_b32 v201, 16, v201
  v_sqrt_f32 v201, v201
  s_nop 0
  v_cvt_pk_bf16_f32 v201, v201, v201
  v_lshlrev_b32 v201, 16, v201
  v_rcp_f32 v205, v201
  v_cvt_pk_bf16_f32 v204, 0, v200
  v_sub_f32 v204, 0, v204
  s_and_b32 s49, s42, 1
  s_lshl_b32 s49, s49, 8
  s_add_u32 s49, s49, 158720
  v_and_b32 v206, 31, v1
  v_lshlrev_b32 v206, 3, v206
  v_add_u32 v206, s49, v206
  ds_write_b64 v206, v[204:205]
  s_waitcnt lgkmcnt(0)
L_NOCHK:
  s_barrier
  s_and_b32 s29, s42, 1
  s_lshl_b32 s29, s29, 8
  s_add_u32 s29, s29, 158720
  v_and_b32 v200, 31, v1
  v_lshlrev_b32 v200, 3, v200
  v_add_u32 v200, s29, v200
  ds_read_b64 v[202:203], v200
  s_waitcnt lgkmcnt(0)
  v_pk_add_f32 v[160:161], v[160:161], v[202:203] op_sel_hi:[1,0]
  v_pk_add_f32 v[162:163], v[162:163], v[202:203] op_sel_hi:[1,0]
  v_pk_add_f32 v[164:165], v[164:165], v[202:203] op_sel_hi:[1,0]
  v_pk_add_f32 v[166:167], v[166:167], v[202:203] op_sel_hi:[1,0]
  v_pk_add_f32 v[168:169], v[168:169], v[202:203] op_sel_hi:[1,0]
  v_pk_add_f32 v[170:171], v[170:171], v[202:203] op_sel_hi:[1,0]
  v_pk_add_f32 v[172:173], v[172:173], v[202:203] op_sel_hi:[1,0]
  v_pk_add_f32 v[174:175], v[174:175], v[202:203] op_sel_hi:[1,0]
  v_cvt_pk_bf16_f32 v160, 0, v160
  v_cvt_pk_bf16_f32 v161, 0, v161
  v_cvt_pk_bf16_f32 v162, 0, v162
  v_cvt_pk_bf16_f32 v163, 0, v163
  v_cvt_pk_bf16_f32 v164, 0, v164
  v_cvt_pk_bf16_f32 v165, 0, v165
  v_cvt_pk_bf16_f32 v166, 0, v166
  v_cvt_pk_bf16_f32 v167, 0, v167
  v_cvt_pk_bf16_f32 v168, 0, v168
  v_cvt_pk_bf16_f32 v169, 0, v169
  v_cvt_pk_bf16_f32 v170, 0, v170
  v_cvt_pk_bf16_f32 v171, 0, v171
  v_cvt_pk_bf16_f32 v172, 0, v172
  v_cvt_pk_bf16_f32 v173, 0, v173
  v_cvt_pk_bf16_f32 v174, 0, v174
  v_cvt_pk_bf16_f32 v175, 0, v175
  v_pk_mul_f32 v[160:161], v[160:161], v[202:203] op_sel:[0,1]
  v_pk_mul_f32 v[162:163], v[162:163], v[202:203] op_sel:[0,1]
  v_pk_mul_f32 v[164:165], v[164:165], v[202:203] op_sel:[0,1]
  v_pk_mul_f32 v[166:167], v[166:167], v[202:203] op_sel:[0,1]
  v_pk_mul_f32 v[168:169], v[168:169], v[202:203] op_sel:[0,1]
  v_pk_mul_f32 v[170:171], v[170:171], v[202:203] op_sel:[0,1]
  v_pk_mul_f32 v[172:173], v[172:173], v[202:203] op_sel:[0,1]
  v_pk_mul_f32 v[174:175], v[174:175], v[202:203] op_sel:[0,1]
  v_cvt_pk_bf16_f32 v192, v160, v161
  v_cvt_pk_bf16_f32 v193, v162, v163
  v_cvt_pk_bf16_f32 v194, v164, v165
  v_cvt_pk_bf16_f32 v195, v166, v167
  v_cvt_pk_bf16_f32 v196, v168, v169
  v_cvt_pk_bf16_f32 v197, v170, v171
  v_cvt_pk_bf16_f32 v198, v172, v173
  v_cvt_pk_bf16_f32 v199, v174, v175
  s_lshl_b32 s29, s42, 11
  s_add_u32 s29, s29, 98304
  v_and_b32 v200, 31, v1
  v_lshlrev_b32 v200, 6, v200
  v_lshrrev_b32 v201, 5, v1
  v_lshl_add_u32 v200, v201, 3, v200
  v_add_u32 v200, s29, v200
  v_bfe_u32 v202, v1, 1, 2
  v_lshlrev_b32 v202, 4, v202
  v_xor_b32 v204, 0, v202
  v_add_u32 v204, v204, v200
  v_xor_b32 v205, 16, v202
  v_add_u32 v205, v205, v200
  v_xor_b32 v206, 32, v202
  v_add_u32 v206, v206, v200
  v_xor_b32 v207, 48, v202
  v_add_u32 v207, v207, v200
  ds_write_b64 v204, v[192:193]
  ds_write_b64 v205, v[194:195]
  ds_write_b64 v206, v[196:197]
  ds_write_b64 v207, v[198:199]
  v_bfe_u32 v202, v1, 2, 2
  v_lshl_add_u32 v201, v201, 3, v202
  v_lshlrev_b32 v201, 6, v201
  v_and_b32 v203, 1, v1
  v_lshl_add_u32 v201, v203, 3, v201
  v_add_u32 v201, s29, v201
  v_bfe_u32 v203, v1, 4, 1
  v_bfe_u32 v208, v1, 1, 1
  v_lshl_add_u32 v203, v203, 1, v208
  v_lshrrev_b32 v202, 1, v202
  v_xor_b32 v203, v203, v202
  v_lshl_add_u32 v208, v203, 4, v201
  v_xor_b32 v203, 2, v203
  v_lshl_add_u32 v209, v203, 4, v201
  ds_read_b64_tr_b16 v[228:229], v208 offset:0
  ds_read_b64_tr_b16 v[230:231], v209 offset:256
  ds_read_b64_tr_b16 v[232:233], v208 offset:1024
  ds_read_b64_tr_b16 v[234:235], v209 offset:1280
  s_add_u32 s28, s58, 32768
  s_waitcnt lgkmcnt(0)
  buffer_store_dwordx4 v[228:231], v245, s[12:15], s58 offen sc1
  buffer_store_dwordx4 v[232:235], v245, s[12:15], s28 offen sc1
  s_add_u32 m0, s48, 0
  s_add_u32 s49, s46, 917504
  buffer_load_dwordx4 v3, s[8:11], s49 offen lds
  s_add_u32 m0, s48, 8192
  s_add_u32 s49, s46, 1032192
  buffer_load_dwordx4 v3, s[8:11], s49 offen lds
L_J1:
  s_cmp_ge_u32 s42, 4
  s_cbranch_scc1 L_NOUX
  v_cvt_pk_f16_f32 v202, v176, v180
  v_cvt_pk_f16_f32 v203, v184, v188
  ds_write_b64 v200, v[202:203] offset:0
  v_cvt_pk_f16_f32 v204, v177, v181
  v_cvt_pk_f16_f32 v205, v185, v189
  ds_write_b64 v200, v[204:205] offset:16
  v_cvt_pk_f16_f32 v206, v178, v182
  v_cvt_pk_f16_f32 v207, v186, v190
  ds_write_b64 v200, v[206:207] offset:32
  v_cvt_pk_f16_f32 v208, v179, v183
  v_cvt_pk_f16_f32 v209, v187, v191
  ds_write_b64 v200, v[208:209] offset:48
  s_waitcnt lgkmcnt(0)
L_NOUX:
  s_waitcnt vmcnt(10)
  s_barrier
  v_lshrrev_b32 v212, 3, v0
  v_and_b32 v213, 7, v0
  v_mul_u32_u24 v214, 144, v212
  v_lshl_add_u32 v214, v213, 4, v214
  v_add_u32 v214, 147456, v214
  ds_read_b128 v[216:219], v214
  v_lshlrev_b32 v212, 12, v212
  v_lshl_add_u32 v212, v213, 4, v212
  ds_read_b64_tr_b16 v[128:129], v6 offset:32768
  ds_read_b64_tr_b16 v[130:131], v6 offset:33792
  ds_read_b64_tr_b16 v[132:133], v6 offset:36864
  ds_read_b64_tr_b16 v[134:135], v6 offset:37888
  ds_read_b64_tr_b16 v[136:137], v6 offset:40960
  ds_read_b64_tr_b16 v[138:139], v6 offset:41984
  ds_read_b64_tr_b16 v[140:141], v6 offset:45056
  ds_read_b64_tr_b16 v[142:143], v6 offset:46080
  s_add_u32 m0, s48, 16384
  s_add_u32 s49, s46, 1146880
  buffer_load_dwordx4 v3, s[8:11], s49 offen lds
  s_add_u32 m0, s48, 24576
  s_add_u32 s49, s46, 1261568
  buffer_load_dwordx4 v3, s[8:11], s49 offen lds
  s_waitcnt lgkmcnt(0)
  buffer_store_dwordx4 v[216:219], v212, s[12:15], s75 offen sc1
  s_waitcnt vmcnt(11)
  s_barrier
  v_mfma_f32_32x32x16_bf16 v[160:175], v[128:131], v[16:19], 0
  ds_read_b64_tr_b16 v[144:145], v6 offset:49152
  ds_read_b64_tr_b16 v[146:147], v6 offset:50176
  ds_read_b64_tr_b16 v[148:149], v6 offset:53248
  ds_read_b64_tr_b16 v[150:151], v6 offset:54272
  v_mfma_f32_32x32x16_bf16 v[160:175], v[132:135], v[20:23], v[160:175]
  ds_read_b64_tr_b16 v[152:153], v6 offset:57344
  ds_read_b64_tr_b16 v[154:155], v6 offset:58368
  ds_read_b64_tr_b16 v[156:157], v6 offset:61440
  ds_read_b64_tr_b16 v[158:159], v6 offset:62464
  v_mfma_f32_32x32x16_bf16 v[160:175], v[136:139], v[24:27], v[160:175]
  s_add_u32 m0, s48, 32768
  s_add_u32 s49, s46, 1376256
  buffer_load_dwordx4 v3, s[8:11], s49 offen lds
  s_add_u32 m0, s48, 40960
  s_add_u32 s49, s46, 1490944
  buffer_load_dwordx4 v3, s[8:11], s49 offen lds
  v_mfma_f32_32x32x16_bf16 v[160:175], v[140:143], v[28:31], v[160:175]
  s_waitcnt lgkmcnt(0)
  s_waitcnt vmcnt(7)
  s_barrier
  s_cmp_lg_u32 s42, 0
  s_cbranch_scc1 L_FZ
  v_mov_b32 v249, s63
  s_mov_b64 exec, 1
  buffer_store_dword v249, v248, s[12:15], s59 offen sc1
  s_mov_b64 exec, -1
L_FZ:
  v_mfma_f32_32x32x16_bf16 v[160:175], v[144:147], v[32:35], v[160:175]
  ds_read_b64_tr_b16 v[128:129], v7 offset:0
  ds_read_b64_tr_b16 v[130:131], v7 offset:1024
  ds_read_b64_tr_b16 v[132:133], v7 offset:4096
  ds_read_b64_tr_b16 v[134:135], v7 offset:5120
  v_mfma_f32_32x32x16_bf16 v[160:175], v[148:151], v[36:39], v[160:175]
  ds_read_b64_tr_b16 v[136:137], v7 offset:8192
  ds_read_b64_tr_b16 v[138:139], v7 offset:9216
  ds_read_b64_tr_b16 v[140:141], v7 offset:12288
  ds_read_b64_tr_b16 v[142:143], v7 offset:13312
  v_mfma_f32_32x32x16_bf16 v[160:175], v[152:155], v[40:43], v[160:175]
  s_add_u32 m0, s48, 114688
  s_add_u32 s49, s87, 0
  buffer_load_dwordx4 v244, s[24:27], s49 offen lds
  s_add_u32 m0, s48, 139264
  s_add_u32 s49, s87, 128
  buffer_load_dwordx4 v244, s[24:27], s49 offen lds
  v_mfma_f32_32x32x16_bf16 v[160:175], v[156:159], v[44:47], v[160:175]
  s_waitcnt lgkmcnt(0)
  s_waitcnt vmcnt(4)
  s_barrier
  s_cmp_lg_u32 s42, 0
  s_cbranch_scc1 L_FU
  v_mov_b32 v249, s63
  s_mov_b64 exec, 1
  buffer_store_dword v249, v248, s[12:15], s60 offen sc1
  s_mov_b64 exec, -1
L_FU:
  v_mfma_f32_32x32x16_bf16 v[160:175], v[128:131], v[48:51], v[160:175]
  ds_read_b64_tr_b16 v[144:145], v7 offset:16384
  ds_read_b64_tr_b16 v[146:147], v7 offset:17408
  ds_read_b64_tr_b16 v[148:149], v7 offset:20480
  ds_read_b64_tr_b16 v[150:151], v7 offset:21504
  v_mfma_f32_32x32x16_bf16 v[160:175], v[132:135], v[52:55], v[160:175]
  ds_read_b64_tr_b16 v[152:153], v7 offset:24576
  ds_read_b64_tr_b16 v[154:155], v7 offset:25600
  ds_read_b64_tr_b16 v[156:157], v7 offset:28672
  ds_read_b64_tr_b16 v[158:159], v7 offset:29696
  v_mfma_f32_32x32x16_bf16 v[160:175], v[136:139], v[56:59], v[160:175]
  s_add_u32 m0, s48, 65536
  s_add_u32 s49, s87, 256
  buffer_load_dwordx4 v244, s[24:27], s49 offen lds
  v_mfma_f32_32x32x16_bf16 v[160:175], v[140:143], v[60:63], v[160:175]
  s_waitcnt lgkmcnt(0)
  s_waitcnt vmcnt(8)
  s_barrier
  v_mfma_f32_32x32x16_bf16 v[160:175], v[144:147], v[64:67], v[160:175]
  ds_read_b64_tr_b16 v[128:129], v6 offset:0
  ds_read_b64_tr_b16 v[130:131], v6 offset:1024
  ds_read_b64_tr_b16 v[132:133], v6 offset:4096
  ds_read_b64_tr_b16 v[134:135], v6 offset:5120
  v_mfma_f32_32x32x16_bf16 v[160:175], v[148:151], v[68:71], v[160:175]
  ds_read_b64_tr_b16 v[136:137], v6 offset:8192
  ds_read_b64_tr_b16 v[138:139], v6 offset:9216
  ds_read_b64_tr_b16 v[140:141], v6 offset:12288
  ds_read_b64_tr_b16 v[142:143], v6 offset:13312
  v_mfma_f32_32x32x16_bf16 v[160:175], v[152:155], v[72:75], v[160:175]
  s_add_u32 m0, s48, 90112
  s_add_u32 s49, s87, 384
  buffer_load_dwordx4 v244, s[24:27], s49 offen lds
  v_mfma_f32_32x32x16_bf16 v[160:175], v[156:159], v[76:79], v[160:175]
  s_waitcnt lgkmcnt(0)
  s_waitcnt vmcnt(7)
  s_barrier
  v_mfma_f32_32x32x16_bf16 v[160:175], v[128:131], v[80:83], v[160:175]
  ds_read_b64_tr_b16 v[144:145], v6 offset:16384
  ds_read_b64_tr_b16 v[146:147], v6 offset:17408
  ds_read_b64_tr_b16 v[148:149], v6 offset:20480
  ds_read_b64_tr_b16 v[150:151], v6 offset:21504
  v_mfma_f32_32x32x16_bf16 v[160:175], v[132:135], v[84:87], v[160:175]
  ds_read_b64_tr_b16 v[152:153], v6 offset:24576
  ds_read_b64_tr_b16 v[154:155], v6 offset:25600
  ds_read_b64_tr_b16 v[156:157], v6 offset:28672
  ds_read_b64_tr_b16 v[158:159], v6 offset:29696
  v_mfma_f32_32x32x16_bf16 v[160:175], v[136:139], v[88:91], v[160:175]
  v_mfma_f32_32x32x16_bf16 v[160:175], v[140:143], v[92:95], v[160:175]
  s_waitcnt lgkmcnt(0)
  s_waitcnt vmcnt(4)
  s_barrier
  v_mfma_f32_32x32x16_bf16 v[160:175], v[144:147], v[96:99], v[160:175]
  ds_read_b64_tr_b16 v[128:129], v6 offset:32768
  ds_read_b64_tr_b16 v[130:131], v6 offset:33792
  ds_read_b64_tr_b16 v[132:133], v6 offset:36864
  ds_read_b64_tr_b16 v[134:135], v6 offset:37888
  v_mfma_f32_32x32x16_bf16 v[160:175], v[148:151], v[100:103], v[160:175]
  ds_read_b64_tr_b16 v[136:137], v6 offset:40960
  ds_read_b64_tr_b16 v[138:139], v6 offset:41984
  ds_read_b64_tr_b16 v[140:141], v6 offset:45056
  ds_read_b64_tr_b16 v[142:143], v6 offset:46080
  v_mfma_f32_32x32x16_bf16 v[160:175], v[152:155], v[104:107], v[160:175]
  s_add_u32 m0, s48, 16384
  s_add_u32 s49, s87, 512
  buffer_load_dwordx4 v244, s[24:27], s49 offen lds
  v_mfma_f32_32x32x16_bf16 v[160:175], v[156:159], v[108:111], v[160:175]
  s_waitcnt lgkmcnt(0)
  v_mfma_f32_32x32x16_bf16 v[160:175], v[128:131], v[112:115], v[160:175]
  v_mfma_f32_32x32x16_bf16 v[160:175], v[132:135], v[116:119], v[160:175]
  v_mfma_f32_32x32x16_bf16 v[160:175], v[136:139], v[120:123], v[160:175]
  v_mfma_f32_32x32x16_bf16 v[160:175], v[140:143], v[124:127], v[160:175]
  s_cmp_eq_u32 s42, 0
  s_cbranch_scc1 L_G0
  s_nop 9
  v_cvt_pk_bf16_f32 v160, 0, v160
  v_cvt_pk_bf16_f32 v161, 0, v161
  v_cvt_pk_bf16_f32 v162, 0, v162
  v_cvt_pk_bf16_f32 v163, 0, v163
  v_cvt_pk_bf16_f32 v164, 0, v164
  v_cvt_pk_bf16_f32 v165, 0, v165
  v_cvt_pk_bf16_f32 v166, 0, v166
  v_cvt_pk_bf16_f32 v167, 0, v167
  v_cvt_pk_bf16_f32 v168, 0, v168
  v_cvt_pk_bf16_f32 v169, 0, v169
  v_cvt_pk_bf16_f32 v170, 0, v170
  v_cvt_pk_bf16_f32 v171, 0, v171
  v_cvt_pk_bf16_f32 v172, 0, v172
  v_cvt_pk_bf16_f32 v173, 0, v173
  v_cvt_pk_bf16_f32 v174, 0, v174
  v_cvt_pk_bf16_f32 v175, 0, v175
  v_pk_mul_f32 v[200:201], v[160:161], v[160:161]
  v_pk_mul_f32 v[202:203], v[162:163], v[162:163]
  v_pk_mul_f32 v[204:205], v[164:165], v[164:165]
  v_pk_mul_f32 v[206:207], v[166:167], v[166:167]
  v_pk_mul_f32 v[208:209], v[168:169], v[168:169]
  v_pk_mul_f32 v[210:211], v[170:171], v[170:171]
  v_pk_mul_f32 v[212:213], v[172:173], v[172:173]
  v_pk_mul_f32 v[214:215], v[174:175], v[174:175]
  v_pk_fma_f32 v[200:201], v[200:201], s[52:53], v[226:227]
  v_pk_fma_f32 v[202:203], v[202:203], s[52:53], v[226:227]
  v_pk_fma_f32 v[204:205], v[204:205], s[52:53], v[226:227]
  v_pk_fma_f32 v[206:207], v[206:207], s[52:53], v[226:227]
  v_pk_fma_f32 v[208:209], v[208:209], s[52:53], v[226:227]
  v_pk_fma_f32 v[210:211], v[210:211], s[52:53], v[226:227]
  v_pk_fma_f32 v[212:213], v[212:213], s[52:53], v[226:227]
  v_pk_fma_f32 v[214:215], v[214:215], s[52:53], v[226:227]
  v_pk_mul_f32 v[200:201], v[200:201], v[160:161]
  v_pk_mul_f32 v[202:203], v[202:203], v[162:163]
  v_pk_mul_f32 v[204:205], v[204:205], v[164:165]
  v_pk_mul_f32 v[206:207], v[206:207], v[166:167]
  v_pk_mul_f32 v[208:209], v[208:209], v[168:169]
  v_pk_mul_f32 v[210:211], v[210:211], v[170:171]
  v_pk_mul_f32 v[212:213], v[212:213], v[172:173]
  v_pk_mul_f32 v[214:215], v[214:215], v[174:175]
  v_exp_f32 v200, v200
  v_exp_f32 v201, v201
  v_exp_f32 v202, v202
  v_exp_f32 v203, v203
  v_exp_f32 v204, v204
  v_exp_f32 v205, v205
  v_exp_f32 v206, v206
  v_exp_f32 v207, v207
  v_exp_f32 v208, v208
  v_exp_f32 v209, v209
  v_exp_f32 v210, v210
  v_exp_f32 v211, v211
  v_exp_f32 v212, v212
  v_exp_f32 v213, v213
  v_exp_f32 v214, v214
  v_exp_f32 v215, v215
  v_pk_add_f32 v[200:201], v[200:201], 1.0 op_sel_hi:[1,0]
  v_pk_add_f32 v[202:203], v[202:203], 1.0 op_sel_hi:[1,0]
  v_pk_add_f32 v[204:205], v[204:205], 1.0 op_sel_hi:[1,0]
  v_pk_add_f32 v[206:207], v[206:207], 1.0 op_sel_hi:[1,0]
  v_pk_add_f32 v[208:209], v[208:209], 1.0 op_sel_hi:[1,0]
  v_pk_add_f32 v[210:211], v[210:211], 1.0 op_sel_hi:[1,0]
  v_pk_add_f32 v[212:213], v[212:213], 1.0 op_sel_hi:[1,0]
  v_pk_add_f32 v[214:215], v[214:215], 1.0 op_sel_hi:[1,0]
  v_rcp_f32 v200, v200
  v_rcp_f32 v201, v201
  v_rcp_f32 v202, v202
  v_rcp_f32 v203, v203
  v_rcp_f32 v204, v204
  v_rcp_f32 v205, v205
  v_rcp_f32 v206, v206
  v_rcp_f32 v207, v207
  v_rcp_f32 v208, v208
  v_rcp_f32 v209, v209
  v_rcp_f32 v210, v210
  v_rcp_f32 v211, v211
  v_rcp_f32 v212, v212
  v_rcp_f32 v213, v213
  v_rcp_f32 v214, v214
  v_rcp_f32 v215, v215
  v_pk_mul_f32 v[200:201], v[200:201], v[160:161]
  v_pk_mul_f32 v[202:203], v[202:203], v[162:163]
  v_pk_mul_f32 v[204:205], v[204:205], v[164:165]
  v_pk_mul_f32 v[206:207], v[206:207], v[166:167]
  v_pk_mul_f32 v[208:209], v[208:209], v[168:169]
  v_pk_mul_f32 v[210:211], v[210:211], v[170:171]
  v_pk_mul_f32 v[212:213], v[212:213], v[172:173]
  v_pk_mul_f32 v[214:215], v[214:215], v[174:175]
  v_cvt_pk_bf16_f32 v124, 0, v200
  v_cvt_pk_bf16_f32 v125, 0, v201
  v_cvt_pk_bf16_f32 v126, 0, v202
  v_cvt_pk_bf16_f32 v127, 0, v203
  v_cvt_pk_bf16_f32 v128, 0, v204
  v_cvt_pk_bf16_f32 v129, 0, v205
  v_cvt_pk_bf16_f32 v130, 0, v206
  v_cvt_pk_bf16_f32 v131, 0, v207
  v_cvt_pk_bf16_f32 v132, 0, v208
  v_cvt_pk_bf16_f32 v133, 0, v209
  v_cvt_pk_bf16_f32 v134, 0, v210
  v_cvt_pk_bf16_f32 v135, 0, v211
  v_cvt_pk_bf16_f32 v136, 0, v212
  v_cvt_pk_bf16_f32 v137, 0, v213
  v_cvt_pk_bf16_f32 v138, 0, v214
  v_cvt_pk_bf16_f32 v139, 0, v215
  s_lshr_b32 s46, s42, 1
  s_lshl_b32 s46, s46, 10
  v_add_u32 v84, s46, v4
  v_add_u32 v85, 49152, v84
  v_add_u32 v86, 98304, v84
  v_and_b32 v100, 31, v1
  s_and_b32 s46, s42, 1
  s_lshl_b32 s46, s46, 5
  v_add_u32 v100, s46, v100
  v_bfe_u32 v101, v100, 1, 3
  v_lshrrev_b32 v102, 5, v1
  v_xor_b32 v101, v101, v102
  v_lshlrev_b32 v100, 7, v100
  v_add_u32 v100, 16384, v100
  v_xor_b32 v102, 0, v101
  v_lshl_add_u32 v140, v102, 4, v100
  v_add_u32 v144, 49152, v140
  v_add_u32 v148, 98304, v140
  v_xor_b32 v102, 2, v101
  v_lshl_add_u32 v141, v102, 4, v100
  v_add_u32 v145, 49152, v141
  v_add_u32 v149, 98304, v141
  v_xor_b32 v102, 4, v101
  v_lshl_add_u32 v142, v102, 4, v100
  v_add_u32 v146, 49152, v142
  v_add_u32 v150, 98304, v142
  v_xor_b32 v102, 6, v101
  v_lshl_add_u32 v143, v102, 4, v100
  v_add_u32 v147, 49152, v143
  v_add_u32 v151, 98304, v143
L_G0:
  s_cmp_lg_u32 s42, 0
  s_cbranch_scc1 L_CZ_OK
  s_mov_b32 s50, 0
  buffer_load_dword v240, v250, s[12:15], s89 offen sc1
  s_sleep 2
  buffer_load_dword v241, v250, s[12:15], s89 offen sc1
  s_sleep 2
  buffer_load_dword v242, v250, s[12:15], s89 offen sc1
  s_sleep 2
  buffer_load_dword v243, v250, s[12:15], s89 offen sc1
L_CZ:
  s_waitcnt vmcnt(3)
  v_cmp_eq_u32 vcc, s63, v240
  s_nop 0
  s_cmp_eq_u64 vcc, exec
  s_cbranch_scc1 L_CZ_OK
  buffer_load_dword v240, v250, s[12:15], s89 offen sc1
  s_sleep 1
  s_waitcnt vmcnt(3)
  v_cmp_eq_u32 vcc, s63, v241
  s_nop 0
  s_cmp_eq_u64 vcc, exec
  s_cbranch_scc1 L_CZ_OK
  buffer_load_dword v241, v250, s[12:15], s89 offen sc1
  s_sleep 1
  s_waitcnt vmcnt(3)
  v_cmp_eq_u32 vcc, s63, v242
  s_nop 0
  s_cmp_eq_u64 vcc, exec
  s_cbranch_scc1 L_CZ_OK
  buffer_load_dword v242, v250, s[12:15], s89 offen sc1
  s_sleep 1
  s_waitcnt vmcnt(3)
  v_cmp_eq_u32 vcc, s63, v243
  s_nop 0
  s_cmp_eq_u64 vcc, exec
  s_cbranch_scc1 L_CZ_OK
  buffer_load_dword v243, v250, s[12:15], s89 offen sc1
  s_sleep 1
  s_add_u32 s50, s50, 1
  s_cmp_lt_u32 s50, 16384
  s_cbranch_scc1 L_CZ
L_CZ_OK:
  s_barrier
  s_add_u32 m0, s48, 98304
  s_add_u32 s49, s88, 0
  buffer_load_dwordx4 v4, s[12:15], s49 offen sc1 lds
  s_add_u32 m0, s48, 106496
  s_add_u32 s49, s88, 8192
  buffer_load_dwordx4 v4, s[12:15], s49 offen sc1 lds
  s_add_u32 m0, s48, 122880
  s_add_u32 s49, s88, 16384
  buffer_load_dwordx4 v4, s[12:15], s49 offen sc1 lds
  s_add_u32 m0, s48, 131072
  s_add_u32 s49, s88, 24576
  buffer_load_dwordx4 v4, s[12:15], s49 offen sc1 lds
  s_add_u32 m0, s48, 49152
  s_add_u32 s49, s88, 32768
  buffer_load_dwordx4 v4, s[12:15], s49 offen sc1 lds
  s_add_u32 m0, s48, 57344
  s_add_u32 s49, s88, 40960
  buffer_load_dwordx4 v4, s[12:15], s49 offen sc1 lds
  s_add_u32 m0, s48, 73728
  s_add_u32 s49, s88, 49152
  buffer_load_dwordx4 v4, s[12:15], s49 offen sc1 lds
  s_add_u32 m0, s48, 81920
  s_add_u32 s49, s88, 57344
  buffer_load_dwordx4 v4, s[12:15], s49 offen sc1 lds
  s_add_u32 m0, s48, 0
  s_add_u32 s49, s88, 65536
  buffer_load_dwordx4 v4, s[12:15], s49 offen sc1 lds
  s_add_u32 m0, s48, 8192
  s_add_u32 s49, s88, 73728
  buffer_load_dwordx4 v4, s[12:15], s49 offen sc1 lds
  s_cmp_lg_u32 s42, 0
  s_cbranch_scc1 L_G1
  v_cvt_pk_bf16_f32 v160, 0, v160
  v_cvt_pk_bf16_f32 v161, 0, v161
  v_cvt_pk_bf16_f32 v162, 0, v162
  v_cvt_pk_bf16_f32 v163, 0, v163
  v_cvt_pk_bf16_f32 v164, 0, v164
  v_cvt_pk_bf16_f32 v165, 0, v165
  v_cvt_pk_bf16_f32 v166, 0, v166
  v_cvt_pk_bf16_f32 v167, 0, v167
  v_cvt_pk_bf16_f32 v168, 0, v168
  v_cvt_pk_bf16_f32 v169, 0, v169
  v_cvt_pk_bf16_f32 v170, 0, v170
  v_cvt_pk_bf16_f32 v171, 0, v171
  v_cvt_pk_bf16_f32 v172, 0, v172
  v_cvt_pk_bf16_f32 v173, 0, v173
  v_cvt_pk_bf16_f32 v174, 0, v174
  v_cvt_pk_bf16_f32 v175, 0, v175
  v_pk_mul_f32 v[200:201], v[160:161], v[160:161]
  v_pk_mul_f32 v[202:203], v[162:163], v[162:163]
  v_pk_mul_f32 v[204:205], v[164:165], v[164:165]
  v_pk_mul_f32 v[206:207], v[166:167], v[166:167]
  v_pk_mul_f32 v[208:209], v[168:169], v[168:169]
  v_pk_mul_f32 v[210:211], v[170:171], v[170:171]
  v_pk_mul_f32 v[212:213], v[172:173], v[172:173]
  v_pk_mul_f32 v[214:215], v[174:175], v[174:175]
  v_pk_fma_f32 v[200:201], v[200:201], s[52:53], v[226:227]
  v_pk_fma_f32 v[202:203], v[202:203], s[52:53], v[226:227]
  v_pk_fma_f32 v[204:205], v[204:205], s[52:53], v[226:227]
  v_pk_fma_f32 v[206:207], v[206:207], s[52:53], v[226:227]
  v_pk_fma_f32 v[208:209], v[208:209], s[52:53], v[226:227]
  v_pk_fma_f32 v[210:211], v[210:211], s[52:53], v[226:227]
  v_pk_fma_f32 v[212:213], v[212:213], s[52:53], v[226:227]
  v_pk_fma_f32 v[214:215], v[214:215], s[52:53], v[226:227]
  v_pk_mul_f32 v[200:201], v[200:201], v[160:161]
  v_pk_mul_f32 v[202:203], v[202:203], v[162:163]
  v_pk_mul_f32 v[204:205], v[204:205], v[164:165]
  v_pk_mul_f32 v[206:207], v[206:207], v[166:167]
  v_pk_mul_f32 v[208:209], v[208:209], v[168:169]
  v_pk_mul_f32 v[210:211], v[210:211], v[170:171]
  v_pk_mul_f32 v[212:213], v[212:213], v[172:173]
  v_pk_mul_f32 v[214:215], v[214:215], v[174:175]
  v_exp_f32 v200, v200
  v_exp_f32 v201, v201
  v_exp_f32 v202, v202
  v_exp_f32 v203, v203
  v_exp_f32 v204, v204
  v_exp_f32 v205, v205
  v_exp_f32 v206, v206
  v_exp_f32 v207, v207
  v_exp_f32 v208, v208
  v_exp_f32 v209, v209
  v_exp_f32 v210, v210
  v_exp_f32 v211, v211
  v_exp_f32 v212, v212
  v_exp_f32 v213, v213
  v_exp_f32 v214, v214
  v_exp_f32 v215, v215
  v_pk_add_f32 v[200:201], v[200:201], 1.0 op_sel_hi:[1,0]
  v_pk_add_f32 v[202:203], v[202:203], 1.0 op_sel_hi:[1,0]
  v_pk_add_f32 v[204:205], v[204:205], 1.0 op_sel_hi:[1,0]
  v_pk_add_f32 v[206:207], v[206:207], 1.0 op_sel_hi:[1,0]
  v_pk_add_f32 v[208:209], v[208:209], 1.0 op_sel_hi:[1,0]
  v_pk_add_f32 v[210:211], v[210:211], 1.0 op_sel_hi:[1,0]
  v_pk_add_f32 v[212:213], v[212:213], 1.0 op_sel_hi:[1,0]
  v_pk_add_f32 v[214:215], v[214:215], 1.0 op_sel_hi:[1,0]
  v_rcp_f32 v200, v200
  v_rcp_f32 v201, v201
  v_rcp_f32 v202, v202
  v_rcp_f32 v203, v203
  v_rcp_f32 v204, v204
  v_rcp_f32 v205, v205
  v_rcp_f32 v206, v206
  v_rcp_f32 v207, v207
  v_rcp_f32 v208, v208
  v_rcp_f32 v209, v209
  v_rcp_f32 v210, v210
  v_rcp_f32 v211, v211
  v_rcp_f32 v212, v212
  v_rcp_f32 v213, v213
  v_rcp_f32 v214, v214
  v_rcp_f32 v215, v215
  v_pk_mul_f32 v[200:201], v[200:201], v[160:161]
  v_pk_mul_f32 v[202:203], v[202:203], v[162:163]
  v_pk_mul_f32 v[204:205], v[204:205], v[164:165]
  v_pk_mul_f32 v[206:207], v[206:207], v[166:167]
  v_pk_mul_f32 v[208:209], v[208:209], v[168:169]
  v_pk_mul_f32 v[210:211], v[210:211], v[170:171]
  v_pk_mul_f32 v[212:213], v[212:213], v[172:173]
  v_pk_mul_f32 v[214:215], v[214:215], v[174:175]
  v_cvt_pk_bf16_f32 v124, 0, v200
  v_cvt_pk_bf16_f32 v125, 0, v201
  v_cvt_pk_bf16_f32 v126, 0, v202
  v_cvt_pk_bf16_f32 v127, 0, v203
  v_cvt_pk_bf16_f32 v128, 0, v204
  v_cvt_pk_bf16_f32 v129, 0, v205
  v_cvt_pk_bf16_f32 v130, 0, v206
  v_cvt_pk_bf16_f32 v131, 0, v207
  v_cvt_pk_bf16_f32 v132, 0, v208
  v_cvt_pk_bf16_f32 v133, 0, v209
  v_cvt_pk_bf16_f32 v134, 0, v210
  v_cvt_pk_bf16_f32 v135, 0, v211
  v_cvt_pk_bf16_f32 v136, 0, v212
  v_cvt_pk_bf16_f32 v137, 0, v213
  v_cvt_pk_bf16_f32 v138, 0, v214
  v_cvt_pk_bf16_f32 v139, 0, v215
  s_lshr_b32 s46, s42, 1
  s_lshl_b32 s46, s46, 10
  v_add_u32 v84, s46, v4
  v_add_u32 v85, 49152, v84
  v_add_u32 v86, 98304, v84
  v_and_b32 v100, 31, v1
  s_and_b32 s46, s42, 1
  s_lshl_b32 s46, s46, 5
  v_add_u32 v100, s46, v100
  v_bfe_u32 v101, v100, 1, 3
  v_lshrrev_b32 v102, 5, v1
  v_xor_b32 v101, v101, v102
  v_lshlrev_b32 v100, 7, v100
  v_add_u32 v100, 16384, v100
  v_xor_b32 v102, 0, v101
  v_lshl_add_u32 v140, v102, 4, v100
  v_add_u32 v144, 49152, v140
  v_add_u32 v148, 98304, v140
  v_xor_b32 v102, 2, v101
  v_lshl_add_u32 v141, v102, 4, v100
  v_add_u32 v145, 49152, v141
  v_add_u32 v149, 98304, v141
  v_xor_b32 v102, 4, v101
  v_lshl_add_u32 v142, v102, 4, v100
  v_add_u32 v146, 49152, v142
  v_add_u32 v150, 98304, v142
  v_xor_b32 v102, 6, v101
  v_lshl_add_u32 v143, v102, 4, v100
  v_add_u32 v147, 49152, v143
  v_add_u32 v151, 98304, v143
L_G1:
  s_waitcnt vmcnt(8)
  s_barrier
  ds_read_b128 v[20:23], v86 offset:0
  ds_read_b128 v[24:27], v148 offset:0
  ds_read_b128 v[28:31], v86 offset:4096
  ds_read_b128 v[32:35], v149 offset:0
  ds_read_b128 v[36:39], v86 offset:8192
  ds_read_b128 v[40:43], v150 offset:0
  ds_read_b128 v[44:47], v86 offset:12288
  ds_read_b128 v[48:51], v151 offset:0
  s_add_u32 m0, s48, 40960
  s_add_u32 s49, s87, 640
  buffer_load_dwordx4 v244, s[24:27], s49 offen lds
  s_add_u32 m0, s48, 24576
  s_add_u32 s49, s88, 81920
  buffer_load_dwordx4 v4, s[12:15], s49 offen sc1 lds
  s_add_u32 m0, s48, 32768
  s_add_u32 s49, s88, 90112
  buffer_load_dwordx4 v4, s[12:15], s49 offen sc1 lds
  s_waitcnt lgkmcnt(0)
  s_waitcnt vmcnt(9)
  s_barrier
  v_mfma_f32_32x32x16_bf16 v[104:119], v[20:23], v[24:27], 0
  ds_read_b128 v[52:55], v86 offset:24576
  ds_read_b128 v[56:59], v148 offset:24576
  ds_read_b128 v[60:63], v86 offset:28672
  ds_read_b128 v[64:67], v149 offset:24576
  v_mfma_f32_32x32x16_bf16 v[104:119], v[28:31], v[32:35], v[104:119]
  ds_read_b128 v[68:71], v86 offset:32768
  ds_read_b128 v[72:75], v150 offset:24576
  ds_read_b128 v[76:79], v86 offset:36864
  ds_read_b128 v[80:83], v151 offset:24576
  v_mfma_f32_32x32x16_bf16 v[104:119], v[36:39], v[40:43], v[104:119]
  s_add_u32 m0, s48, 114688
  s_add_u32 s49, s87, 768
  buffer_load_dwordx4 v244, s[24:27], s49 offen lds
  s_add_u32 m0, s48, 98304
  s_add_u32 s49, s88, 98304
  buffer_load_dwordx4 v4, s[12:15], s49 offen sc1 lds
  s_add_u32 m0, s48, 106496
  s_add_u32 s49, s88, 106496
  buffer_load_dwordx4 v4, s[12:15], s49 offen sc1 lds
  v_mfma_f32_32x32x16_bf16 v[104:119], v[44:47], v[48:51], v[104:119]
  s_waitcnt lgkmcnt(0)
  s_waitcnt vmcnt(10)
  s_barrier
  v_mfma_f32_32x32x16_bf16 v[104:119], v[52:55], v[56:59], v[104:119]
  ds_read_b128 v[20:23], v85 offset:0
  ds_read_b128 v[24:27], v144 offset:0
  ds_read_b128 v[28:31], v85 offset:4096
  ds_read_b128 v[32:35], v145 offset:0
  s_mov_b32 s8, s82
  s_and_b32 s9, s83, 0xffff
  s_mov_b32 s10, 802816
  v_mfma_f32_32x32x16_bf16 v[104:119], v[60:63], v[64:67], v[104:119]
  ds_read_b128 v[36:39], v85 offset:8192
  ds_read_b128 v[40:43], v146 offset:0
  ds_read_b128 v[44:47], v85 offset:12288
  ds_read_b128 v[48:51], v147 offset:0
  s_mov_b32 s11, 0x20000
  s_lshl_b32 s51, s40, 2
  s_and_b32 s52, s41, 3
  v_mfma_f32_32x32x16_bf16 v[104:119], v[68:71], v[72:75], v[104:119]
  s_add_u32 m0, s48, 139264
  s_add_u32 s49, s87, 896
  buffer_load_dwordx4 v244, s[24:27], s49 offen lds
  s_add_u32 m0, s48, 122880
  s_add_u32 s49, s88, 114688
  buffer_load_dwordx4 v4, s[12:15], s49 offen sc1 lds
  s_add_u32 m0, s48, 131072
  s_add_u32 s49, s88, 122880
  buffer_load_dwordx4 v4, s[12:15], s49 offen sc1 lds
  s_add_u32 s51, s51, s52
  s_lshr_b32 s52, s41, 2
  s_lshr_b32 s53, s51, 4
  v_mfma_f32_32x32x16_bf16 v[104:119], v[76:79], v[80:83], v[104:119]
  s_lshl_b32 s53, s53, 4
  s_bfe_u32 s54, s51, 0x10003
  s_lshl_b32 s54, s54, 2
  s_waitcnt lgkmcnt(0)
  s_waitcnt vmcnt(11)
  s_barrier
  v_mfma_f32_32x32x16_bf16 v[104:119], v[20:23], v[24:27], v[104:119]
  ds_read_b128 v[52:55], v85 offset:24576
  ds_read_b128 v[56:59], v144 offset:24576
  ds_read_b128 v[60:63], v85 offset:28672
  ds_read_b128 v[64:67], v145 offset:24576
  s_add_u32 s53, s53, s54
  v_lshrrev_b32 v100, 3, v1
  v_and_b32 v101, 7, v1
  v_mfma_f32_32x32x16_bf16 v[104:119], v[28:31], v[32:35], v[104:119]
  ds_read_b128 v[68:71], v85 offset:32768
  ds_read_b128 v[72:75], v146 offset:24576
  ds_read_b128 v[76:79], v85 offset:36864
  ds_read_b128 v[80:83], v147 offset:24576
  v_bfe_u32 v102, v1, 4, 1
  v_lshlrev_b32 v102, 2, v102
  v_xor_b32 v102, v101, v102
  v_mfma_f32_32x32x16_bf16 v[104:119], v[36:39], v[40:43], v[104:119]
  s_add_u32 m0, s48, 65536
  s_add_u32 s49, s87, 1024
  buffer_load_dwordx4 v244, s[24:27], s49 offen lds
  s_add_u32 m0, s48, 49152
  s_add_u32 s49, s88, 131072
  buffer_load_dwordx4 v4, s[12:15], s49 offen sc1 lds
  s_add_u32 m0, s48, 57344
  s_add_u32 s49, s88, 139264
  buffer_load_dwordx4 v4, s[12:15], s49 offen sc1 lds
  v_mul_u32_u24 v152, 896, v100
  v_lshl_add_u32 v154, v101, 4, v152
  v_lshl_add_u32 v152, v102, 4, v152
  v_mfma_f32_32x32x16_bf16 v[104:119], v[44:47], v[48:51], v[104:119]
  s_lshl_b32 s54, s51, 1
  s_lshr_b32 s55, s42, 2
  s_add_u32 s54, s54, s55
  s_waitcnt lgkmcnt(0)
  s_waitcnt vmcnt(12)
  s_barrier
  v_mfma_f32_32x32x16_bf16 v[104:119], v[52:55], v[56:59], v[104:119]
  ds_read_b128 v[20:23], v84 offset:0
  ds_read_b128 v[24:27], v140 offset:0
  ds_read_b128 v[28:31], v84 offset:4096
  ds_read_b128 v[32:35], v141 offset:0
  s_mul_i32 s54, s54, 56
  s_and_b32 s55, s42, 3
  s_add_u32 s54, s54, s55
  v_mfma_f32_32x32x16_bf16 v[104:119], v[60:63], v[64:67], v[104:119]
  ds_read_b128 v[36:39], v84 offset:8192
  ds_read_b128 v[40:43], v142 offset:0
  ds_read_b128 v[44:47], v84 offset:12288
  ds_read_b128 v[48:51], v143 offset:0
  s_lshl_b32 s54, s54, 10
  s_add_u32 s54, s54, 12582912
  s_mul_i32 s55, s42, 7168
  v_mfma_f32_32x32x16_bf16 v[104:119], v[68:71], v[72:75], v[104:119]
  s_add_u32 m0, s48, 90112
  s_add_u32 s49, s87, 1152
  buffer_load_dwordx4 v244, s[24:27], s49 offen lds
  s_add_u32 m0, s48, 73728
  s_add_u32 s49, s88, 147456
  buffer_load_dwordx4 v4, s[12:15], s49 offen sc1 lds
  s_add_u32 m0, s48, 81920
  s_add_u32 s49, s88, 155648
  buffer_load_dwordx4 v4, s[12:15], s49 offen sc1 lds
  s_lshl_b32 s56, s52, 7
  s_add_u32 s55, s55, s56
  s_mul_i32 s56, s51, 57344
  v_mfma_f32_32x32x16_bf16 v[104:119], v[76:79], v[80:83], v[104:119]
  s_add_u32 s56, s56, s48
  s_add_u32 s56, s56, 16777216
  s_mul_i32 s57, s52, 56
  s_waitcnt lgkmcnt(0)
  s_waitcnt vmcnt(12)
  s_barrier
  v_mfma_f32_32x32x16_bf16 v[104:119], v[20:23], v[24:27], v[104:119]
  ds_read_b128 v[52:55], v84 offset:24576
  ds_read_b128 v[56:59], v140 offset:24576
  ds_read_b128 v[60:63], v84 offset:28672
  ds_read_b128 v[64:67], v141 offset:24576
  s_add_u32 s57, s57, s42
  s_lshl_b32 s57, s57, 10
  s_lshr_b32 s58, s42, 2
  v_mfma_f32_32x32x16_bf16 v[104:119], v[28:31], v[32:35], v[104:119]
  ds_read_b128 v[68:71], v84 offset:32768
  ds_read_b128 v[72:75], v142 offset:24576
  ds_read_b128 v[76:79], v84 offset:36864
  ds_read_b128 v[80:83], v143 offset:24576
  s_lshl_b32 s58, s58, 3
  s_add_u32 s58, s58, s53
  s_and_b32 s59, s42, 3
  v_mfma_f32_32x32x16_bf16 v[104:119], v[36:39], v[40:43], v[104:119]
  s_add_u32 m0, s48, 16384
  s_add_u32 s49, s87, 1280
  buffer_load_dwordx4 v244, s[24:27], s49 offen lds
  s_add_u32 m0, s48, 0
  s_add_u32 s49, s88, 163840
  buffer_load_dwordx4 v4, s[12:15], s49 offen sc1 lds
  s_add_u32 m0, s48, 8192
  s_add_u32 s49, s88, 172032
  buffer_load_dwordx4 v4, s[12:15], s49 offen sc1 lds
  s_add_u32 s58, s58, s59
  s_lshl_b32 s58, s58, 6
  s_and_b32 s59, s51, 7
  v_mfma_f32_32x32x16_bf16 v[104:119], v[44:47], v[48:51], v[104:119]
  s_lshl_b32 s59, s59, 3
  s_add_u32 s58, s58, s59
  s_mul_i32 s58, s58, 896
  s_waitcnt lgkmcnt(0)
  s_waitcnt vmcnt(12)
  s_barrier
  v_mfma_f32_32x32x16_bf16 v[104:119], v[52:55], v[56:59], v[104:119]
  ds_read_b128 v[20:23], v86 offset:0
  ds_read_b128 v[24:27], v148 offset:0
  ds_read_b128 v[28:31], v86 offset:4096
  ds_read_b128 v[32:35], v149 offset:0
  s_lshl_b32 s59, s52, 7
  s_add_u32 s58, s58, s59
  s_lshl_b32 s61, s51, 10
  v_mfma_f32_32x32x16_bf16 v[104:119], v[60:63], v[64:67], v[104:119]
  ds_read_b128 v[36:39], v86 offset:8192
  ds_read_b128 v[40:43], v150 offset:0
  ds_read_b128 v[44:47], v86 offset:12288
  ds_read_b128 v[48:51], v151 offset:0
  s_add_u32 s61, s61, 20086784
  s_mov_b32 s62, 20119552
  v_mfma_f32_32x32x16_bf16 v[104:119], v[68:71], v[72:75], v[104:119]
  s_add_u32 m0, s48, 40960
  s_add_u32 s49, s87, 1408
  buffer_load_dwordx4 v244, s[24:27], s49 offen lds
  s_add_u32 m0, s48, 24576
  s_add_u32 s49, s88, 180224
  buffer_load_dwordx4 v4, s[12:15], s49 offen sc1 lds
  s_add_u32 m0, s48, 32768
  s_add_u32 s49, s88, 188416
  buffer_load_dwordx4 v4, s[12:15], s49 offen sc1 lds
  v_mfma_f32_32x32x16_bf16 v[104:119], v[76:79], v[80:83], v[104:119]
  s_waitcnt lgkmcnt(0)
  s_waitcnt vmcnt(12)
  s_barrier
  v_mfma_f32_32x32x16_bf16 v[104:119], v[20:23], v[24:27], v[104:119]
  ds_read_b128 v[52:55], v86 offset:24576
  ds_read_b128 v[56:59], v148 offset:24576
  ds_read_b128 v[60:63], v86 offset:28672
  ds_read_b128 v[64:67], v149 offset:24576
  v_mfma_f32_32x32x16_bf16 v[104:119], v[28:31], v[32:35], v[104:119]
  ds_read_b128 v[68:71], v86 offset:32768
  ds_read_b128 v[72:75], v150 offset:24576
  ds_read_b128 v[76:79], v86 offset:36864
  ds_read_b128 v[80:83], v151 offset:24576
  v_mfma_f32_32x32x16_bf16 v[104:119], v[36:39], v[40:43], v[104:119]
  s_add_u32 m0, s48, 114688
  s_add_u32 s49, s87, 1536
  buffer_load_dwordx4 v244, s[24:27], s49 offen lds
  s_add_u32 m0, s48, 98304
  s_add_u32 s49, s88, 196608
  buffer_load_dwordx4 v4, s[12:15], s49 offen sc1 lds
  s_add_u32 m0, s48, 106496
  s_add_u32 s49, s88, 204800
  buffer_load_dwordx4 v4, s[12:15], s49 offen sc1 lds
  v_mfma_f32_32x32x16_bf16 v[104:119], v[44:47], v[48:51], v[104:119]
  s_waitcnt lgkmcnt(0)
  s_waitcnt vmcnt(12)
  s_barrier
  v_mfma_f32_32x32x16_bf16 v[104:119], v[52:55], v[56:59], v[104:119]
  ds_read_b128 v[20:23], v85 offset:0
  ds_read_b128 v[24:27], v144 offset:0
  ds_read_b128 v[28:31], v85 offset:4096
  ds_read_b128 v[32:35], v145 offset:0
  v_mfma_f32_32x32x16_bf16 v[104:119], v[60:63], v[64:67], v[104:119]
  ds_read_b128 v[36:39], v85 offset:8192
  ds_read_b128 v[40:43], v146 offset:0
  ds_read_b128 v[44:47], v85 offset:12288
  ds_read_b128 v[48:51], v147 offset:0
  v_mfma_f32_32x32x16_bf16 v[104:119], v[68:71], v[72:75], v[104:119]
  s_add_u32 m0, s48, 139264
  s_add_u32 s49, s87, 1664
  buffer_load_dwordx4 v244, s[24:27], s49 offen lds
  s_add_u32 m0, s48, 122880
  s_add_u32 s49, s88, 212992
  buffer_load_dwordx4 v4, s[12:15], s49 offen sc1 lds
  s_add_u32 m0, s48, 131072
  s_add_u32 s49, s88, 221184
  buffer_load_dwordx4 v4, s[12:15], s49 offen sc1 lds
  v_mfma_f32_32x32x16_bf16 v[104:119], v[76:79], v[80:83], v[104:119]
  s_waitcnt lgkmcnt(0)
  s_waitcnt vmcnt(12)
  s_barrier
  v_mfma_f32_32x32x16_bf16 v[104:119], v[20:23], v[24:27], v[104:119]
  ds_read_b128 v[52:55], v85 offset:24576
  ds_read_b128 v[56:59], v144 offset:24576
  ds_read_b128 v[60:63], v85 offset:28672
  ds_read_b128 v[64:67], v145 offset:24576
  v_mfma_f32_32x32x16_bf16 v[104:119], v[28:31], v[32:35], v[104:119]
  ds_read_b128 v[68:71], v85 offset:32768
  ds_read_b128 v[72:75], v146 offset:24576
  ds_read_b128 v[76:79], v85 offset:36864
  ds_read_b128 v[80:83], v147 offset:24576
  v_mfma_f32_32x32x16_bf16 v[104:119], v[36:39], v[40:43], v[104:119]
  s_add_u32 m0, s48, 65536
  s_add_u32 s49, s87, 1792
  buffer_load_dwordx4 v244, s[24:27], s49 offen lds
  s_add_u32 m0, s48, 49152
  s_add_u32 s49, s88, 229376
  buffer_load_dwordx4 v4, s[12:15], s49 offen sc1 lds
  s_add_u32 m0, s48, 57344
  s_add_u32 s49, s88, 237568
  buffer_load_dwordx4 v4, s[12:15], s49 offen sc1 lds
  v_mfma_f32_32x32x16_bf16 v[104:119], v[44:47], v[48:51], v[104:119]
  s_waitcnt lgkmcnt(0)
  s_waitcnt vmcnt(12)
  s_barrier
  v_mfma_f32_32x32x16_bf16 v[104:119], v[52:55], v[56:59], v[104:119]
  ds_read_b128 v[20:23], v84 offset:0
  ds_read_b128 v[24:27], v140 offset:0
  ds_read_b128 v[28:31], v84 offset:4096
  ds_read_b128 v[32:35], v141 offset:0
  v_mfma_f32_32x32x16_bf16 v[104:119], v[60:63], v[64:67], v[104:119]
  ds_read_b128 v[36:39], v84 offset:8192
  ds_read_b128 v[40:43], v142 offset:0
  ds_read_b128 v[44:47], v84 offset:12288
  ds_read_b128 v[48:51], v143 offset:0
  v_mfma_f32_32x32x16_bf16 v[104:119], v[68:71], v[72:75], v[104:119]
  s_add_u32 m0, s48, 90112
  s_add_u32 s49, s87, 1920
  buffer_load_dwordx4 v244, s[24:27], s49 offen lds
  s_add_u32 m0, s48, 73728
  s_add_u32 s49, s88, 245760
  buffer_load_dwordx4 v4, s[12:15], s49 offen sc1 lds
  s_add_u32 m0, s48, 81920
  s_add_u32 s49, s88, 253952
  buffer_load_dwordx4 v4, s[12:15], s49 offen sc1 lds
  v_mfma_f32_32x32x16_bf16 v[104:119], v[76:79], v[80:83], v[104:119]
  s_waitcnt lgkmcnt(0)
  s_waitcnt vmcnt(12)
  s_barrier
  v_mfma_f32_32x32x16_bf16 v[104:119], v[20:23], v[24:27], v[104:119]
  ds_read_b128 v[52:55], v84 offset:24576
  ds_read_b128 v[56:59], v140 offset:24576
  ds_read_b128 v[60:63], v84 offset:28672
  ds_read_b128 v[64:67], v141 offset:24576
  v_mfma_f32_32x32x16_bf16 v[104:119], v[28:31], v[32:35], v[104:119]
  ds_read_b128 v[68:71], v84 offset:32768
  ds_read_b128 v[72:75], v142 offset:24576
  ds_read_b128 v[76:79], v84 offset:36864
  ds_read_b128 v[80:83], v143 offset:24576
  v_mfma_f32_32x32x16_bf16 v[104:119], v[36:39], v[40:43], v[104:119]
  s_add_u32 m0, s48, 16384
  s_add_u32 s49, s87, 2048
  buffer_load_dwordx4 v244, s[24:27], s49 offen lds
  s_add_u32 m0, s48, 0
  s_add_u32 s49, s88, 262144
  buffer_load_dwordx4 v4, s[12:15], s49 offen sc1 lds
  s_add_u32 m0, s48, 8192
  s_add_u32 s49, s88, 270336
  buffer_load_dwordx4 v4, s[12:15], s49 offen sc1 lds
  v_mfma_f32_32x32x16_bf16 v[104:119], v[44:47], v[48:51], v[104:119]
  s_waitcnt lgkmcnt(0)
  s_waitcnt vmcnt(12)
  s_barrier
  v_mfma_f32_32x32x16_bf16 v[104:119], v[52:55], v[56:59], v[104:119]
  ds_read_b128 v[20:23], v86 offset:0
  ds_read_b128 v[24:27], v148 offset:0
  ds_read_b128 v[28:31], v86 offset:4096
  ds_read_b128 v[32:35], v149 offset:0
  v_mfma_f32_32x32x16_bf16 v[104:119], v[60:63], v[64:67], v[104:119]
  ds_read_b128 v[36:39], v86 offset:8192
  ds_read_b128 v[40:43], v150 offset:0
  ds_read_b128 v[44:47], v86 offset:12288
  ds_read_b128 v[48:51], v151 offset:0
  v_mfma_f32_32x32x16_bf16 v[104:119], v[68:71], v[72:75], v[104:119]
  s_add_u32 m0, s48, 40960
  s_add_u32 s49, s87, 2176
  buffer_load_dwordx4 v244, s[24:27], s49 offen lds
  s_add_u32 m0, s48, 24576
  s_add_u32 s49, s88, 278528
  buffer_load_dwordx4 v4, s[12:15], s49 offen sc1 lds
  s_add_u32 m0, s48, 32768
  s_add_u32 s49, s88, 286720
  buffer_load_dwordx4 v4, s[12:15], s49 offen sc1 lds
  v_mfma_f32_32x32x16_bf16 v[104:119], v[76:79], v[80:83], v[104:119]
  s_waitcnt lgkmcnt(0)
  s_waitcnt vmcnt(12)
  s_barrier
  v_mfma_f32_32x32x16_bf16 v[104:119], v[20:23], v[24:27], v[104:119]
  ds_read_b128 v[52:55], v86 offset:24576
  ds_read_b128 v[56:59], v148 offset:24576
  ds_read_b128 v[60:63], v86 offset:28672
  ds_read_b128 v[64:67], v149 offset:24576
  v_mfma_f32_32x32x16_bf16 v[104:119], v[28:31], v[32:35], v[104:119]
  ds_read_b128 v[68:71], v86 offset:32768
  ds_read_b128 v[72:75], v150 offset:24576
  ds_read_b128 v[76:79], v86 offset:36864
  ds_read_b128 v[80:83], v151 offset:24576
  v_mfma_f32_32x32x16_bf16 v[104:119], v[36:39], v[40:43], v[104:119]
  s_add_u32 m0, s48, 114688
  s_add_u32 s49, s87, 2304
  buffer_load_dwordx4 v244, s[24:27], s49 offen lds
  s_add_u32 m0, s48, 98304
  s_add_u32 s49, s88, 294912
  buffer_load_dwordx4 v4, s[12:15], s49 offen sc1 lds
  s_add_u32 m0, s48, 106496
  s_add_u32 s49, s88, 303104
  buffer_load_dwordx4 v4, s[12:15], s49 offen sc1 lds
  v_mfma_f32_32x32x16_bf16 v[104:119], v[44:47], v[48:51], v[104:119]
  s_waitcnt lgkmcnt(0)
  s_waitcnt vmcnt(12)
  s_barrier
  v_mfma_f32_32x32x16_bf16 v[104:119], v[52:55], v[56:59], v[104:119]
  ds_read_b128 v[20:23], v85 offset:0
  ds_read_b128 v[24:27], v144 offset:0
  ds_read_b128 v[28:31], v85 offset:4096
  ds_read_b128 v[32:35], v145 offset:0
  v_mfma_f32_32x32x16_bf16 v[104:119], v[60:63], v[64:67], v[104:119]
  ds_read_b128 v[36:39], v85 offset:8192
  ds_read_b128 v[40:43], v146 offset:0
  ds_read_b128 v[44:47], v85 offset:12288
  ds_read_b128 v[48:51], v147 offset:0
  v_mfma_f32_32x32x16_bf16 v[104:119], v[68:71], v[72:75], v[104:119]
  s_add_u32 m0, s48, 139264
  s_add_u32 s49, s87, 2432
  buffer_load_dwordx4 v244, s[24:27], s49 offen lds
  s_add_u32 m0, s48, 122880
  s_add_u32 s49, s88, 311296
  buffer_load_dwordx4 v4, s[12:15], s49 offen sc1 lds
  s_add_u32 m0, s48, 131072
  s_add_u32 s49, s88, 319488
  buffer_load_dwordx4 v4, s[12:15], s49 offen sc1 lds
  v_mfma_f32_32x32x16_bf16 v[104:119], v[76:79], v[80:83], v[104:119]
  s_waitcnt lgkmcnt(0)
  s_waitcnt vmcnt(12)
  s_barrier
  v_mfma_f32_32x32x16_bf16 v[104:119], v[20:23], v[24:27], v[104:119]
  ds_read_b128 v[52:55], v85 offset:24576
  ds_read_b128 v[56:59], v144 offset:24576
  ds_read_b128 v[60:63], v85 offset:28672
  ds_read_b128 v[64:67], v145 offset:24576
  v_mfma_f32_32x32x16_bf16 v[104:119], v[28:31], v[32:35], v[104:119]
  ds_read_b128 v[68:71], v85 offset:32768
  ds_read_b128 v[72:75], v146 offset:24576
  ds_read_b128 v[76:79], v85 offset:36864
  ds_read_b128 v[80:83], v147 offset:24576
  v_mfma_f32_32x32x16_bf16 v[104:119], v[36:39], v[40:43], v[104:119]
  s_add_u32 m0, s48, 65536
  s_add_u32 s49, s87, 2560
  buffer_load_dwordx4 v244, s[24:27], s49 offen lds
  s_add_u32 m0, s48, 49152
  s_add_u32 s49, s88, 327680
  buffer_load_dwordx4 v4, s[12:15], s49 offen sc1 lds
  s_add_u32 m0, s48, 57344
  s_add_u32 s49, s88, 335872
  buffer_load_dwordx4 v4, s[12:15], s49 offen sc1 lds
  v_mfma_f32_32x32x16_bf16 v[104:119], v[44:47], v[48:51], v[104:119]
  s_waitcnt lgkmcnt(0)
  s_waitcnt vmcnt(12)
  s_barrier
  v_mfma_f32_32x32x16_bf16 v[104:119], v[52:55], v[56:59], v[104:119]
  ds_read_b128 v[20:23], v84 offset:0
  ds_read_b128 v[24:27], v140 offset:0
  ds_read_b128 v[28:31], v84 offset:4096
  ds_read_b128 v[32:35], v141 offset:0
  v_mfma_f32_32x32x16_bf16 v[104:119], v[60:63], v[64:67], v[104:119]
  ds_read_b128 v[36:39], v84 offset:8192
  ds_read_b128 v[40:43], v142 offset:0
  ds_read_b128 v[44:47], v84 offset:12288
  ds_read_b128 v[48:51], v143 offset:0
  v_mfma_f32_32x32x16_bf16 v[104:119], v[68:71], v[72:75], v[104:119]
  s_add_u32 m0, s48, 90112
  s_add_u32 s49, s87, 2688
  buffer_load_dwordx4 v244, s[24:27], s49 offen lds
  s_add_u32 m0, s48, 73728
  s_add_u32 s49, s88, 344064
  buffer_load_dwordx4 v4, s[12:15], s49 offen sc1 lds
  s_add_u32 m0, s48, 81920
  s_add_u32 s49, s88, 352256
  buffer_load_dwordx4 v4, s[12:15], s49 offen sc1 lds
  v_mfma_f32_32x32x16_bf16 v[104:119], v[76:79], v[80:83], v[104:119]
  s_waitcnt lgkmcnt(0)
  s_waitcnt vmcnt(12)
  s_barrier
  v_mfma_f32_32x32x16_bf16 v[104:119], v[20:23], v[24:27], v[104:119]
  ds_read_b128 v[52:55], v84 offset:24576
  ds_read_b128 v[56:59], v140 offset:24576
  ds_read_b128 v[60:63], v84 offset:28672
  ds_read_b128 v[64:67], v141 offset:24576
  v_mfma_f32_32x32x16_bf16 v[104:119], v[28:31], v[32:35], v[104:119]
  ds_read_b128 v[68:71], v84 offset:32768
  ds_read_b128 v[72:75], v142 offset:24576
  ds_read_b128 v[76:79], v84 offset:36864
  ds_read_b128 v[80:83], v143 offset:24576
  v_mfma_f32_32x32x16_bf16 v[104:119], v[36:39], v[40:43], v[104:119]
  s_add_u32 m0, s48, 16384
  s_add_u32 s49, s87, 2816
  buffer_load_dwordx4 v244, s[24:27], s49 offen lds
  s_add_u32 m0, s48, 0
  s_add_u32 s49, s88, 360448
  buffer_load_dwordx4 v4, s[12:15], s49 offen sc1 lds
  s_add_u32 m0, s48, 8192
  s_add_u32 s49, s88, 368640
  buffer_load_dwordx4 v4, s[12:15], s49 offen sc1 lds
  v_mfma_f32_32x32x16_bf16 v[104:119], v[44:47], v[48:51], v[104:119]
  s_waitcnt lgkmcnt(0)
  s_waitcnt vmcnt(12)
  s_barrier
  v_mfma_f32_32x32x16_bf16 v[104:119], v[52:55], v[56:59], v[104:119]
  ds_read_b128 v[20:23], v86 offset:0
  ds_read_b128 v[24:27], v148 offset:0
  ds_read_b128 v[28:31], v86 offset:4096
  ds_read_b128 v[32:35], v149 offset:0
  v_mfma_f32_32x32x16_bf16 v[104:119], v[60:63], v[64:67], v[104:119]
  ds_read_b128 v[36:39], v86 offset:8192
  ds_read_b128 v[40:43], v150 offset:0
  ds_read_b128 v[44:47], v86 offset:12288
  ds_read_b128 v[48:51], v151 offset:0
  v_mfma_f32_32x32x16_bf16 v[104:119], v[68:71], v[72:75], v[104:119]
  s_add_u32 m0, s48, 40960
  s_add_u32 s49, s87, 2944
  buffer_load_dwordx4 v244, s[24:27], s49 offen lds
  s_add_u32 m0, s48, 24576
  s_add_u32 s49, s88, 376832
  buffer_load_dwordx4 v4, s[12:15], s49 offen sc1 lds
  s_add_u32 m0, s48, 32768
  s_add_u32 s49, s88, 385024
  buffer_load_dwordx4 v4, s[12:15], s49 offen sc1 lds
  v_mfma_f32_32x32x16_bf16 v[104:119], v[76:79], v[80:83], v[104:119]
  s_waitcnt lgkmcnt(0)
  s_waitcnt vmcnt(12)
  s_barrier
  v_mfma_f32_32x32x16_bf16 v[104:119], v[20:23], v[24:27], v[104:119]
  ds_read_b128 v[52:55], v86 offset:24576
  ds_read_b128 v[56:59], v148 offset:24576
  ds_read_b128 v[60:63], v86 offset:28672
  ds_read_b128 v[64:67], v149 offset:24576
  v_mfma_f32_32x32x16_bf16 v[104:119], v[28:31], v[32:35], v[104:119]
  ds_read_b128 v[68:71], v86 offset:32768
  ds_read_b128 v[72:75], v150 offset:24576
  ds_read_b128 v[76:79], v86 offset:36864
  ds_read_b128 v[80:83], v151 offset:24576
  v_mfma_f32_32x32x16_bf16 v[104:119], v[36:39], v[40:43], v[104:119]
  s_add_u32 m0, s48, 114688
  s_add_u32 s49, s87, 3072
  buffer_load_dwordx4 v244, s[24:27], s49 offen lds
  s_add_u32 m0, s48, 98304
  s_add_u32 s49, s88, 393216
  buffer_load_dwordx4 v4, s[12:15], s49 offen sc1 lds
  s_add_u32 m0, s48, 106496
  s_add_u32 s49, s88, 401408
  buffer_load_dwordx4 v4, s[12:15], s49 offen sc1 lds
  v_mfma_f32_32x32x16_bf16 v[104:119], v[44:47], v[48:51], v[104:119]
  s_waitcnt lgkmcnt(0)
  s_waitcnt vmcnt(12)
  s_barrier
  v_mfma_f32_32x32x16_bf16 v[104:119], v[52:55], v[56:59], v[104:119]
  ds_read_b128 v[20:23], v85 offset:0
  ds_read_b128 v[24:27], v144 offset:0
  ds_read_b128 v[28:31], v85 offset:4096
  ds_read_b128 v[32:35], v145 offset:0
  v_mfma_f32_32x32x16_bf16 v[104:119], v[60:63], v[64:67], v[104:119]
  ds_read_b128 v[36:39], v85 offset:8192
  ds_read_b128 v[40:43], v146 offset:0
  ds_read_b128 v[44:47], v85 offset:12288
  ds_read_b128 v[48:51], v147 offset:0
  v_mfma_f32_32x32x16_bf16 v[104:119], v[68:71], v[72:75], v[104:119]
  s_add_u32 m0, s48, 139264
  s_add_u32 s49, s87, 3200
  buffer_load_dwordx4 v244, s[24:27], s49 offen lds
  s_add_u32 m0, s48, 122880
  s_add_u32 s49, s88, 409600
  buffer_load_dwordx4 v4, s[12:15], s49 offen sc1 lds
  s_add_u32 m0, s48, 131072
  s_add_u32 s49, s88, 417792
  buffer_load_dwordx4 v4, s[12:15], s49 offen sc1 lds
  v_mfma_f32_32x32x16_bf16 v[104:119], v[76:79], v[80:83], v[104:119]
  s_waitcnt lgkmcnt(0)
  s_waitcnt vmcnt(12)
  s_barrier
  v_mfma_f32_32x32x16_bf16 v[104:119], v[20:23], v[24:27], v[104:119]
  ds_read_b128 v[52:55], v85 offset:24576
  ds_read_b128 v[56:59], v144 offset:24576
  ds_read_b128 v[60:63], v85 offset:28672
  ds_read_b128 v[64:67], v145 offset:24576
  v_mfma_f32_32x32x16_bf16 v[104:119], v[28:31], v[32:35], v[104:119]
  ds_read_b128 v[68:71], v85 offset:32768
  ds_read_b128 v[72:75], v146 offset:24576
  ds_read_b128 v[76:79], v85 offset:36864
  ds_read_b128 v[80:83], v147 offset:24576
  v_mfma_f32_32x32x16_bf16 v[104:119], v[36:39], v[40:43], v[104:119]
  s_add_u32 m0, s48, 65536
  s_add_u32 s49, s87, 3328
  buffer_load_dwordx4 v244, s[24:27], s49 offen lds
  s_add_u32 m0, s48, 49152
  s_add_u32 s49, s88, 425984
  buffer_load_dwordx4 v4, s[12:15], s49 offen sc1 lds
  s_add_u32 m0, s48, 57344
  s_add_u32 s49, s88, 434176
  buffer_load_dwordx4 v4, s[12:15], s49 offen sc1 lds
  v_mfma_f32_32x32x16_bf16 v[104:119], v[44:47], v[48:51], v[104:119]
  s_waitcnt lgkmcnt(0)
  s_waitcnt vmcnt(12)
  s_barrier
  v_mfma_f32_32x32x16_bf16 v[104:119], v[52:55], v[56:59], v[104:119]
  ds_read_b128 v[20:23], v84 offset:0
  ds_read_b128 v[24:27], v140 offset:0
  ds_read_b128 v[28:31], v84 offset:4096
  ds_read_b128 v[32:35], v141 offset:0
  v_mfma_f32_32x32x16_bf16 v[104:119], v[60:63], v[64:67], v[104:119]
  ds_read_b128 v[36:39], v84 offset:8192
  ds_read_b128 v[40:43], v142 offset:0
  ds_read_b128 v[44:47], v84 offset:12288
  ds_read_b128 v[48:51], v143 offset:0
  v_mfma_f32_32x32x16_bf16 v[104:119], v[68:71], v[72:75], v[104:119]
  s_add_u32 m0, s48, 90112
  s_add_u32 s49, s87, 3456
  buffer_load_dwordx4 v244, s[24:27], s49 offen lds
  s_add_u32 m0, s48, 73728
  s_add_u32 s49, s88, 442368
  buffer_load_dwordx4 v4, s[12:15], s49 offen sc1 lds
  s_add_u32 m0, s48, 81920
  s_add_u32 s49, s88, 450560
  buffer_load_dwordx4 v4, s[12:15], s49 offen sc1 lds
  v_mfma_f32_32x32x16_bf16 v[104:119], v[76:79], v[80:83], v[104:119]
  s_waitcnt lgkmcnt(0)
  s_waitcnt vmcnt(12)
  s_barrier
  v_mfma_f32_32x32x16_bf16 v[104:119], v[20:23], v[24:27], v[104:119]
  ds_read_b128 v[52:55], v84 offset:24576
  ds_read_b128 v[56:59], v140 offset:24576
  ds_read_b128 v[60:63], v84 offset:28672
  ds_read_b128 v[64:67], v141 offset:24576
  v_mfma_f32_32x32x16_bf16 v[104:119], v[28:31], v[32:35], v[104:119]
  ds_read_b128 v[68:71], v84 offset:32768
  ds_read_b128 v[72:75], v142 offset:24576
  ds_read_b128 v[76:79], v84 offset:36864
  ds_read_b128 v[80:83], v143 offset:24576
  v_mfma_f32_32x32x16_bf16 v[104:119], v[36:39], v[40:43], v[104:119]
  s_add_u32 m0, s48, 16384
  s_add_u32 s49, s87, 3584
  buffer_load_dwordx4 v244, s[24:27], s49 offen lds
  s_add_u32 m0, s48, 0
  s_add_u32 s49, s88, 458752
  buffer_load_dwordx4 v4, s[12:15], s49 offen sc1 lds
  s_add_u32 m0, s48, 8192
  s_add_u32 s49, s88, 466944
  buffer_load_dwordx4 v4, s[12:15], s49 offen sc1 lds
  v_mfma_f32_32x32x16_bf16 v[104:119], v[44:47], v[48:51], v[104:119]
  s_waitcnt lgkmcnt(0)
  s_waitcnt vmcnt(12)
  s_barrier
  v_mfma_f32_32x32x16_bf16 v[104:119], v[52:55], v[56:59], v[104:119]
  ds_read_b128 v[20:23], v86 offset:0
  ds_read_b128 v[24:27], v148 offset:0
  ds_read_b128 v[28:31], v86 offset:4096
  ds_read_b128 v[32:35], v149 offset:0
  v_mfma_f32_32x32x16_bf16 v[104:119], v[60:63], v[64:67], v[104:119]
  ds_read_b128 v[36:39], v86 offset:8192
  ds_read_b128 v[40:43], v150 offset:0
  ds_read_b128 v[44:47], v86 offset:12288
  ds_read_b128 v[48:51], v151 offset:0
  v_mfma_f32_32x32x16_bf16 v[104:119], v[68:71], v[72:75], v[104:119]
  s_add_u32 m0, s48, 40960
  s_add_u32 s49, s87, 3712
  buffer_load_dwordx4 v244, s[24:27], s49 offen lds
  s_add_u32 m0, s48, 24576
  s_add_u32 s49, s88, 475136
  buffer_load_dwordx4 v4, s[12:15], s49 offen sc1 lds
  s_add_u32 m0, s48, 32768
  s_add_u32 s49, s88, 483328
  buffer_load_dwordx4 v4, s[12:15], s49 offen sc1 lds
  v_mfma_f32_32x32x16_bf16 v[104:119], v[76:79], v[80:83], v[104:119]
  s_waitcnt lgkmcnt(0)
  s_waitcnt vmcnt(12)
  s_barrier
  v_mfma_f32_32x32x16_bf16 v[104:119], v[20:23], v[24:27], v[104:119]
  ds_read_b128 v[52:55], v86 offset:24576
  ds_read_b128 v[56:59], v148 offset:24576
  ds_read_b128 v[60:63], v86 offset:28672
  ds_read_b128 v[64:67], v149 offset:24576
  v_mfma_f32_32x32x16_bf16 v[104:119], v[28:31], v[32:35], v[104:119]
  ds_read_b128 v[68:71], v86 offset:32768
  ds_read_b128 v[72:75], v150 offset:24576
  ds_read_b128 v[76:79], v86 offset:36864
  ds_read_b128 v[80:83], v151 offset:24576
  v_mfma_f32_32x32x16_bf16 v[104:119], v[36:39], v[40:43], v[104:119]
  s_add_u32 m0, s48, 114688
  s_add_u32 s49, s87, 3840
  buffer_load_dwordx4 v244, s[24:27], s49 offen lds
  s_add_u32 m0, s48, 98304
  s_add_u32 s49, s88, 491520
  buffer_load_dwordx4 v4, s[12:15], s49 offen sc1 lds
  s_add_u32 m0, s48, 106496
  s_add_u32 s49, s88, 499712
  buffer_load_dwordx4 v4, s[12:15], s49 offen sc1 lds
  v_mfma_f32_32x32x16_bf16 v[104:119], v[44:47], v[48:51], v[104:119]
  s_waitcnt lgkmcnt(0)
  s_waitcnt vmcnt(12)
  s_barrier
  v_mfma_f32_32x32x16_bf16 v[104:119], v[52:55], v[56:59], v[104:119]
  ds_read_b128 v[20:23], v85 offset:0
  ds_read_b128 v[24:27], v144 offset:0
  ds_read_b128 v[28:31], v85 offset:4096
  ds_read_b128 v[32:35], v145 offset:0
  v_mfma_f32_32x32x16_bf16 v[104:119], v[60:63], v[64:67], v[104:119]
  ds_read_b128 v[36:39], v85 offset:8192
  ds_read_b128 v[40:43], v146 offset:0
  ds_read_b128 v[44:47], v85 offset:12288
  ds_read_b128 v[48:51], v147 offset:0
  v_mfma_f32_32x32x16_bf16 v[104:119], v[68:71], v[72:75], v[104:119]
  s_add_u32 m0, s48, 139264
  s_add_u32 s49, s87, 3968
  buffer_load_dwordx4 v244, s[24:27], s49 offen lds
  s_add_u32 m0, s48, 122880
  s_add_u32 s49, s88, 507904
  buffer_load_dwordx4 v4, s[12:15], s49 offen sc1 lds
  s_add_u32 m0, s48, 131072
  s_add_u32 s49, s88, 516096
  buffer_load_dwordx4 v4, s[12:15], s49 offen sc1 lds
  v_mfma_f32_32x32x16_bf16 v[104:119], v[76:79], v[80:83], v[104:119]
  s_waitcnt lgkmcnt(0)
  s_waitcnt vmcnt(12)
  s_barrier
  v_mfma_f32_32x32x16_bf16 v[104:119], v[20:23], v[24:27], v[104:119]
  ds_read_b128 v[52:55], v85 offset:24576
  ds_read_b128 v[56:59], v144 offset:24576
  ds_read_b128 v[60:63], v85 offset:28672
  ds_read_b128 v[64:67], v145 offset:24576
  v_mfma_f32_32x32x16_bf16 v[104:119], v[28:31], v[32:35], v[104:119]
  ds_read_b128 v[68:71], v85 offset:32768
  ds_read_b128 v[72:75], v146 offset:24576
  ds_read_b128 v[76:79], v85 offset:36864
  ds_read_b128 v[80:83], v147 offset:24576
  v_mfma_f32_32x32x16_bf16 v[104:119], v[36:39], v[40:43], v[104:119]
  s_mov_b32 s46, s73
  v_bfe_u32 v100, v1, 3, 2
  v_and_b32 v101, 7, v1
  v_lshlrev_b32 v100, 7, v100
  v_lshl_add_u32 v100, v101, 1, v100
  buffer_load_ushort v96, v100, s[68:71], s46 offen
  s_mov_b32 s49, s58
  buffer_load_dwordx4 v[156:159], v154, s[4:7], s49 offen
  s_add_u32 m0, s48, 49152
  s_add_u32 s49, s57, 0
  buffer_load_dwordx4 v4, s[92:95], s49 offen lds
  s_add_u32 m0, s48, 57344
  s_add_u32 s49, s57, 8192
  buffer_load_dwordx4 v4, s[92:95], s49 offen lds
  s_add_u32 m0, s48, 65536
  s_add_u32 s49, s57, 16384
  buffer_load_dwordx4 v4, s[92:95], s49 offen lds
  v_mfma_f32_32x32x16_bf16 v[104:119], v[44:47], v[48:51], v[104:119]
  s_waitcnt lgkmcnt(0)
  s_waitcnt vmcnt(14)
  s_barrier
  v_mfma_f32_32x32x16_bf16 v[104:119], v[52:55], v[56:59], v[104:119]
  ds_read_b128 v[20:23], v84 offset:0
  ds_read_b128 v[24:27], v140 offset:0
  ds_read_b128 v[28:31], v84 offset:4096
  ds_read_b128 v[32:35], v141 offset:0
  v_mfma_f32_32x32x16_bf16 v[104:119], v[60:63], v[64:67], v[104:119]
  ds_read_b128 v[36:39], v84 offset:8192
  ds_read_b128 v[40:43], v142 offset:0
  ds_read_b128 v[44:47], v84 offset:12288
  ds_read_b128 v[48:51], v143 offset:0
  v_mfma_f32_32x32x16_bf16 v[104:119], v[68:71], v[72:75], v[104:119]
  s_add_u32 m0, s48, 73728
  s_add_u32 s49, s57, 24576
  buffer_load_dwordx4 v4, s[92:95], s49 offen lds
  s_add_u32 m0, s48, 81920
  s_add_u32 s49, s57, 32768
  buffer_load_dwordx4 v4, s[92:95], s49 offen lds
  s_add_u32 m0, s48, 90112
  s_add_u32 s49, s57, 40960
  buffer_load_dwordx4 v4, s[92:95], s49 offen lds
  v_mfma_f32_32x32x16_bf16 v[104:119], v[76:79], v[80:83], v[104:119]
  s_waitcnt lgkmcnt(0)
  s_waitcnt vmcnt(14)
  s_barrier
  v_mfma_f32_32x32x16_bf16 v[104:119], v[20:23], v[24:27], v[104:119]
  ds_read_b128 v[52:55], v84 offset:24576
  ds_read_b128 v[56:59], v140 offset:24576
  ds_read_b128 v[60:63], v84 offset:28672
  ds_read_b128 v[64:67], v141 offset:24576
  v_mfma_f32_32x32x16_bf16 v[104:119], v[28:31], v[32:35], v[104:119]
  ds_read_b128 v[68:71], v84 offset:32768
  ds_read_b128 v[72:75], v142 offset:24576
  ds_read_b128 v[76:79], v84 offset:36864
  ds_read_b128 v[80:83], v143 offset:24576
  v_mfma_f32_32x32x16_bf16 v[104:119], v[36:39], v[40:43], v[104:119]
  s_add_u32 m0, s48, 0
  s_add_u32 s49, s57, 49152
  buffer_load_dwordx4 v4, s[92:95], s49 offen lds
  s_add_u32 m0, s48, 8192
  s_add_u32 s49, s55, 0
  buffer_load_dwordx4 v152, s[8:11], s49 offen lds
  s_add_u32 m0, s48, 16384
  s_add_u32 s49, s55, 57344
  buffer_load_dwordx4 v152, s[8:11], s49 offen lds
  v_mfma_f32_32x32x16_bf16 v[104:119], v[44:47], v[48:51], v[104:119]
  s_waitcnt lgkmcnt(0)
  s_waitcnt vmcnt(14)
  s_barrier
  v_mfma_f32_32x32x16_bf16 v[104:119], v[52:55], v[56:59], v[104:119]
  ds_read_b128 v[20:23], v86 offset:0
  ds_read_b128 v[24:27], v148 offset:0
  ds_read_b128 v[28:31], v86 offset:4096
  ds_read_b128 v[32:35], v149 offset:0
  v_mfma_f32_32x32x16_bf16 v[104:119], v[60:63], v[64:67], v[104:119]
  ds_read_b128 v[36:39], v86 offset:8192
  ds_read_b128 v[40:43], v150 offset:0
  ds_read_b128 v[44:47], v86 offset:12288
  ds_read_b128 v[48:51], v151 offset:0
  v_mfma_f32_32x32x16_bf16 v[104:119], v[68:71], v[72:75], v[104:119]
  s_add_u32 m0, s48, 24576
  s_add_u32 s49, s55, 114688
  buffer_load_dwordx4 v152, s[8:11], s49 offen lds
  s_add_u32 m0, s48, 32768
  s_add_u32 s49, s55, 172032
  buffer_load_dwordx4 v152, s[8:11], s49 offen lds
  v_mfma_f32_32x32x16_bf16 v[104:119], v[76:79], v[80:83], v[104:119]
  s_waitcnt lgkmcnt(0)
  s_waitcnt vmcnt(13)
  s_barrier
  v_mfma_f32_32x32x16_bf16 v[104:119], v[20:23], v[24:27], v[104:119]
  ds_read_b128 v[52:55], v86 offset:24576
  ds_read_b128 v[56:59], v148 offset:24576
  ds_read_b128 v[60:63], v86 offset:28672
  ds_read_b128 v[64:67], v149 offset:24576
  v_mfma_f32_32x32x16_bf16 v[104:119], v[28:31], v[32:35], v[104:119]
  ds_read_b128 v[68:71], v86 offset:32768
  ds_read_b128 v[72:75], v150 offset:24576
  ds_read_b128 v[76:79], v86 offset:36864
  ds_read_b128 v[80:83], v151 offset:24576
  v_mfma_f32_32x32x16_bf16 v[104:119], v[36:39], v[40:43], v[104:119]
  s_cmp_lg_u32 s42, 0
  s_cbranch_scc1 L_PY
  buffer_load_dword v160, v250, s[12:15], s62 offen sc1
L_PY:
  v_mfma_f32_32x32x16_bf16 v[104:119], v[44:47], v[48:51], v[104:119]
  s_waitcnt lgkmcnt(0)
  v_bfe_u32 v100, v1, 2, 2
  v_lshrrev_b32 v101, 5, v1
  v_bfe_u32 v102, v1, 4, 1
  v_bfe_u32 v103, v1, 1, 1
  v_lshl_add_u32 v102, v102, 1, v103
  v_lshrrev_b32 v103, 1, v100
  v_lshlrev_b32 v103, 2, v103
  v_xor_b32 v102, v102, v103
  v_and_b32 v103, 1, v1
  v_lshlrev_b32 v103, 3, v103
  v_lshl_add_u32 v103, v100, 7, v103
  s_and_b32 s46, s42, 1
  s_bfe_u32 s47, s42, 0x10001
  s_lshl_b32 s49, s47, 2
  v_xor_b32 v100, s49, v102
  v_lshl_add_u32 v168, v100, 4, v103
  v_lshl_add_u32 v168, v101, 9, v168
  s_lshl_b32 s49, s46, 12
  v_add_u32 v171, s49, v4
  s_lshl_b32 s49, s46, 2
  v_xor_b32 v100, s49, v102
  v_lshl_add_u32 v224, v100, 4, v103
  v_lshl_add_u32 v224, v101, 10, v224
  s_lshl_b32 s49, s47, 10
  v_add_u32 v227, s49, v4
  v_add_u32 v169, 49152, v168
  v_add_u32 v170, 98304, v168
  v_add_u32 v172, 49152, v171
  v_add_u32 v173, 98304, v171
  v_add_u32 v225, 49152, v224
  v_add_u32 v226, 98304, v224
  v_add_u32 v228, 49152, v227
  v_add_u32 v229, 98304, v227
  s_cmp_ge_u32 s42, 4
  s_cbranch_scc1 L_S
  s_barrier
  v_mfma_f32_32x32x16_bf16 v[104:119], v[52:55], v[56:59], v[104:119]
  v_mfma_f32_32x32x16_bf16 v[104:119], v[60:63], v[64:67], v[104:119]
  v_mfma_f32_32x32x16_bf16 v[104:119], v[68:71], v[72:75], v[104:119]
  v_mfma_f32_32x32x16_bf16 v[104:119], v[76:79], v[80:83], v[104:119]
  s_waitcnt vmcnt(11)
  v_lshlrev_b32 v96, 16, v96
  s_nop 9
  v_cvt_pk_bf16_f32 v52, 0, v104
  v_cvt_pk_bf16_f32 v53, 0, v105
  v_cvt_pk_bf16_f32 v54, 0, v106
  v_cvt_pk_bf16_f32 v55, 0, v107
  v_cvt_pk_bf16_f32 v56, 0, v108
  v_cvt_pk_bf16_f32 v57, 0, v109
  v_cvt_pk_bf16_f32 v58, 0, v110
  v_cvt_pk_bf16_f32 v59, 0, v111
  v_cvt_pk_bf16_f32 v60, 0, v112
  v_cvt_pk_bf16_f32 v61, 0, v113
  v_cvt_pk_bf16_f32 v62, 0, v114
  v_cvt_pk_bf16_f32 v63, 0, v115
  v_cvt_pk_bf16_f32 v64, 0, v116
  v_cvt_pk_bf16_f32 v65, 0, v117
  v_cvt_pk_bf16_f32 v66, 0, v118
  v_cvt_pk_bf16_f32 v67, 0, v119
  v_pk_add_f32 v[52:53], v[52:53], v[96:97] op_sel_hi:[1,0]
  v_pk_add_f32 v[54:55], v[54:55], v[96:97] op_sel_hi:[1,0]
  v_pk_add_f32 v[56:57], v[56:57], v[96:97] op_sel_hi:[1,0]
  v_pk_add_f32 v[58:59], v[58:59], v[96:97] op_sel_hi:[1,0]
  v_pk_add_f32 v[60:61], v[60:61], v[96:97] op_sel_hi:[1,0]
  v_pk_add_f32 v[62:63], v[62:63], v[96:97] op_sel_hi:[1,0]
  v_pk_add_f32 v[64:65], v[64:65], v[96:97] op_sel_hi:[1,0]
  v_pk_add_f32 v[66:67], v[66:67], v[96:97] op_sel_hi:[1,0]
  v_cvt_pk_bf16_f32 v52, 0, v52
  v_cvt_pk_bf16_f32 v53, 0, v53
  v_cvt_pk_bf16_f32 v54, 0, v54
  v_cvt_pk_bf16_f32 v55, 0, v55
  v_cvt_pk_bf16_f32 v56, 0, v56
  v_cvt_pk_bf16_f32 v57, 0, v57
  v_cvt_pk_bf16_f32 v58, 0, v58
  v_cvt_pk_bf16_f32 v59, 0, v59
  v_cvt_pk_bf16_f32 v60, 0, v60
  v_cvt_pk_bf16_f32 v61, 0, v61
  v_cvt_pk_bf16_f32 v62, 0, v62
  v_cvt_pk_bf16_f32 v63, 0, v63
  v_cvt_pk_bf16_f32 v64, 0, v64
  v_cvt_pk_bf16_f32 v65, 0, v65
  v_cvt_pk_bf16_f32 v66, 0, v66
  v_cvt_pk_bf16_f32 v67, 0, v67
  v_pk_mul_f32 v[52:53], v[52:53], v[124:125]
  v_pk_mul_f32 v[54:55], v[54:55], v[126:127]
  v_pk_mul_f32 v[56:57], v[56:57], v[128:129]
  v_pk_mul_f32 v[58:59], v[58:59], v[130:131]
  v_pk_mul_f32 v[60:61], v[60:61], v[132:133]
  v_pk_mul_f32 v[62:63], v[62:63], v[134:135]
  v_pk_mul_f32 v[64:65], v[64:65], v[136:137]
  v_pk_mul_f32 v[66:67], v[66:67], v[138:139]
  v_cvt_pk_bf16_f32 v68, v52, v53
  v_cvt_pk_bf16_f32 v69, v54, v55
  v_cvt_pk_bf16_f32 v70, v56, v57
  v_cvt_pk_bf16_f32 v71, v58, v59
  v_cvt_pk_bf16_f32 v72, v60, v61
  v_cvt_pk_bf16_f32 v73, v62, v63
  v_cvt_pk_bf16_f32 v74, v64, v65
  v_cvt_pk_bf16_f32 v75, v66, v67
  s_mov_b32 s49, s72
  buffer_store_dwordx4 v[68:71], v4, s[12:15], s49 offen offset:0 sc1
  buffer_store_dwordx4 v[72:75], v4, s[12:15], s49 offen offset:1024 sc1
  s_waitcnt lgkmcnt(0)
  s_waitcnt vmcnt(2)
  s_cmp_lg_u32 s42, 0
  s_cbranch_scc1 L_CY_OK
  s_mov_b32 s50, 0
  s_branch L_CY_1
L_CY:
  s_waitcnt vmcnt(0)
L_CY_1:
  v_cmp_eq_u32 vcc, s63, v160
  s_add_u32 s50, s50, 1
  s_cmp_eq_u64 vcc, exec
  s_cbranch_scc1 L_CY_OK
  s_cmp_ge_u32 s50, 16384
  s_cbranch_scc1 L_CY_OK
  s_sleep 2
  buffer_load_dword v160, v250, s[12:15], s62 offen sc1
  s_branch L_CY
L_CY_OK:
  v_and_b32 v250, 7, v1
  v_min_u32 v250, 6, v250
  v_lshlrev_b32 v250, 7, v250
  s_barrier
  s_add_u32 m0, s48, 40960
  s_add_u32 s49, s56, 0
  buffer_load_dwordx4 v4, s[12:15], s49 offen sc1 lds
  s_add_u32 m0, s48, 98304
  s_add_u32 s49, s56, 8192
  buffer_load_dwordx4 v4, s[12:15], s49 offen sc1 lds
  s_add_u32 m0, s48, 106496
  s_add_u32 s49, s56, 16384
  buffer_load_dwordx4 v4, s[12:15], s49 offen sc1 lds
  s_add_u32 m0, s48, 114688
  s_add_u32 s49, s56, 24576
  buffer_load_dwordx4 v4, s[12:15], s49 offen sc1 lds
  s_add_u32 m0, s48, 122880
  s_add_u32 s49, s56, 32768
  buffer_load_dwordx4 v4, s[12:15], s49 offen sc1 lds
  s_add_u32 m0, s48, 131072
  s_add_u32 s49, s56, 40960
  buffer_load_dwordx4 v4, s[12:15], s49 offen sc1 lds
  s_add_u32 m0, s48, 139264
  s_add_u32 s49, s56, 49152
  buffer_load_dwordx4 v4, s[12:15], s49 offen sc1 lds
  s_mov_b32 s49, 19922944
  buffer_load_dwordx4 v[164:167], v4, s[12:15], s49 offen sc1
  s_waitcnt lgkmcnt(0)
  s_waitcnt vmcnt(8)
  s_barrier
  s_cmp_lg_u32 s42, 0
  s_cbranch_scc1 L_FH
  v_mov_b32 v249, s63
  s_mov_b64 exec, 1
  buffer_store_dword v249, v248, s[12:15], s74 offen sc1
  s_mov_b64 exec, -1
L_FH:
  s_waitcnt lgkmcnt(0)
  s_waitcnt vmcnt(7)
  s_barrier
  s_waitcnt lgkmcnt(0)
  s_waitcnt vmcnt(6)
  s_barrier
  s_add_u32 m0, s48, 40960
  s_add_u32 s49, s55, 229376
  buffer_load_dwordx4 v152, s[8:11], s49 offen lds
  s_add_u32 m0, s48, 49152
  s_add_u32 s49, s55, 286720
  buffer_load_dwordx4 v152, s[8:11], s49 offen lds
  s_waitcnt lgkmcnt(0)
  s_waitcnt vmcnt(7)
  s_barrier
  s_add_u32 m0, s48, 98304
  s_add_u32 s49, s55, 344064
  buffer_load_dwordx4 v152, s[8:11], s49 offen lds
  s_add_u32 m0, s48, 57344
  s_add_u32 s49, s55, 401408
  buffer_load_dwordx4 v152, s[8:11], s49 offen lds
  s_cmp_lg_u32 s42, 0
  s_cbranch_scc1 L_PH37
  buffer_load_dword v240, v250, s[12:15], s61 offen sc1
L_PH37:
  s_waitcnt lgkmcnt(0)
  s_waitcnt vmcnt(8)
  s_barrier
  s_cmp_lg_u32 s42, 0
  s_cbranch_scc1 L_PH38
  buffer_load_dword v241, v250, s[12:15], s61 offen sc1
L_PH38:
  s_waitcnt lgkmcnt(0)
  s_waitcnt vmcnt(7)
  s_barrier
  s_cmp_lg_u32 s42, 0
  s_cbranch_scc1 L_PH39
  buffer_load_dword v242, v250, s[12:15], s61 offen sc1
L_PH39:
  s_waitcnt lgkmcnt(0)
  s_waitcnt vmcnt(6)
  s_cmp_lg_u32 s42, 0
  s_cbranch_scc1 L_CH_OK
  s_mov_b32 s50, 0
  buffer_load_dword v243, v250, s[12:15], s61 offen sc1
L_CH:
  s_waitcnt vmcnt(3)
  v_cmp_eq_u32 vcc, s63, v240
  s_nop 0
  s_cmp_eq_u64 vcc, exec
  s_cbranch_scc1 L_CH_OK
  buffer_load_dword v240, v250, s[12:15], s61 offen sc1
  s_sleep 2
  s_waitcnt vmcnt(3)
  v_cmp_eq_u32 vcc, s63, v241
  s_nop 0
  s_cmp_eq_u64 vcc, exec
  s_cbranch_scc1 L_CH_OK
  buffer_load_dword v241, v250, s[12:15], s61 offen sc1
  s_sleep 2
  s_waitcnt vmcnt(3)
  v_cmp_eq_u32 vcc, s63, v242
  s_nop 0
  s_cmp_eq_u64 vcc, exec
  s_cbranch_scc1 L_CH_OK
  buffer_load_dword v242, v250, s[12:15], s61 offen sc1
  s_sleep 2
  s_waitcnt vmcnt(3)
  v_cmp_eq_u32 vcc, s63, v243
  s_nop 0
  s_cmp_eq_u64 vcc, exec
  s_cbranch_scc1 L_CH_OK
  buffer_load_dword v243, v250, s[12:15], s61 offen sc1
  s_sleep 2
  s_add_u32 s50, s50, 1
  s_cmp_lt_u32 s50, 16384
  s_cbranch_scc1 L_CH
L_CH_OK:
  s_barrier
  s_add_u32 m0, s48, 106496
  s_add_u32 s49, s54, 0
  buffer_load_dwordx4 v4, s[12:15], s49 offen sc1 lds
  s_add_u32 m0, s48, 65536
  s_add_u32 s49, s54, 4096
  buffer_load_dwordx4 v4, s[12:15], s49 offen sc1 lds
  s_add_u32 m0, s48, 114688
  s_add_u32 s49, s54, 8192
  buffer_load_dwordx4 v4, s[12:15], s49 offen sc1 lds
  s_add_u32 m0, s48, 73728
  s_add_u32 s49, s54, 12288
  buffer_load_dwordx4 v4, s[12:15], s49 offen sc1 lds
  s_add_u32 m0, s48, 122880
  s_add_u32 s49, s54, 16384
  buffer_load_dwordx4 v4, s[12:15], s49 offen sc1 lds
  s_add_u32 m0, s48, 81920
  s_add_u32 s49, s54, 20480
  buffer_load_dwordx4 v4, s[12:15], s49 offen sc1 lds
  s_waitcnt lgkmcnt(0)
  s_waitcnt vmcnt(11)
  s_barrier
  s_add_u32 m0, s48, 131072
  s_add_u32 s49, s54, 24576
  buffer_load_dwordx4 v4, s[12:15], s49 offen sc1 lds
  s_add_u32 m0, s48, 90112
  s_add_u32 s49, s54, 28672
  buffer_load_dwordx4 v4, s[12:15], s49 offen sc1 lds
  s_waitcnt lgkmcnt(0)
  s_barrier
  s_add_u32 m0, s48, 139264
  s_add_u32 s49, s55, 458752
  buffer_load_dwordx4 v152, s[8:11], s49 offen lds
  s_add_u32 m0, s48, 0
  s_add_u32 s49, s54, 32768
  buffer_load_dwordx4 v4, s[12:15], s49 offen sc1 lds
  s_waitcnt lgkmcnt(0)
  s_waitcnt vmcnt(8)
  s_barrier
  ds_read_b64_tr_b16 v[176:177], v168 offset:8192
  ds_read_b64_tr_b16 v[178:179], v168 offset:9216
  ds_read_b128 v[180:183], v173 offset:8192
  ds_read_b64_tr_b16 v[184:185], v168 offset:10240
  ds_read_b64_tr_b16 v[186:187], v168 offset:11264
  ds_read_b128 v[188:191], v173 offset:9216
  ds_read_b64_tr_b16 v[192:193], v168 offset:12288
  ds_read_b64_tr_b16 v[194:195], v168 offset:13312
  ds_read_b128 v[196:199], v173 offset:10240
  ds_read_b64_tr_b16 v[200:201], v168 offset:14336
  ds_read_b64_tr_b16 v[202:203], v168 offset:15360
  ds_read_b128 v[204:207], v173 offset:11264
  s_waitcnt lgkmcnt(0)
  s_waitcnt vmcnt(6)
  s_barrier
  v_mfma_f32_32x32x16_bf16 v[104:119], v[176:179], v[180:183], 0
  ds_read_b64_tr_b16 v[20:21], v168 offset:24576
  ds_read_b64_tr_b16 v[22:23], v168 offset:25600
  ds_read_b128 v[24:27], v173 offset:16384
  ds_read_b64_tr_b16 v[28:29], v168 offset:26624
  ds_read_b64_tr_b16 v[30:31], v168 offset:27648
  ds_read_b128 v[32:35], v173 offset:17408
  v_mfma_f32_32x32x16_bf16 v[104:119], v[184:187], v[188:191], v[104:119]
  ds_read_b64_tr_b16 v[36:37], v168 offset:28672
  ds_read_b64_tr_b16 v[38:39], v168 offset:29696
  ds_read_b128 v[40:43], v173 offset:18432
  ds_read_b64_tr_b16 v[44:45], v168 offset:30720
  ds_read_b64_tr_b16 v[46:47], v168 offset:31744
  ds_read_b128 v[48:51], v173 offset:19456
  v_mfma_f32_32x32x16_bf16 v[104:119], v[192:195], v[196:199], v[104:119]
  s_add_u32 m0, s48, 8192
  s_add_u32 s49, s55, 516096
  buffer_load_dwordx4 v152, s[8:11], s49 offen lds
  s_add_u32 m0, s48, 16384
  s_add_u32 s49, s54, 36864
  buffer_load_dwordx4 v4, s[12:15], s49 offen sc1 lds
  s_add_u32 m0, s48, 106496
  s_add_u32 s49, s55, 573440
  buffer_load_dwordx4 v152, s[8:11], s49 offen lds
  s_add_u32 m0, s48, 65536
  s_add_u32 s49, s54, 40960
  buffer_load_dwordx4 v4, s[12:15], s49 offen sc1 lds
  v_mfma_f32_32x32x16_bf16 v[104:119], v[200:203], v[204:207], v[104:119]
  s_waitcnt lgkmcnt(0)
  s_waitcnt vmcnt(8)
  s_barrier
  v_mfma_f32_32x32x16_bf16 v[104:119], v[20:23], v[24:27], v[104:119]
  ds_read_b64_tr_b16 v[176:177], v168 offset:40960
  ds_read_b64_tr_b16 v[178:179], v168 offset:41984
  ds_read_b128 v[180:183], v173 offset:24576
  ds_read_b64_tr_b16 v[184:185], v168 offset:43008
  ds_read_b64_tr_b16 v[186:187], v168 offset:44032
  ds_read_b128 v[188:191], v173 offset:25600
  v_mfma_f32_32x32x16_bf16 v[104:119], v[28:31], v[32:35], v[104:119]
  ds_read_b64_tr_b16 v[192:193], v168 offset:45056
  ds_read_b64_tr_b16 v[194:195], v168 offset:46080
  ds_read_b128 v[196:199], v173 offset:26624
  ds_read_b64_tr_b16 v[200:201], v168 offset:47104
  ds_read_b64_tr_b16 v[202:203], v168 offset:48128
  ds_read_b128 v[204:207], v173 offset:27648
  v_mfma_f32_32x32x16_bf16 v[104:119], v[36:39], v[40:43], v[104:119]
  s_add_u32 m0, s48, 24576
  s_add_u32 s49, s55, 630784
  buffer_load_dwordx4 v152, s[8:11], s49 offen lds
  s_add_u32 m0, s48, 32768
  s_add_u32 s49, s54, 45056
  buffer_load_dwordx4 v4, s[12:15], s49 offen sc1 lds
  s_add_u32 m0, s48, 114688
  s_add_u32 s49, s55, 688128
  buffer_load_dwordx4 v152, s[8:11], s49 offen lds
  s_add_u32 m0, s48, 73728
  s_add_u32 s49, s54, 49152
  buffer_load_dwordx4 v4, s[12:15], s49 offen sc1 lds
  v_mfma_f32_32x32x16_bf16 v[104:119], v[44:47], v[48:51], v[104:119]
  s_waitcnt lgkmcnt(0)
  s_waitcnt vmcnt(10)
  s_barrier
  v_mfma_f32_32x32x16_bf16 v[104:119], v[176:179], v[180:183], v[104:119]
  ds_read_b64_tr_b16 v[20:21], v170 offset:0
  ds_read_b64_tr_b16 v[22:23], v170 offset:1024
  ds_read_b128 v[24:27], v173 offset:32768
  ds_read_b64_tr_b16 v[28:29], v170 offset:2048
  ds_read_b64_tr_b16 v[30:31], v170 offset:3072
  ds_read_b128 v[32:35], v173 offset:33792
  v_mfma_f32_32x32x16_bf16 v[104:119], v[184:187], v[188:191], v[104:119]
  ds_read_b64_tr_b16 v[36:37], v170 offset:4096
  ds_read_b64_tr_b16 v[38:39], v170 offset:5120
  ds_read_b128 v[40:43], v173 offset:34816
  ds_read_b64_tr_b16 v[44:45], v170 offset:6144
  ds_read_b64_tr_b16 v[46:47], v170 offset:7168
  ds_read_b128 v[48:51], v173 offset:35840
  v_mfma_f32_32x32x16_bf16 v[104:119], v[192:195], v[196:199], v[104:119]
  s_add_u32 m0, s48, 40960
  s_add_u32 s49, s55, 745472
  buffer_load_dwordx4 v152, s[8:11], s49 offen lds
  s_add_u32 m0, s48, 49152
  s_add_u32 s49, s54, 53248
  buffer_load_dwordx4 v4, s[12:15], s49 offen sc1 lds
  v_mfma_f32_32x32x16_bf16 v[104:119], v[200:203], v[204:207], v[104:119]
  s_waitcnt lgkmcnt(0)
  s_waitcnt vmcnt(8)
  s_barrier
  v_mfma_f32_32x32x16_bf16 v[104:119], v[20:23], v[24:27], v[104:119]
  ds_read_b64_tr_b16 v[176:177], v170 offset:40960
  ds_read_b64_tr_b16 v[178:179], v170 offset:41984
  ds_read_b128 v[180:183], v171 offset:0
  ds_read_b64_tr_b16 v[184:185], v170 offset:43008
  ds_read_b64_tr_b16 v[186:187], v170 offset:44032
  ds_read_b128 v[188:191], v171 offset:1024
  v_mfma_f32_32x32x16_bf16 v[104:119], v[28:31], v[32:35], v[104:119]
  ds_read_b64_tr_b16 v[192:193], v170 offset:45056
  ds_read_b64_tr_b16 v[194:195], v170 offset:46080
  ds_read_b128 v[196:199], v171 offset:2048
  ds_read_b64_tr_b16 v[200:201], v170 offset:47104
  ds_read_b64_tr_b16 v[202:203], v170 offset:48128
  ds_read_b128 v[204:207], v171 offset:3072
  v_mfma_f32_32x32x16_bf16 v[104:119], v[36:39], v[40:43], v[104:119]
  v_mfma_f32_32x32x16_bf16 v[104:119], v[44:47], v[48:51], v[104:119]
  s_waitcnt lgkmcnt(0)
  s_waitcnt vmcnt(4)
  s_barrier
  v_mfma_f32_32x32x16_bf16 v[104:119], v[176:179], v[180:183], v[104:119]
  ds_read_b64_tr_b16 v[20:21], v170 offset:8192
  ds_read_b64_tr_b16 v[22:23], v170 offset:9216
  ds_read_b128 v[24:27], v172 offset:16384
  ds_read_b64_tr_b16 v[28:29], v170 offset:10240
  ds_read_b64_tr_b16 v[30:31], v170 offset:11264
  ds_read_b128 v[32:35], v172 offset:17408
  v_mfma_f32_32x32x16_bf16 v[104:119], v[184:187], v[188:191], v[104:119]
  ds_read_b64_tr_b16 v[36:37], v170 offset:12288
  ds_read_b64_tr_b16 v[38:39], v170 offset:13312
  ds_read_b128 v[40:43], v172 offset:18432
  ds_read_b64_tr_b16 v[44:45], v170 offset:14336
  ds_read_b64_tr_b16 v[46:47], v170 offset:15360
  ds_read_b128 v[48:51], v172 offset:19456
  v_mfma_f32_32x32x16_bf16 v[104:119], v[192:195], v[196:199], v[104:119]
  v_mfma_f32_32x32x16_bf16 v[104:119], v[200:203], v[204:207], v[104:119]
  s_waitcnt lgkmcnt(0)
  s_waitcnt vmcnt(0)
  s_barrier
  v_mfma_f32_32x32x16_bf16 v[104:119], v[20:23], v[24:27], v[104:119]
  ds_read_b64_tr_b16 v[176:177], v170 offset:16384
  ds_read_b64_tr_b16 v[178:179], v170 offset:17408
  ds_read_b128 v[180:183], v172 offset:24576
  ds_read_b64_tr_b16 v[184:185], v170 offset:18432
  ds_read_b64_tr_b16 v[186:187], v170 offset:19456
  ds_read_b128 v[188:191], v172 offset:25600
  v_mfma_f32_32x32x16_bf16 v[104:119], v[28:31], v[32:35], v[104:119]
  ds_read_b64_tr_b16 v[192:193], v170 offset:20480
  ds_read_b64_tr_b16 v[194:195], v170 offset:21504
  ds_read_b128 v[196:199], v172 offset:26624
  ds_read_b64_tr_b16 v[200:201], v170 offset:22528
  ds_read_b64_tr_b16 v[202:203], v170 offset:23552
  ds_read_b128 v[204:207], v172 offset:27648
  v_mfma_f32_32x32x16_bf16 v[104:119], v[36:39], v[40:43], v[104:119]
  v_mfma_f32_32x32x16_bf16 v[104:119], v[44:47], v[48:51], v[104:119]
  s_waitcnt lgkmcnt(0)
  s_barrier
  v_mfma_f32_32x32x16_bf16 v[104:119], v[176:179], v[180:183], v[104:119]
  v_mfma_f32_32x32x16_bf16 v[104:119], v[184:187], v[188:191], v[104:119]
  v_mfma_f32_32x32x16_bf16 v[104:119], v[192:195], v[196:199], v[104:119]
  v_mfma_f32_32x32x16_bf16 v[104:119], v[200:203], v[204:207], v[104:119]
  v_and_b32 v100, 31, v1
  s_lshl_b32 s49, s46, 5
  v_add_u32 v100, s49, v100
  v_lshrrev_b32 v101, 5, v1
  v_mul_u32_u24 v100, 272, v100
  v_lshl_add_u32 v100, v101, 4, v100
  s_lshl_b32 s49, s47, 7
  s_add_u32 s49, s49, 0
  v_add_u32 v100, s49, v100
  s_nop 2
  ds_write_b128 v100, v[104:107] offset:0
  ds_write_b128 v100, v[108:111] offset:32
  ds_write_b128 v100, v[112:115] offset:64
  ds_write_b128 v100, v[116:119] offset:96
  s_branch L_J3
L_S:
  s_barrier
  v_mfma_f32_32x32x16_bf16 v[104:119], v[52:55], v[56:59], v[104:119]
  v_mfma_f32_32x32x16_bf16 v[104:119], v[60:63], v[64:67], v[104:119]
  v_mfma_f32_32x32x16_bf16 v[104:119], v[68:71], v[72:75], v[104:119]
  v_mfma_f32_32x32x16_bf16 v[104:119], v[76:79], v[80:83], v[104:119]
  s_waitcnt vmcnt(11)
  v_lshlrev_b32 v96, 16, v96
  s_nop 9
  v_cvt_pk_bf16_f32 v52, 0, v104
  v_cvt_pk_bf16_f32 v53, 0, v105
  v_cvt_pk_bf16_f32 v54, 0, v106
  v_cvt_pk_bf16_f32 v55, 0, v107
  v_cvt_pk_bf16_f32 v56, 0, v108
  v_cvt_pk_bf16_f32 v57, 0, v109
  v_cvt_pk_bf16_f32 v58, 0, v110
  v_cvt_pk_bf16_f32 v59, 0, v111
  v_cvt_pk_bf16_f32 v60, 0, v112
  v_cvt_pk_bf16_f32 v61, 0, v113
  v_cvt_pk_bf16_f32 v62, 0, v114
  v_cvt_pk_bf16_f32 v63, 0, v115
  v_cvt_pk_bf16_f32 v64, 0, v116
  v_cvt_pk_bf16_f32 v65, 0, v117
  v_cvt_pk_bf16_f32 v66, 0, v118
  v_cvt_pk_bf16_f32 v67, 0, v119
  v_pk_add_f32 v[52:53], v[52:53], v[96:97] op_sel_hi:[1,0]
  v_pk_add_f32 v[54:55], v[54:55], v[96:97] op_sel_hi:[1,0]
  v_pk_add_f32 v[56:57], v[56:57], v[96:97] op_sel_hi:[1,0]
  v_pk_add_f32 v[58:59], v[58:59], v[96:97] op_sel_hi:[1,0]
  v_pk_add_f32 v[60:61], v[60:61], v[96:97] op_sel_hi:[1,0]
  v_pk_add_f32 v[62:63], v[62:63], v[96:97] op_sel_hi:[1,0]
  v_pk_add_f32 v[64:65], v[64:65], v[96:97] op_sel_hi:[1,0]
  v_pk_add_f32 v[66:67], v[66:67], v[96:97] op_sel_hi:[1,0]
  v_cvt_pk_bf16_f32 v52, 0, v52
  v_cvt_pk_bf16_f32 v53, 0, v53
  v_cvt_pk_bf16_f32 v54, 0, v54
  v_cvt_pk_bf16_f32 v55, 0, v55
  v_cvt_pk_bf16_f32 v56, 0, v56
  v_cvt_pk_bf16_f32 v57, 0, v57
  v_cvt_pk_bf16_f32 v58, 0, v58
  v_cvt_pk_bf16_f32 v59, 0, v59
  v_cvt_pk_bf16_f32 v60, 0, v60
  v_cvt_pk_bf16_f32 v61, 0, v61
  v_cvt_pk_bf16_f32 v62, 0, v62
  v_cvt_pk_bf16_f32 v63, 0, v63
  v_cvt_pk_bf16_f32 v64, 0, v64
  v_cvt_pk_bf16_f32 v65, 0, v65
  v_cvt_pk_bf16_f32 v66, 0, v66
  v_cvt_pk_bf16_f32 v67, 0, v67
  v_pk_mul_f32 v[52:53], v[52:53], v[124:125]
  v_pk_mul_f32 v[54:55], v[54:55], v[126:127]
  v_pk_mul_f32 v[56:57], v[56:57], v[128:129]
  v_pk_mul_f32 v[58:59], v[58:59], v[130:131]
  v_pk_mul_f32 v[60:61], v[60:61], v[132:133]
  v_pk_mul_f32 v[62:63], v[62:63], v[134:135]
  v_pk_mul_f32 v[64:65], v[64:65], v[136:137]
  v_pk_mul_f32 v[66:67], v[66:67], v[138:139]
  v_cvt_pk_bf16_f32 v68, v52, v53
  v_cvt_pk_bf16_f32 v69, v54, v55
  v_cvt_pk_bf16_f32 v70, v56, v57
  v_cvt_pk_bf16_f32 v71, v58, v59
  v_cvt_pk_bf16_f32 v72, v60, v61
  v_cvt_pk_bf16_f32 v73, v62, v63
  v_cvt_pk_bf16_f32 v74, v64, v65
  v_cvt_pk_bf16_f32 v75, v66, v67
  s_mov_b32 s49, s72
  buffer_store_dwordx4 v[68:71], v4, s[12:15], s49 offen offset:0 sc1
  buffer_store_dwordx4 v[72:75], v4, s[12:15], s49 offen offset:1024 sc1
  s_waitcnt lgkmcnt(0)
  s_barrier
  s_add_u32 m0, s48, 40960
  s_add_u32 s49, s56, 0
  buffer_load_dwordx4 v4, s[12:15], s49 offen sc1 lds
  s_add_u32 m0, s48, 98304
  s_add_u32 s49, s56, 8192
  buffer_load_dwordx4 v4, s[12:15], s49 offen sc1 lds
  s_add_u32 m0, s48, 106496
  s_add_u32 s49, s56, 16384
  buffer_load_dwordx4 v4, s[12:15], s49 offen sc1 lds
  s_add_u32 m0, s48, 114688
  s_add_u32 s49, s56, 24576
  buffer_load_dwordx4 v4, s[12:15], s49 offen sc1 lds
  s_add_u32 m0, s48, 122880
  s_add_u32 s49, s56, 32768
  buffer_load_dwordx4 v4, s[12:15], s49 offen sc1 lds
  s_add_u32 m0, s48, 131072
  s_add_u32 s49, s56, 40960
  buffer_load_dwordx4 v4, s[12:15], s49 offen sc1 lds
  s_add_u32 m0, s48, 139264
  s_add_u32 s49, s56, 49152
  buffer_load_dwordx4 v4, s[12:15], s49 offen sc1 lds
  s_mov_b32 s49, 19922944
  buffer_load_dwordx4 v[164:167], v4, s[12:15], s49 offen sc1
  s_waitcnt lgkmcnt(0)
  s_waitcnt vmcnt(8)
  s_barrier
  s_waitcnt lgkmcnt(0)
  s_waitcnt vmcnt(7)
  s_barrier
  ds_read_b64_tr_b16 v[176:177], v224 offset:40960
  ds_read_b64_tr_b16 v[178:179], v224 offset:41472
  ds_read_b128 v[180:183], v228 offset:0
  ds_read_b64_tr_b16 v[184:185], v224 offset:43008
  ds_read_b64_tr_b16 v[186:187], v224 offset:43520
  ds_read_b128 v[188:191], v228 offset:2048
  ds_read_b64_tr_b16 v[192:193], v224 offset:45056
  ds_read_b64_tr_b16 v[194:195], v224 offset:45568
  ds_read_b128 v[196:199], v228 offset:4096
  ds_read_b64_tr_b16 v[200:201], v224 offset:47104
  ds_read_b64_tr_b16 v[202:203], v224 offset:47616
  ds_read_b128 v[204:207], v228 offset:6144
  s_waitcnt lgkmcnt(0)
  s_waitcnt vmcnt(6)
  s_barrier
  v_mfma_f32_32x32x16_f16 v[208:223], v[180:183], v[176:179], 0
  ds_read_b64_tr_b16 v[20:21], v226 offset:0
  ds_read_b64_tr_b16 v[22:23], v226 offset:512
  ds_read_b128 v[24:27], v228 offset:8192
  ds_read_b64_tr_b16 v[28:29], v226 offset:2048
  ds_read_b64_tr_b16 v[30:31], v226 offset:2560
  ds_read_b128 v[32:35], v228 offset:10240
  v_mfma_f32_32x32x16_f16 v[208:223], v[188:191], v[184:187], v[208:223]
  ds_read_b64_tr_b16 v[36:37], v226 offset:4096
  ds_read_b64_tr_b16 v[38:39], v226 offset:4608
  ds_read_b128 v[40:43], v228 offset:12288
  ds_read_b64_tr_b16 v[44:45], v226 offset:6144
  ds_read_b64_tr_b16 v[46:47], v226 offset:6656
  ds_read_b128 v[48:51], v228 offset:14336
  v_mfma_f32_32x32x16_f16 v[208:223], v[196:199], v[192:195], v[208:223]
  s_add_u32 m0, s48, 40960
  s_add_u32 s49, s55, 229376
  buffer_load_dwordx4 v152, s[8:11], s49 offen lds
  s_add_u32 m0, s48, 49152
  s_add_u32 s49, s55, 286720
  buffer_load_dwordx4 v152, s[8:11], s49 offen lds
  v_mfma_f32_32x32x16_f16 v[208:223], v[204:207], v[200:203], v[208:223]
  s_waitcnt lgkmcnt(0)
  s_waitcnt vmcnt(7)
  s_barrier
  v_mfma_f32_32x32x16_f16 v[208:223], v[24:27], v[20:23], v[208:223]
  ds_read_b64_tr_b16 v[176:177], v226 offset:8192
  ds_read_b64_tr_b16 v[178:179], v226 offset:8704
  ds_read_b128 v[180:183], v228 offset:16384
  ds_read_b64_tr_b16 v[184:185], v226 offset:10240
  ds_read_b64_tr_b16 v[186:187], v226 offset:10752
  ds_read_b128 v[188:191], v228 offset:18432
  v_mfma_f32_32x32x16_f16 v[208:223], v[32:35], v[28:31], v[208:223]
  ds_read_b64_tr_b16 v[192:193], v226 offset:12288
  ds_read_b64_tr_b16 v[194:195], v226 offset:12800
  ds_read_b128 v[196:199], v228 offset:20480
  ds_read_b64_tr_b16 v[200:201], v226 offset:14336
  ds_read_b64_tr_b16 v[202:203], v226 offset:14848
  ds_read_b128 v[204:207], v228 offset:22528
  v_mfma_f32_32x32x16_f16 v[208:223], v[40:43], v[36:39], v[208:223]
  s_add_u32 m0, s48, 98304
  s_add_u32 s49, s55, 344064
  buffer_load_dwordx4 v152, s[8:11], s49 offen lds
  s_add_u32 m0, s48, 57344
  s_add_u32 s49, s55, 401408
  buffer_load_dwordx4 v152, s[8:11], s49 offen lds
  v_mfma_f32_32x32x16_f16 v[208:223], v[48:51], v[44:47], v[208:223]
  s_waitcnt lgkmcnt(0)
  s_waitcnt vmcnt(8)
  s_barrier
  v_mfma_f32_32x32x16_f16 v[208:223], v[180:183], v[176:179], v[208:223]
  ds_read_b64_tr_b16 v[20:21], v226 offset:16384
  ds_read_b64_tr_b16 v[22:23], v226 offset:16896
  ds_read_b128 v[24:27], v228 offset:24576
  ds_read_b64_tr_b16 v[28:29], v226 offset:18432
  ds_read_b64_tr_b16 v[30:31], v226 offset:18944
  ds_read_b128 v[32:35], v228 offset:26624
  v_mfma_f32_32x32x16_f16 v[208:223], v[188:191], v[184:187], v[208:223]
  ds_read_b64_tr_b16 v[36:37], v226 offset:20480
  ds_read_b64_tr_b16 v[38:39], v226 offset:20992
  ds_read_b128 v[40:43], v228 offset:28672
  ds_read_b64_tr_b16 v[44:45], v226 offset:22528
  ds_read_b64_tr_b16 v[46:47], v226 offset:23040
  ds_read_b128 v[48:51], v228 offset:30720
  v_mfma_f32_32x32x16_f16 v[208:223], v[196:199], v[192:195], v[208:223]
  v_mfma_f32_32x32x16_f16 v[208:223], v[204:207], v[200:203], v[208:223]
  s_waitcnt lgkmcnt(0)
  s_waitcnt vmcnt(7)
  s_barrier
  v_mfma_f32_32x32x16_f16 v[208:223], v[24:27], v[20:23], v[208:223]
  ds_read_b64_tr_b16 v[176:177], v226 offset:24576
  ds_read_b64_tr_b16 v[178:179], v226 offset:25088
  ds_read_b128 v[180:183], v228 offset:32768
  ds_read_b64_tr_b16 v[184:185], v226 offset:26624
  ds_read_b64_tr_b16 v[186:187], v226 offset:27136
  ds_read_b128 v[188:191], v228 offset:34816
  v_mfma_f32_32x32x16_f16 v[208:223], v[32:35], v[28:31], v[208:223]
  ds_read_b64_tr_b16 v[192:193], v226 offset:28672
  ds_read_b64_tr_b16 v[194:195], v226 offset:29184
  ds_read_b128 v[196:199], v228 offset:36864
  ds_read_b64_tr_b16 v[200:201], v226 offset:30720
  ds_read_b64_tr_b16 v[202:203], v226 offset:31232
  ds_read_b128 v[204:207], v228 offset:38912
  v_mfma_f32_32x32x16_f16 v[208:223], v[40:43], v[36:39], v[208:223]
  v_mfma_f32_32x32x16_f16 v[208:223], v[48:51], v[44:47], v[208:223]
  s_waitcnt lgkmcnt(0)
  s_waitcnt vmcnt(6)
  s_barrier
  v_mfma_f32_32x32x16_f16 v[208:223], v[180:183], v[176:179], v[208:223]
  ds_read_b64_tr_b16 v[20:21], v226 offset:32768
  ds_read_b64_tr_b16 v[22:23], v226 offset:33280
  ds_read_b128 v[24:27], v228 offset:40960
  ds_read_b64_tr_b16 v[28:29], v226 offset:34816
  ds_read_b64_tr_b16 v[30:31], v226 offset:35328
  ds_read_b128 v[32:35], v228 offset:43008
  v_mfma_f32_32x32x16_f16 v[208:223], v[188:191], v[184:187], v[208:223]
  ds_read_b64_tr_b16 v[36:37], v226 offset:36864
  ds_read_b64_tr_b16 v[38:39], v226 offset:37376
  ds_read_b128 v[40:43], v228 offset:45056
  ds_read_b64_tr_b16 v[44:45], v226 offset:38912
  ds_read_b64_tr_b16 v[46:47], v226 offset:39424
  ds_read_b128 v[48:51], v228 offset:47104
  v_mfma_f32_32x32x16_f16 v[208:223], v[196:199], v[192:195], v[208:223]
  s_add_u32 m0, s48, 106496
  s_add_u32 s49, s54, 0
  buffer_load_dwordx4 v4, s[12:15], s49 offen sc1 lds
  s_add_u32 m0, s48, 65536
  s_add_u32 s49, s54, 4096
  buffer_load_dwordx4 v4, s[12:15], s49 offen sc1 lds
  s_add_u32 m0, s48, 114688
  s_add_u32 s49, s54, 8192
  buffer_load_dwordx4 v4, s[12:15], s49 offen sc1 lds
  s_add_u32 m0, s48, 73728
  s_add_u32 s49, s54, 12288
  buffer_load_dwordx4 v4, s[12:15], s49 offen sc1 lds
  s_add_u32 m0, s48, 122880
  s_add_u32 s49, s54, 16384
  buffer_load_dwordx4 v4, s[12:15], s49 offen sc1 lds
  s_add_u32 m0, s48, 81920
  s_add_u32 s49, s54, 20480
  buffer_load_dwordx4 v4, s[12:15], s49 offen sc1 lds
  v_mfma_f32_32x32x16_f16 v[208:223], v[204:207], v[200:203], v[208:223]
  s_waitcnt lgkmcnt(0)
  s_waitcnt vmcnt(11)
  s_barrier
  v_mfma_f32_32x32x16_f16 v[208:223], v[24:27], v[20:23], v[208:223]
  ds_read_b64_tr_b16 v[176:177], v226 offset:40960
  ds_read_b64_tr_b16 v[178:179], v226 offset:41472
  ds_read_b128 v[180:183], v227 offset:0
  ds_read_b64_tr_b16 v[184:185], v226 offset:43008
  ds_read_b64_tr_b16 v[186:187], v226 offset:43520
  ds_read_b128 v[188:191], v227 offset:2048
  v_mfma_f32_32x32x16_f16 v[208:223], v[32:35], v[28:31], v[208:223]
  ds_read_b64_tr_b16 v[192:193], v226 offset:45056
  ds_read_b64_tr_b16 v[194:195], v226 offset:45568
  ds_read_b128 v[196:199], v227 offset:4096
  ds_read_b64_tr_b16 v[200:201], v226 offset:47104
  ds_read_b64_tr_b16 v[202:203], v226 offset:47616
  ds_read_b128 v[204:207], v227 offset:6144
  v_mfma_f32_32x32x16_f16 v[208:223], v[40:43], v[36:39], v[208:223]
  s_add_u32 m0, s48, 131072
  s_add_u32 s49, s54, 24576
  buffer_load_dwordx4 v4, s[12:15], s49 offen sc1 lds
  s_add_u32 m0, s48, 90112
  s_add_u32 s49, s54, 28672
  buffer_load_dwordx4 v4, s[12:15], s49 offen sc1 lds
  v_mfma_f32_32x32x16_f16 v[208:223], v[48:51], v[44:47], v[208:223]
  s_waitcnt lgkmcnt(0)
  s_barrier
  v_mfma_f32_32x32x16_f16 v[208:223], v[180:183], v[176:179], v[208:223]
  v_mfma_f32_32x32x16_f16 v[208:223], v[188:191], v[184:187], v[208:223]
  v_mfma_f32_32x32x16_f16 v[208:223], v[196:199], v[192:195], v[208:223]
  s_add_u32 m0, s48, 139264
  s_add_u32 s49, s55, 458752
  buffer_load_dwordx4 v152, s[8:11], s49 offen lds
  s_add_u32 m0, s48, 0
  s_add_u32 s49, s54, 32768
  buffer_load_dwordx4 v4, s[12:15], s49 offen sc1 lds
  v_mfma_f32_32x32x16_f16 v[208:223], v[204:207], v[200:203], v[208:223]
  s_waitcnt lgkmcnt(0)
  s_waitcnt vmcnt(8)
  s_barrier
  ds_read_b64_tr_b16 v[176:177], v168 offset:16384
  ds_read_b64_tr_b16 v[178:179], v168 offset:17408
  ds_read_b128 v[180:183], v172 offset:16384
  ds_read_b64_tr_b16 v[184:185], v168 offset:18432
  ds_read_b64_tr_b16 v[186:187], v168 offset:19456
  ds_read_b128 v[188:191], v172 offset:17408
  ds_read_b64_tr_b16 v[192:193], v168 offset:20480
  ds_read_b64_tr_b16 v[194:195], v168 offset:21504
  ds_read_b128 v[196:199], v172 offset:18432
  ds_read_b64_tr_b16 v[200:201], v168 offset:22528
  ds_read_b64_tr_b16 v[202:203], v168 offset:23552
  ds_read_b128 v[204:207], v172 offset:19456
  v_max_u32 v164, v164, v165
  v_max3_u32 v164, v164, v166, v167
  s_nop 1
  v_max_u32_dpp v164, v164, v164 quad_perm:[1,0,3,2] row_mask:0xf bank_mask:0xf
  s_nop 1
  v_max_u32_dpp v164, v164, v164 quad_perm:[2,3,0,1] row_mask:0xf bank_mask:0xf
  s_nop 1
  v_max_u32_dpp v164, v164, v164 row_half_mirror row_mask:0xf bank_mask:0xf
  s_nop 1
  v_max_u32_dpp v164, v164, v164 row_mirror row_mask:0xf bank_mask:0xf
  s_nop 0
  v_readlane_b32 s28, v164, 0
  v_readlane_b32 s29, v164, 16
  v_readlane_b32 s30, v164, 32
  v_readlane_b32 s31, v164, 48
  s_max_u32 s28, s28, s29
  s_max_u32 s30, s30, s31
  s_max_u32 s28, s28, s30
  s_lshr_b32 s28, s28, 7
  s_max_u32 s28, s28, 2
  s_min_u32 s28, s28, 252
  s_lshl_b32 s28, s28, 23
  v_mov_b32 v174, 0x3d124925
  v_mul_f32 v174, s28, v174
  s_waitcnt lgkmcnt(0)
  s_waitcnt vmcnt(6)
  s_barrier
  v_mfma_f32_32x32x16_bf16 v[104:119], v[176:179], v[180:183], 0
  ds_read_b64_tr_b16 v[20:21], v168 offset:32768
  ds_read_b64_tr_b16 v[22:23], v168 offset:33792
  ds_read_b128 v[24:27], v172 offset:24576
  ds_read_b64_tr_b16 v[28:29], v168 offset:34816
  ds_read_b64_tr_b16 v[30:31], v168 offset:35840
  ds_read_b128 v[32:35], v172 offset:25600
  v_mfma_f32_32x32x16_bf16 v[104:119], v[184:187], v[188:191], v[104:119]
  ds_read_b64_tr_b16 v[36:37], v168 offset:36864
  ds_read_b64_tr_b16 v[38:39], v168 offset:37888
  ds_read_b128 v[40:43], v172 offset:26624
  ds_read_b64_tr_b16 v[44:45], v168 offset:38912
  ds_read_b64_tr_b16 v[46:47], v168 offset:39936
  ds_read_b128 v[48:51], v172 offset:27648
  v_mfma_f32_32x32x16_bf16 v[104:119], v[192:195], v[196:199], v[104:119]
  s_add_u32 m0, s48, 8192
  s_add_u32 s49, s55, 516096
  buffer_load_dwordx4 v152, s[8:11], s49 offen lds
  s_add_u32 m0, s48, 16384
  s_add_u32 s49, s54, 36864
  buffer_load_dwordx4 v4, s[12:15], s49 offen sc1 lds
  s_add_u32 m0, s48, 106496
  s_add_u32 s49, s55, 573440
  buffer_load_dwordx4 v152, s[8:11], s49 offen lds
  s_add_u32 m0, s48, 65536
  s_add_u32 s49, s54, 40960
  buffer_load_dwordx4 v4, s[12:15], s49 offen sc1 lds
  v_mfma_f32_32x32x16_bf16 v[104:119], v[200:203], v[204:207], v[104:119]
  v_mul_f32 v208, v208, v174
  v_mul_f32 v209, v209, v174
  v_mul_f32 v210, v210, v174
  v_mul_f32 v211, v211, v174
  v_mul_f32 v212, v212, v174
  v_mul_f32 v213, v213, v174
  v_mul_f32 v214, v214, v174
  v_mul_f32 v215, v215, v174
  v_mul_f32 v216, v216, v174
  v_mul_f32 v217, v217, v174
  v_mul_f32 v218, v218, v174
  v_mul_f32 v219, v219, v174
  v_mul_f32 v220, v220, v174
  v_mul_f32 v221, v221, v174
  v_mul_f32 v222, v222, v174
  v_mul_f32 v223, v223, v174
  v_cvt_pk_bf16_f32 v88, v208, v209
  v_cvt_pk_bf16_f32 v89, v210, v211
  v_cvt_pk_bf16_f32 v90, v212, v213
  v_cvt_pk_bf16_f32 v91, v214, v215
  v_cvt_pk_bf16_f32 v92, v216, v217
  v_cvt_pk_bf16_f32 v93, v218, v219
  v_cvt_pk_bf16_f32 v94, v220, v221
  v_cvt_pk_bf16_f32 v95, v222, v223
  s_waitcnt lgkmcnt(0)
  s_waitcnt vmcnt(8)
  s_barrier
  v_mfma_f32_32x32x16_bf16 v[104:119], v[20:23], v[24:27], v[104:119]
  ds_read_b64_tr_b16 v[176:177], v169 offset:0
  ds_read_b64_tr_b16 v[178:179], v169 offset:1024
  ds_read_b128 v[180:183], v172 offset:32768
  ds_read_b64_tr_b16 v[184:185], v169 offset:2048
  ds_read_b64_tr_b16 v[186:187], v169 offset:3072
  ds_read_b128 v[188:191], v172 offset:33792
  v_mfma_f32_32x32x16_bf16 v[104:119], v[28:31], v[32:35], v[104:119]
  ds_read_b64_tr_b16 v[192:193], v169 offset:4096
  ds_read_b64_tr_b16 v[194:195], v169 offset:5120
  ds_read_b128 v[196:199], v172 offset:34816
  ds_read_b64_tr_b16 v[200:201], v169 offset:6144
  ds_read_b64_tr_b16 v[202:203], v169 offset:7168
  ds_read_b128 v[204:207], v172 offset:35840
  v_mfma_f32_32x32x16_bf16 v[104:119], v[36:39], v[40:43], v[104:119]
  s_add_u32 m0, s48, 24576
  s_add_u32 s49, s55, 630784
  buffer_load_dwordx4 v152, s[8:11], s49 offen lds
  s_add_u32 m0, s48, 32768
  s_add_u32 s49, s54, 45056
  buffer_load_dwordx4 v4, s[12:15], s49 offen sc1 lds
  s_add_u32 m0, s48, 114688
  s_add_u32 s49, s55, 688128
  buffer_load_dwordx4 v152, s[8:11], s49 offen lds
  s_add_u32 m0, s48, 73728
  s_add_u32 s49, s54, 49152
  buffer_load_dwordx4 v4, s[12:15], s49 offen sc1 lds
  v_mfma_f32_32x32x16_bf16 v[104:119], v[44:47], v[48:51], v[104:119]
  s_waitcnt lgkmcnt(0)
  s_waitcnt vmcnt(10)
  s_barrier
  v_mfma_f32_32x32x16_bf16 v[104:119], v[176:179], v[180:183], v[104:119]
  ds_read_b64_tr_b16 v[20:21], v169 offset:8192
  ds_read_b64_tr_b16 v[22:23], v169 offset:9216
  ds_read_b128 v[24:27], v172 offset:40960
  ds_read_b64_tr_b16 v[28:29], v169 offset:10240
  ds_read_b64_tr_b16 v[30:31], v169 offset:11264
  ds_read_b128 v[32:35], v172 offset:41984
  v_mfma_f32_32x32x16_bf16 v[104:119], v[184:187], v[188:191], v[104:119]
  ds_read_b64_tr_b16 v[36:37], v169 offset:12288
  ds_read_b64_tr_b16 v[38:39], v169 offset:13312
  ds_read_b128 v[40:43], v172 offset:43008
  ds_read_b64_tr_b16 v[44:45], v169 offset:14336
  ds_read_b64_tr_b16 v[46:47], v169 offset:15360
  ds_read_b128 v[48:51], v172 offset:44032
  v_mfma_f32_32x32x16_bf16 v[104:119], v[192:195], v[196:199], v[104:119]
  s_add_u32 m0, s48, 40960
  s_add_u32 s49, s55, 745472
  buffer_load_dwordx4 v152, s[8:11], s49 offen lds
  s_add_u32 m0, s48, 49152
  s_add_u32 s49, s54, 53248
  buffer_load_dwordx4 v4, s[12:15], s49 offen sc1 lds
  v_mfma_f32_32x32x16_bf16 v[104:119], v[200:203], v[204:207], v[104:119]
  s_waitcnt lgkmcnt(0)
  s_waitcnt vmcnt(8)
  s_barrier
  v_mfma_f32_32x32x16_bf16 v[104:119], v[20:23], v[24:27], v[104:119]
  ds_read_b64_tr_b16 v[176:177], v168 offset:8192
  ds_read_b64_tr_b16 v[178:179], v168 offset:9216
  ds_read_b128 v[180:183], v171 offset:16384
  ds_read_b64_tr_b16 v[184:185], v168 offset:10240
  ds_read_b64_tr_b16 v[186:187], v168 offset:11264
  ds_read_b128 v[188:191], v171 offset:17408
  v_mfma_f32_32x32x16_bf16 v[104:119], v[28:31], v[32:35], v[104:119]
  ds_read_b64_tr_b16 v[192:193], v168 offset:12288
  ds_read_b64_tr_b16 v[194:195], v168 offset:13312
  ds_read_b128 v[196:199], v171 offset:18432
  ds_read_b64_tr_b16 v[200:201], v168 offset:14336
  ds_read_b64_tr_b16 v[202:203], v168 offset:15360
  ds_read_b128 v[204:207], v171 offset:19456
  v_mfma_f32_32x32x16_bf16 v[104:119], v[36:39], v[40:43], v[104:119]
  v_mfma_f32_32x32x16_bf16 v[104:119], v[44:47], v[48:51], v[104:119]
  s_waitcnt lgkmcnt(0)
  s_waitcnt vmcnt(4)
  s_barrier
  v_mfma_f32_32x32x16_bf16 v[104:119], v[176:179], v[180:183], v[104:119]
  ds_read_b64_tr_b16 v[20:21], v168 offset:24576
  ds_read_b64_tr_b16 v[22:23], v168 offset:25600
  ds_read_b128 v[24:27], v171 offset:32768
  ds_read_b64_tr_b16 v[28:29], v168 offset:26624
  ds_read_b64_tr_b16 v[30:31], v168 offset:27648
  ds_read_b128 v[32:35], v171 offset:33792
  v_mfma_f32_32x32x16_bf16 v[104:119], v[184:187], v[188:191], v[104:119]
  ds_read_b64_tr_b16 v[36:37], v168 offset:28672
  ds_read_b64_tr_b16 v[38:39], v168 offset:29696
  ds_read_b128 v[40:43], v171 offset:34816
  ds_read_b64_tr_b16 v[44:45], v168 offset:30720
  ds_read_b64_tr_b16 v[46:47], v168 offset:31744
  ds_read_b128 v[48:51], v171 offset:35840
  v_mfma_f32_32x32x16_bf16 v[104:119], v[192:195], v[196:199], v[104:119]
  v_mfma_f32_32x32x16_bf16 v[104:119], v[200:203], v[204:207], v[104:119]
  s_waitcnt lgkmcnt(0)
  s_waitcnt vmcnt(0)
  s_barrier
  v_mfma_f32_32x32x16_bf16 v[104:119], v[20:23], v[24:27], v[104:119]
  ds_read_b64_tr_b16 v[176:177], v168 offset:40960
  ds_read_b64_tr_b16 v[178:179], v168 offset:41984
  ds_read_b128 v[180:183], v172 offset:0
  ds_read_b64_tr_b16 v[184:185], v168 offset:43008
  ds_read_b64_tr_b16 v[186:187], v168 offset:44032
  ds_read_b128 v[188:191], v172 offset:1024
  v_mfma_f32_32x32x16_bf16 v[104:119], v[28:31], v[32:35], v[104:119]
  ds_read_b64_tr_b16 v[192:193], v168 offset:45056
  ds_read_b64_tr_b16 v[194:195], v168 offset:46080
  ds_read_b128 v[196:199], v172 offset:2048
  ds_read_b64_tr_b16 v[200:201], v168 offset:47104
  ds_read_b64_tr_b16 v[202:203], v168 offset:48128
  ds_read_b128 v[204:207], v172 offset:3072
  v_mfma_f32_32x32x16_bf16 v[104:119], v[36:39], v[40:43], v[104:119]
  v_mfma_f32_32x32x16_bf16 v[104:119], v[44:47], v[48:51], v[104:119]
  s_waitcnt lgkmcnt(0)
  s_barrier
  v_mfma_f32_32x32x16_bf16 v[104:119], v[176:179], v[180:183], v[104:119]
  v_mfma_f32_32x32x16_bf16 v[104:119], v[184:187], v[188:191], v[104:119]
  v_mfma_f32_32x32x16_bf16 v[104:119], v[192:195], v[196:199], v[104:119]
  v_mfma_f32_32x32x16_bf16 v[104:119], v[200:203], v[204:207], v[104:119]
  v_and_b32 v100, 31, v1
  s_lshl_b32 s49, s46, 5
  v_add_u32 v100, s49, v100
  v_lshrrev_b32 v101, 5, v1
  v_mul_u32_u24 v102, 144, v100
  v_lshl_add_u32 v102, v101, 3, v102
  s_lshl_b32 s49, s47, 6
  s_add_u32 s49, s49, 34816
  v_add_u32 v102, s49, v102
  ds_write_b64 v102, v[88:89] offset:0
  ds_write_b64 v102, v[90:91] offset:16
  ds_write_b64 v102, v[92:93] offset:32
  ds_write_b64 v102, v[94:95] offset:48
  v_mul_u32_u24 v100, 272, v100
  v_lshl_add_u32 v100, v101, 4, v100
  s_lshl_b32 s49, s47, 7
  s_add_u32 s49, s49, 17408
  v_add_u32 v100, s49, v100
  ds_write_b128 v100, v[104:107] offset:0
  ds_write_b128 v100, v[108:111] offset:32
  ds_write_b128 v100, v[112:115] offset:64
  ds_write_b128 v100, v[116:119] offset:96
L_J3:
  s_waitcnt lgkmcnt(0)
  s_barrier
  v_lshrrev_b32 v100, 3, v0
  v_and_b32 v101, 7, v0
  v_mul_u32_u24 v102, 144, v100
  v_lshl_add_u32 v102, v101, 4, v102
  v_mul_u32_u24 v100, 272, v100
  v_lshl_add_u32 v100, v101, 5, v100
  ds_read_b128 v[32:35], v100
  ds_read_b128 v[36:39], v100 offset:16
  ds_read_b128 v[40:43], v100 offset:17408
  ds_read_b128 v[44:47], v100 offset:17424
  ds_read_b128 v[24:27], v102 offset:34816
  s_mov_b32 s46, 0xbfb8aa3b
  s_mov_b32 s47, s46
  s_waitcnt lgkmcnt(0)
  v_pk_add_f32 v[32:33], v[32:33], v[40:41]
  v_pk_add_f32 v[34:35], v[34:35], v[42:43]
  v_pk_add_f32 v[36:37], v[36:37], v[44:45]
  v_pk_add_f32 v[38:39], v[38:39], v[46:47]
  v_cvt_pk_bf16_f32 v32, 0, v32
  v_cvt_pk_bf16_f32 v33, 0, v33
  v_cvt_pk_bf16_f32 v34, 0, v34
  v_cvt_pk_bf16_f32 v35, 0, v35
  v_cvt_pk_bf16_f32 v36, 0, v36
  v_cvt_pk_bf16_f32 v37, 0, v37
  v_cvt_pk_bf16_f32 v38, 0, v38
  v_cvt_pk_bf16_f32 v39, 0, v39
  v_pk_mul_f32 v[40:41], v[32:33], s[46:47]
  v_pk_mul_f32 v[42:43], v[34:35], s[46:47]
  v_pk_mul_f32 v[44:45], v[36:37], s[46:47]
  v_pk_mul_f32 v[46:47], v[38:39], s[46:47]
  v_exp_f32 v40, v40
  v_exp_f32 v41, v41
  v_exp_f32 v42, v42
  v_exp_f32 v43, v43
  v_exp_f32 v44, v44
  v_exp_f32 v45, v45
  v_exp_f32 v46, v46
  v_exp_f32 v47, v47
  v_pk_add_f32 v[40:41], v[40:41], 1.0 op_sel_hi:[1,0]
  v_pk_add_f32 v[42:43], v[42:43], 1.0 op_sel_hi:[1,0]
  v_pk_add_f32 v[44:45], v[44:45], 1.0 op_sel_hi:[1,0]
  v_pk_add_f32 v[46:47], v[46:47], 1.0 op_sel_hi:[1,0]
  v_rcp_f32 v40, v40
  v_rcp_f32 v41, v41
  v_rcp_f32 v42, v42
  v_rcp_f32 v43, v43
  v_rcp_f32 v44, v44
  v_rcp_f32 v45, v45
  v_rcp_f32 v46, v46
  v_rcp_f32 v47, v47
  v_pk_mul_f32 v[32:33], v[32:33], v[40:41]
  v_pk_mul_f32 v[34:35], v[34:35], v[42:43]
  v_pk_mul_f32 v[36:37], v[36:37], v[44:45]
  v_pk_mul_f32 v[38:39], v[38:39], v[46:47]
  v_cvt_pk_bf16_f32 v32, 0, v32
  v_cvt_pk_bf16_f32 v33, 0, v33
  v_cvt_pk_bf16_f32 v34, 0, v34
  v_cvt_pk_bf16_f32 v35, 0, v35
  v_cvt_pk_bf16_f32 v36, 0, v36
  v_cvt_pk_bf16_f32 v37, 0, v37
  v_cvt_pk_bf16_f32 v38, 0, v38
  v_cvt_pk_bf16_f32 v39, 0, v39
  v_lshlrev_b32 v40, 16, v24
  v_and_b32 v41, 0xffff0000, v24
  v_lshlrev_b32 v42, 16, v25
  v_and_b32 v43, 0xffff0000, v25
  v_lshlrev_b32 v44, 16, v26
  v_and_b32 v45, 0xffff0000, v26
  v_lshlrev_b32 v46, 16, v27
  v_and_b32 v47, 0xffff0000, v27
  v_pk_mul_f32 v[32:33], v[32:33], v[40:41]
  v_pk_mul_f32 v[34:35], v[34:35], v[42:43]
  v_pk_mul_f32 v[36:37], v[36:37], v[44:45]
  v_pk_mul_f32 v[38:39], v[38:39], v[46:47]
  v_cvt_pk_bf16_f32 v32, 0, v32
  v_cvt_pk_bf16_f32 v33, 0, v33
  v_cvt_pk_bf16_f32 v34, 0, v34
  v_cvt_pk_bf16_f32 v35, 0, v35
  v_cvt_pk_bf16_f32 v36, 0, v36
  v_cvt_pk_bf16_f32 v37, 0, v37
  v_cvt_pk_bf16_f32 v38, 0, v38
  v_cvt_pk_bf16_f32 v39, 0, v39
  v_lshlrev_b32 v40, 16, v156
  v_and_b32 v41, 0xffff0000, v156
  v_lshlrev_b32 v42, 16, v157
  v_and_b32 v43, 0xffff0000, v157
  v_lshlrev_b32 v44, 16, v158
  v_and_b32 v45, 0xffff0000, v158
  v_lshlrev_b32 v46, 16, v159
  v_and_b32 v47, 0xffff0000, v159
  v_pk_add_f32 v[32:33], v[32:33], v[40:41]
  v_pk_add_f32 v[34:35], v[34:35], v[42:43]
  v_pk_add_f32 v[36:37], v[36:37], v[44:45]
  v_pk_add_f32 v[38:39], v[38:39], v[46:47]
  v_cvt_pk_bf16_f32 v20, v32, v33
  v_cvt_pk_bf16_f32 v21, v34, v35
  v_cvt_pk_bf16_f32 v22, v36, v37
  v_cvt_pk_bf16_f32 v23, v38, v39
  buffer_store_dwordx4 v[20:23], v154, s[64:67], s58 offen
  s_endpgm
L_AUX:
  s_mov_b32 s4, s28
  s_and_b32 s5, s29, 0xffff
  s_mov_b32 s6, 921600
  s_mov_b32 s7, 0x20000
  s_mov_b32 s8, s30
  s_and_b32 s9, s31, 0xffff
  s_mov_b32 s10, 921600
  s_mov_b32 s11, 0x20000
  s_getpc_b64 s[16:17]
  s_add_u32 s16, s16, TAB_FFT@rel32@lo+4
  s_addc_u32 s17, s17, TAB_FFT@rel32@hi+12
  s_and_b32 s17, s17, 0xffff
  s_mov_b32 s18, 57344
  s_mov_b32 s19, 0x20000
  s_sub_u32 s41, s41, 28
  s_lshl_b32 s43, s41, 3
  s_add_u32 s43, s43, s40
  s_cmp_lg_u32 s41, 0
  s_cbranch_scc1 L_NOCODE
  s_getpc_b64 s[44:45]
  s_add_u32 s44, s44, recurrent_scan__spectral_gfnet__mixer_gmlp__prompt_kernel@rel32@lo+4
  s_addc_u32 s45, s45, recurrent_scan__spectral_gfnet__mixer_gmlp__prompt_kernel@rel32@hi+12
  s_and_b32 s45, s45, 0xffff
  s_mov_b32 s46, L_END-recurrent_scan__spectral_gfnet__mixer_gmlp__prompt_kernel
  s_mov_b32 s47, 0x20000
  v_lshlrev_b32 v5, 7, v0
  buffer_load_dword v254, v5, s[44:47], 0 offen
L_NOCODE:
  v_lshlrev_b32 v5, 7, v0
  buffer_load_dword v255, v5, s[68:71], 0 offen
  s_waitcnt vmcnt(0)
  s_barrier
  s_lshr_b32 s44, s43, 1
  s_lshl_b32 s44, s44, 2
  s_and_b32 s45, s42, 3
  s_add_u32 s44, s44, s45
  s_lshl_b32 s44, s44, 5
  s_and_b32 s45, s43, 1
  s_lshl_b32 s45, s45, 4
  s_add_u32 s44, s44, s45
  s_mul_i32 s44, s44, 450
  s_lshl_b32 s46, s42, 13
  s_add_u32 s46, s46, 65536
  s_cmp_ge_u32 s42, 4
  s_cbranch_scc1 L_AUXI
  s_add_u32 m0, s46, 0
  s_add_u32 s47, s44, 0
  buffer_load_dwordx4 v4, s[4:7], s47 offen lds
  s_add_u32 m0, s46, 1024
  s_add_u32 s47, s44, 1024
  buffer_load_dwordx4 v4, s[4:7], s47 offen lds
  s_add_u32 m0, s46, 2048
  s_add_u32 s47, s44, 2048
  buffer_load_dwordx4 v4, s[4:7], s47 offen lds
  s_add_u32 m0, s46, 3072
  s_add_u32 s47, s44, 3072
  buffer_load_dwordx4 v4, s[4:7], s47 offen lds
  s_add_u32 m0, s46, 4096
  s_add_u32 s47, s44, 4096
  buffer_load_dwordx4 v4, s[4:7], s47 offen lds
  s_add_u32 m0, s46, 5120
  s_add_u32 s47, s44, 5120
  buffer_load_dwordx4 v4, s[4:7], s47 offen lds
  s_add_u32 m0, s46, 6144
  s_add_u32 s47, s44, 6144
  buffer_load_dwordx4 v4, s[4:7], s47 offen lds
  s_add_u32 m0, s46, 7168
  s_add_u32 s47, s44, 7168
  buffer_load_dwordx4 v4, s[4:7], s47 offen lds
  s_branch L_AUXJ
L_AUXI:
  s_add_u32 m0, s46, 0
  s_add_u32 s47, s44, 0
  buffer_load_dwordx4 v4, s[8:11], s47 offen lds
  s_add_u32 m0, s46, 1024
  s_add_u32 s47, s44, 1024
  buffer_load_dwordx4 v4, s[8:11], s47 offen lds
  s_add_u32 m0, s46, 2048
  s_add_u32 s47, s44, 2048
  buffer_load_dwordx4 v4, s[8:11], s47 offen lds
  s_add_u32 m0, s46, 3072
  s_add_u32 s47, s44, 3072
  buffer_load_dwordx4 v4, s[8:11], s47 offen lds
  s_add_u32 m0, s46, 4096
  s_add_u32 s47, s44, 4096
  buffer_load_dwordx4 v4, s[8:11], s47 offen lds
  s_add_u32 m0, s46, 5120
  s_add_u32 s47, s44, 5120
  buffer_load_dwordx4 v4, s[8:11], s47 offen lds
  s_add_u32 m0, s46, 6144
  s_add_u32 s47, s44, 6144
  buffer_load_dwordx4 v4, s[8:11], s47 offen lds
  s_add_u32 m0, s46, 7168
  s_add_u32 s47, s44, 7168
  buffer_load_dwordx4 v4, s[8:11], s47 offen lds
L_AUXJ:
  buffer_load_dword v249, v248, s[20:23], 0 offen sc1
  v_and_b32 v5, 63, v0
  v_lshlrev_b32 v5, 12, v5
  v_lshrrev_b32 v6, 6, v0
  v_lshl_add_u32 v5, v6, 7, v5
  s_lshl_b32 s47, s43, 18
  s_and_b32 s47, s40, 4
  s_and_b32 s50, s40, 1
  s_lshl_b32 s50, s50, 1
  s_add_u32 s47, s47, s50
  s_bfe_u32 s50, s40, 0x10001
  s_add_u32 s47, s47, s50
  s_lshl_b32 s47, s47, 2
  s_add_u32 s47, s47, s41
  s_lshl_b32 s47, s47, 18
  s_waitcnt vmcnt(0)
  s_barrier
  v_and_b32 v6, 15, v0
  v_lshrrev_b32 v7, 4, v0
  v_mul_u32_u24 v8, 450, v6
  v_lshl_add_u32 v8, v7, 1, v8
  v_add_u32 v8, 65536, v8
  v_lshlrev_b32 v9, 13, v7
  v_lshl_add_u32 v9, v6, 4, v9
  s_lshl_b32 s48, s43, 8
  s_add_u32 s48, s48, 10485760
  v_mov_b32 v10, 0
  ds_read_u16 v16, v8 offset:0
  ds_read_u16 v112, v8 offset:32768
  ds_read_u16 v17, v8 offset:8192
  ds_read_u16 v113, v8 offset:40960
  ds_read_u16 v18, v8 offset:16384
  ds_read_u16 v114, v8 offset:49152
  ds_read_u16 v19, v8 offset:24576
  ds_read_u16 v115, v8 offset:57344
  ds_read_u16 v20, v8 offset:64
  ds_read_u16 v116, v8 offset:32832
  ds_read_u16 v21, v8 offset:8256
  ds_read_u16 v117, v8 offset:41024
  ds_read_u16 v22, v8 offset:16448
  ds_read_u16 v118, v8 offset:49216
  ds_read_u16 v23, v8 offset:24640
  ds_read_u16 v119, v8 offset:57408
  ds_read_u16 v24, v8 offset:128
  ds_read_u16 v120, v8 offset:32896
  ds_read_u16 v25, v8 offset:8320
  ds_read_u16 v121, v8 offset:41088
  ds_read_u16 v26, v8 offset:16512
  ds_read_u16 v122, v8 offset:49280
  ds_read_u16 v27, v8 offset:24704
  ds_read_u16 v123, v8 offset:57472
  ds_read_u16 v28, v8 offset:192
  ds_read_u16 v124, v8 offset:32960
  ds_read_u16 v29, v8 offset:8384
  ds_read_u16 v125, v8 offset:41152
  ds_read_u16 v30, v8 offset:16576
  ds_read_u16 v126, v8 offset:49344
  ds_read_u16 v31, v8 offset:24768
  ds_read_u16 v127, v8 offset:57536
  ds_read_u16 v32, v8 offset:256
  ds_read_u16 v128, v8 offset:33024
  ds_read_u16 v33, v8 offset:8448
  ds_read_u16 v129, v8 offset:41216
  ds_read_u16 v34, v8 offset:16640
  ds_read_u16 v130, v8 offset:49408
  ds_read_u16 v35, v8 offset:24832
  ds_read_u16 v131, v8 offset:57600
  ds_read_u16 v36, v8 offset:320
  ds_read_u16 v132, v8 offset:33088
  ds_read_u16 v37, v8 offset:8512
  ds_read_u16 v133, v8 offset:41280
  ds_read_u16 v38, v8 offset:16704
  ds_read_u16 v134, v8 offset:49472
  ds_read_u16 v39, v8 offset:24896
  ds_read_u16 v135, v8 offset:57664
  ds_read_u16 v40, v8 offset:384
  ds_read_u16 v136, v8 offset:33152
  ds_read_u16 v41, v8 offset:8576
  ds_read_u16 v137, v8 offset:41344
  ds_read_u16 v42, v8 offset:16768
  ds_read_u16 v138, v8 offset:49536
  ds_read_u16 v43, v8 offset:24960
  ds_read_u16 v139, v8 offset:57728
  ds_read_u16 v44, v8 offset:448
  ds_read_u16 v140, v8 offset:33216
  ds_read_u16 v45, v8 offset:8640
  ds_read_u16 v141, v8 offset:41408
  ds_read_u16 v46, v8 offset:16832
  ds_read_u16 v142, v8 offset:49600
  ds_read_u16 v47, v8 offset:25024
  ds_read_u16 v143, v8 offset:57792
  s_mov_b32 s50, 0
L_ANON:
  v_readfirstlane_b32 s63, v249
  s_add_u32 s50, s50, 1
  s_cmp_lg_u32 s63, 0
  s_cbranch_scc1 L_ANON_OK
  s_cmp_ge_u32 s50, 16384
  s_cbranch_scc1 L_ANON_OK
  s_sleep 4
  buffer_load_dword v249, v248, s[20:23], 0 offen sc1
  s_waitcnt vmcnt(0)
  s_branch L_ANON
L_ANON_OK:
  s_waitcnt lgkmcnt(0)
  v_lshl_or_b32 v16, v112, 16, v16
  v_lshl_or_b32 v17, v113, 16, v17
  v_lshl_or_b32 v18, v114, 16, v18
  v_lshl_or_b32 v19, v115, 16, v19
  buffer_store_dwordx4 v[16:19], v9, s[12:15], s48 offen sc1
  v_and_b32 v12, 0x7fff7fff, v16
  v_pk_max_u16 v10, v10, v12
  v_and_b32 v13, 0x7fff7fff, v17
  v_pk_max_u16 v10, v10, v13
  v_and_b32 v12, 0x7fff7fff, v18
  v_pk_max_u16 v10, v10, v12
  v_and_b32 v13, 0x7fff7fff, v19
  v_pk_max_u16 v10, v10, v13
  s_add_u32 s48, s48, 262144
  v_lshl_or_b32 v20, v116, 16, v20
  v_lshl_or_b32 v21, v117, 16, v21
  v_lshl_or_b32 v22, v118, 16, v22
  v_lshl_or_b32 v23, v119, 16, v23
  buffer_store_dwordx4 v[20:23], v9, s[12:15], s48 offen sc1
  v_and_b32 v12, 0x7fff7fff, v20
  v_pk_max_u16 v10, v10, v12
  v_and_b32 v13, 0x7fff7fff, v21
  v_pk_max_u16 v10, v10, v13
  v_and_b32 v12, 0x7fff7fff, v22
  v_pk_max_u16 v10, v10, v12
  v_and_b32 v13, 0x7fff7fff, v23
  v_pk_max_u16 v10, v10, v13
  s_add_u32 s48, s48, 262144
  v_lshl_or_b32 v24, v120, 16, v24
  v_lshl_or_b32 v25, v121, 16, v25
  v_lshl_or_b32 v26, v122, 16, v26
  v_lshl_or_b32 v27, v123, 16, v27
  buffer_store_dwordx4 v[24:27], v9, s[12:15], s48 offen sc1
  v_and_b32 v12, 0x7fff7fff, v24
  v_pk_max_u16 v10, v10, v12
  v_and_b32 v13, 0x7fff7fff, v25
  v_pk_max_u16 v10, v10, v13
  v_and_b32 v12, 0x7fff7fff, v26
  v_pk_max_u16 v10, v10, v12
  v_and_b32 v13, 0x7fff7fff, v27
  v_pk_max_u16 v10, v10, v13
  s_add_u32 s48, s48, 262144
  v_lshl_or_b32 v28, v124, 16, v28
  v_lshl_or_b32 v29, v125, 16, v29
  v_lshl_or_b32 v30, v126, 16, v30
  v_lshl_or_b32 v31, v127, 16, v31
  buffer_store_dwordx4 v[28:31], v9, s[12:15], s48 offen sc1
  v_and_b32 v12, 0x7fff7fff, v28
  v_pk_max_u16 v10, v10, v12
  v_and_b32 v13, 0x7fff7fff, v29
  v_pk_max_u16 v10, v10, v13
  v_and_b32 v12, 0x7fff7fff, v30
  v_pk_max_u16 v10, v10, v12
  v_and_b32 v13, 0x7fff7fff, v31
  v_pk_max_u16 v10, v10, v13
  s_add_u32 s48, s48, 262144
  v_lshl_or_b32 v32, v128, 16, v32
  v_lshl_or_b32 v33, v129, 16, v33
  v_lshl_or_b32 v34, v130, 16, v34
  v_lshl_or_b32 v35, v131, 16, v35
  buffer_store_dwordx4 v[32:35], v9, s[12:15], s48 offen sc1
  v_and_b32 v12, 0x7fff7fff, v32
  v_pk_max_u16 v10, v10, v12
  v_and_b32 v13, 0x7fff7fff, v33
  v_pk_max_u16 v10, v10, v13
  v_and_b32 v12, 0x7fff7fff, v34
  v_pk_max_u16 v10, v10, v12
  v_and_b32 v13, 0x7fff7fff, v35
  v_pk_max_u16 v10, v10, v13
  s_add_u32 s48, s48, 262144
  v_lshl_or_b32 v36, v132, 16, v36
  v_lshl_or_b32 v37, v133, 16, v37
  v_lshl_or_b32 v38, v134, 16, v38
  v_lshl_or_b32 v39, v135, 16, v39
  buffer_store_dwordx4 v[36:39], v9, s[12:15], s48 offen sc1
  v_and_b32 v12, 0x7fff7fff, v36
  v_pk_max_u16 v10, v10, v12
  v_and_b32 v13, 0x7fff7fff, v37
  v_pk_max_u16 v10, v10, v13
  v_and_b32 v12, 0x7fff7fff, v38
  v_pk_max_u16 v10, v10, v12
  v_and_b32 v13, 0x7fff7fff, v39
  v_pk_max_u16 v10, v10, v13
  s_add_u32 s48, s48, 262144
  v_lshl_or_b32 v40, v136, 16, v40
  v_lshl_or_b32 v41, v137, 16, v41
  v_lshl_or_b32 v42, v138, 16, v42
  v_lshl_or_b32 v43, v139, 16, v43
  buffer_store_dwordx4 v[40:43], v9, s[12:15], s48 offen sc1
  v_and_b32 v12, 0x7fff7fff, v40
  v_pk_max_u16 v10, v10, v12
  v_and_b32 v13, 0x7fff7fff, v41
  v_pk_max_u16 v10, v10, v13
  v_and_b32 v12, 0x7fff7fff, v42
  v_pk_max_u16 v10, v10, v12
  v_and_b32 v13, 0x7fff7fff, v43
  v_pk_max_u16 v10, v10, v13
  s_add_u32 s48, s48, 262144
  v_lshl_or_b32 v44, v140, 16, v44
  v_lshl_or_b32 v45, v141, 16, v45
  v_lshl_or_b32 v46, v142, 16, v46
  v_lshl_or_b32 v47, v143, 16, v47
  v_cmp_gt_u32 vcc, 16, v0
  s_nop 0
  s_and_saveexec_b64 s[50:51], vcc
  s_cbranch_execz L_AUXSK
  buffer_store_dwordx4 v[44:47], v9, s[12:15], s48 offen sc1
  v_and_b32 v12, 0x7fff7fff, v44
  v_pk_max_u16 v10, v10, v12
  v_and_b32 v13, 0x7fff7fff, v45
  v_pk_max_u16 v10, v10, v13
  v_and_b32 v12, 0x7fff7fff, v46
  v_pk_max_u16 v10, v10, v12
  v_and_b32 v13, 0x7fff7fff, v47
  v_pk_max_u16 v10, v10, v13
L_AUXSK:
  s_mov_b64 exec, -1
  v_lshrrev_b32 v11, 16, v10
  v_and_b32 v10, 0xffff, v10
  v_max_u32 v10, v10, v11
  s_nop 1
  v_max_u32_dpp v10, v10, v10 quad_perm:[1,0,3,2] row_mask:0xf bank_mask:0xf
  s_nop 1
  v_max_u32_dpp v10, v10, v10 quad_perm:[2,3,0,1] row_mask:0xf bank_mask:0xf
  s_nop 1
  v_max_u32_dpp v10, v10, v10 row_half_mirror row_mask:0xf bank_mask:0xf
  s_nop 1
  v_max_u32_dpp v10, v10, v10 row_mirror row_mask:0xf bank_mask:0xf
  s_nop 0
  v_readlane_b32 s50, v10, 0
  v_readlane_b32 s51, v10, 16
  v_readlane_b32 s52, v10, 32
  v_readlane_b32 s53, v10, 48
  s_max_u32 s50, s50, s51
  s_max_u32 s52, s52, s53
  s_max_u32 s50, s50, s52
  s_lshl_b32 s49, s43, 3
  s_add_u32 s49, s49, s42
  s_lshl_b32 s49, s49, 2
  s_add_u32 s49, s49, 19922944
  v_mov_b32 v10, s50
  s_mov_b64 exec, 1
  buffer_store_dword v10, v248, s[12:15], s49 offen sc1
  s_mov_b64 exec, -1
  s_waitcnt vmcnt(0)
  s_barrier
  s_lshl_b32 s49, s43, 7
  s_add_u32 s49, s49, 20054016
  s_cmp_lg_u32 s42, 0
  s_cbranch_scc1 L_FW
  v_mov_b32 v249, s63
  s_mov_b64 exec, 1
  buffer_store_dword v249, v248, s[12:15], s49 offen sc1
  s_mov_b64 exec, -1
L_FW:
  buffer_load_dword v252, v5, s[24:27], s47 offen
  s_mul_i32 s45, s42, 7168
  s_add_u32 m0, s45, 0
  s_add_u32 s46, s45, 0
  buffer_load_dwordx4 v4, s[16:19], s46 offen lds
  s_add_u32 m0, s45, 1024
  s_add_u32 s46, s45, 1024
  buffer_load_dwordx4 v4, s[16:19], s46 offen lds
  s_add_u32 m0, s45, 2048
  s_add_u32 s46, s45, 2048
  buffer_load_dwordx4 v4, s[16:19], s46 offen lds
  s_add_u32 m0, s45, 3072
  s_add_u32 s46, s45, 3072
  buffer_load_dwordx4 v4, s[16:19], s46 offen lds
  s_add_u32 m0, s45, 4096
  s_add_u32 s46, s45, 4096
  buffer_load_dwordx4 v4, s[16:19], s46 offen lds
  s_add_u32 m0, s45, 5120
  s_add_u32 s46, s45, 5120
  buffer_load_dwordx4 v4, s[16:19], s46 offen lds
  s_add_u32 m0, s45, 6144
  s_add_u32 s46, s45, 6144
  buffer_load_dwordx4 v4, s[16:19], s46 offen lds
  v_mov_b32 v8, 156672
  ds_write_b32 v8, v248
  v_and_b32 v250, 31, v1
  v_lshlrev_b32 v250, 7, v250
  s_mov_b32 s59, 20054016
  s_cmp_lg_u32 s42, 0
  s_cbranch_scc1 L_PW
  buffer_load_dword v249, v250, s[12:15], s59 offen sc1
L_PW:
  s_cmp_lg_u32 s42, 0
  s_cbranch_scc1 L_CW_OK
  s_mov_b32 s50, 0
L_CW:
  s_waitcnt vmcnt(0)
L_CW_1:
  v_cmp_eq_u32 vcc, s63, v249
  s_add_u32 s50, s50, 1
  s_cmp_eq_u64 vcc, exec
  s_cbranch_scc1 L_CW_OK
  s_cmp_ge_u32 s50, 16384
  s_cbranch_scc1 L_CW_OK
  s_sleep 16
  buffer_load_dword v249, v250, s[12:15], s59 offen sc1
  s_branch L_CW
L_CW_OK:
  s_barrier
  s_mul_i32 s44, s43, 7
  s_add_u32 s44, s44, s42
  s_cmp_eq_u32 s42, 7
  s_cselect_b32 s44, 224, s44
  s_mov_b32 s53, 19922944
  buffer_load_dwordx4 v[12:15], v4, s[12:15], s53 offen sc1
  s_lshl_b32 s54, s44, 13
  s_add_u32 s54, s54, 10485760
  s_cmp_eq_u32 s42, 7
  s_cselect_b32 s55, s43, 0
  s_cmp_lg_u32 s55, 0
  s_cselect_b32 s54, 0x20000000, s54
  s_add_u32 s55, s54, 4096
  buffer_load_dwordx4 v[128:131], v4, s[12:15], s54 offen offset:0 sc1
  buffer_load_dwordx4 v[132:135], v4, s[12:15], s54 offen offset:1024 sc1
  buffer_load_dwordx4 v[136:139], v4, s[12:15], s54 offen offset:2048 sc1
  buffer_load_dwordx4 v[140:143], v4, s[12:15], s54 offen offset:3072 sc1
  buffer_load_dwordx4 v[144:147], v4, s[12:15], s55 offen offset:0 sc1
  buffer_load_dwordx4 v[148:151], v4, s[12:15], s55 offen offset:1024 sc1
  buffer_load_dwordx4 v[152:155], v4, s[12:15], s55 offen offset:2048 sc1
  buffer_load_dwordx4 v[156:159], v4, s[12:15], s55 offen offset:3072 sc1
  s_mul_i32 s51, s43, 14
  s_add_u32 s52, s51, 13
  s_lshr_b32 s51, s51, 6
  s_lshr_b32 s52, s52, 6
  s_lshl_b32 s51, s51, 12
  s_lshl_b32 s52, s52, 12
  v_mov_b32 v8, s51
  v_mov_b32 v9, s52
  v_cmp_gt_u32 vcc, 32, v1
  s_nop 1
  v_cndmask_b32 v8, v9, v8, vcc
  v_add_u32 v250, v250, v8
  s_mov_b32 s59, 20021248
  s_cmp_lg_u32 s42, 0
  s_cbranch_scc1 L_CF_OK
  s_mov_b32 s50, 0
  buffer_load_dword v240, v250, s[12:15], s59 offen sc1
  s_sleep 8
  buffer_load_dword v241, v250, s[12:15], s59 offen sc1
  s_sleep 8
  buffer_load_dword v242, v250, s[12:15], s59 offen sc1
  s_sleep 8
  buffer_load_dword v243, v250, s[12:15], s59 offen sc1
L_CF:
  s_waitcnt vmcnt(3)
  v_cmp_eq_u32 vcc, s63, v240
  s_nop 0
  s_cmp_eq_u64 vcc, exec
  s_cbranch_scc1 L_CF_OK
  buffer_load_dword v240, v250, s[12:15], s59 offen sc1
  s_sleep 4
  s_waitcnt vmcnt(3)
  v_cmp_eq_u32 vcc, s63, v241
  s_nop 0
  s_cmp_eq_u64 vcc, exec
  s_cbranch_scc1 L_CF_OK
  buffer_load_dword v241, v250, s[12:15], s59 offen sc1
  s_sleep 4
  s_waitcnt vmcnt(3)
  v_cmp_eq_u32 vcc, s63, v242
  s_nop 0
  s_cmp_eq_u64 vcc, exec
  s_cbranch_scc1 L_CF_OK
  buffer_load_dword v242, v250, s[12:15], s59 offen sc1
  s_sleep 4
  s_waitcnt vmcnt(3)
  v_cmp_eq_u32 vcc, s63, v243
  s_nop 0
  s_cmp_eq_u64 vcc, exec
  s_cbranch_scc1 L_CF_OK
  buffer_load_dword v243, v250, s[12:15], s59 offen sc1
  s_sleep 4
  s_add_u32 s50, s50, 1
  s_cmp_lt_u32 s50, 16384
  s_cbranch_scc1 L_CF
L_CF_OK:
  s_waitcnt vmcnt(9) lgkmcnt(0)
  s_barrier
  s_cmp_lg_u32 s42, 7
  s_cbranch_scc1 L_FFT0
  s_cmp_lg_u32 s43, 0
  s_cbranch_scc1 L_PFW
L_FFT0:
  s_lshl_b32 s48, s44, 1
  s_add_u32 s49, s48, 1
  s_min_u32 s49, s49, 447
  s_cmp_eq_u32 s44, 224
  s_cselect_b32 s48, 1, s48
  s_cmp_eq_u32 s44, 224
  s_cselect_b32 s58, 1, 0
  s_cmp_eq_u32 s44, 0
  s_cselect_b32 s58, 1, s58
  s_lshl_b32 s48, s48, 12
  s_lshl_b32 s49, s49, 12
  s_add_u32 s51, s48, 8388608
  s_add_u32 s52, s49, 8388608
  v_and_b32 v5, 31, v1
  v_lshrrev_b32 v6, 5, v1
  v_lshlrev_b32 v7, 4, v5
  v_lshl_add_u32 v7, v6, 10, v7
  buffer_load_dwordx4 v[16:19], v7, s[12:15], s51 offen offset:0 sc1
  buffer_load_dwordx4 v[32:35], v7, s[12:15], s52 offen offset:0 sc1
  buffer_load_dwordx4 v[20:23], v7, s[12:15], s51 offen offset:2048 sc1
  buffer_load_dwordx4 v[36:39], v7, s[12:15], s52 offen offset:2048 sc1
  buffer_load_dwordx4 v[24:27], v7, s[12:15], s51 offen offset:512 sc1
  buffer_load_dwordx4 v[40:43], v7, s[12:15], s52 offen offset:512 sc1
  buffer_load_dwordx4 v[28:31], v7, s[12:15], s51 offen offset:2560 sc1
  buffer_load_dwordx4 v[44:47], v7, s[12:15], s52 offen offset:2560 sc1
  ds_read_b128 v[160:163], v4 offset:49152
  ds_read_b128 v[164:167], v4 offset:50176
  ds_read_b128 v[168:171], v4 offset:51200
  ds_read_b128 v[172:175], v4 offset:52224
  ds_read_b128 v[176:179], v4 offset:53248
  ds_read_b128 v[180:183], v4 offset:54272
  s_waitcnt vmcnt(8)
  v_max_u32 v12, v12, v13
  v_max3_u32 v12, v12, v14, v15
  s_nop 1
  v_max_u32_dpp v12, v12, v12 quad_perm:[1,0,3,2] row_mask:0xf bank_mask:0xf
  s_nop 1
  v_max_u32_dpp v12, v12, v12 quad_perm:[2,3,0,1] row_mask:0xf bank_mask:0xf
  s_nop 1
  v_max_u32_dpp v12, v12, v12 row_half_mirror row_mask:0xf bank_mask:0xf
  s_nop 1
  v_max_u32_dpp v12, v12, v12 row_mirror row_mask:0xf bank_mask:0xf
  s_nop 0
  v_readlane_b32 s53, v12, 0
  v_readlane_b32 s28, v12, 16
  v_readlane_b32 s29, v12, 32
  v_readlane_b32 s30, v12, 48
  s_max_u32 s53, s53, s28
  s_max_u32 s29, s29, s30
  s_max_u32 s53, s53, s29
  s_lshr_b32 s53, s53, 7
  s_max_u32 s53, s53, 2
  s_min_u32 s53, s53, 252
  s_sub_u32 s56, 254, s53
  s_sub_u32 s56, s56, s58
  s_lshl_b32 s56, s56, 23
  s_mov_b32 s57, s56
  s_waitcnt vmcnt(0)
  s_cmp_eq_u32 s58, 0
  s_cbranch_scc1 L_NSP
  v_mov_b32 v32, 0
  v_mov_b32 v33, 0
  v_mov_b32 v34, 0
  v_mov_b32 v35, 0
  v_mov_b32 v36, 0
  v_mov_b32 v37, 0
  v_mov_b32 v38, 0
  v_mov_b32 v39, 0
  v_mov_b32 v40, 0
  v_mov_b32 v41, 0
  v_mov_b32 v42, 0
  v_mov_b32 v43, 0
  v_mov_b32 v44, 0
  v_mov_b32 v45, 0
  v_mov_b32 v46, 0
  v_mov_b32 v47, 0
L_NSP:
  s_waitcnt lgkmcnt(0)
  v_mfma_f32_32x32x16_f16 v[64:79], v[16:19], v[160:163], 0
  v_mfma_f32_32x32x16_f16 v[96:111], v[16:19], v[168:171], 0
  v_mfma_f32_32x32x16_f16 v[64:79], v[32:35], v[176:179], v[64:79]
  v_mfma_f32_32x32x16_f16 v[96:111], v[32:35], v[160:163], v[96:111]
  v_mfma_f32_32x32x16_f16 v[64:79], v[20:23], v[164:167], v[64:79]
  v_mfma_f32_32x32x16_f16 v[96:111], v[20:23], v[172:175], v[96:111]
  v_mfma_f32_32x32x16_f16 v[64:79], v[36:39], v[180:183], v[64:79]
  v_mfma_f32_32x32x16_f16 v[96:111], v[36:39], v[164:167], v[96:111]
  v_mfma_f32_32x32x16_f16 v[80:95], v[24:27], v[160:163], 0
  v_mfma_f32_32x32x16_f16 v[112:127], v[24:27], v[168:171], 0
  v_mfma_f32_32x32x16_f16 v[80:95], v[40:43], v[176:179], v[80:95]
  v_mfma_f32_32x32x16_f16 v[112:127], v[40:43], v[160:163], v[112:127]
  v_mfma_f32_32x32x16_f16 v[80:95], v[28:31], v[164:167], v[80:95]
  v_mfma_f32_32x32x16_f16 v[112:127], v[28:31], v[172:175], v[112:127]
  v_mfma_f32_32x32x16_f16 v[80:95], v[44:47], v[180:183], v[80:95]
  v_mfma_f32_32x32x16_f16 v[112:127], v[44:47], v[164:167], v[112:127]
  ds_read_b128 v[216:219], v4 offset:16384
  ds_read_b128 v[220:223], v4 offset:17408
  ds_read_b128 v[224:227], v4 offset:18432
  ds_read_b128 v[228:231], v4 offset:19456
  ds_read_b128 v[232:235], v4 offset:20480
  ds_read_b128 v[236:239], v4 offset:21504
  s_waitcnt lgkmcnt(4)
  v_mul_f32 v8, v64, v216
  v_mul_f32 v12, v64, v220
  v_mul_f32 v9, v65, v217
  v_mul_f32 v13, v65, v221
  v_mul_f32 v10, v66, v218
  v_mul_f32 v14, v66, v222
  v_mul_f32 v11, v67, v219
  v_mul_f32 v15, v67, v223
  v_fma_f32 v8, -v96, v220, v8
  v_fmac_f32 v12, v96, v216
  v_fma_f32 v9, -v97, v221, v9
  v_fmac_f32 v13, v97, v217
  v_fma_f32 v10, -v98, v222, v10
  v_fmac_f32 v14, v98, v218
  v_fma_f32 v11, -v99, v223, v11
  v_fmac_f32 v15, v99, v219
  v_cvt_pk_f16_f32 v16, v8, v9
  v_cvt_pk_f16_f32 v32, v12, v13
  v_cvt_pk_f16_f32 v17, v10, v11
  v_cvt_pk_f16_f32 v33, v14, v15
  v_xor_b32 v48, 0x80008000, v32
  v_xor_b32 v49, 0x80008000, v33
  ds_read_b128 v[216:219], v4 offset:22528
  ds_read_b128 v[220:223], v4 offset:23552
  s_waitcnt lgkmcnt(4)
  v_mul_f32 v8, v68, v224
  v_mul_f32 v12, v68, v228
  v_mul_f32 v9, v69, v225
  v_mul_f32 v13, v69, v229
  v_mul_f32 v10, v70, v226
  v_mul_f32 v14, v70, v230
  v_mul_f32 v11, v71, v227
  v_mul_f32 v15, v71, v231
  v_fma_f32 v8, -v100, v228, v8
  v_fmac_f32 v12, v100, v224
  v_fma_f32 v9, -v101, v229, v9
  v_fmac_f32 v13, v101, v225
  v_fma_f32 v10, -v102, v230, v10
  v_fmac_f32 v14, v102, v226
  v_fma_f32 v11, -v103, v231, v11
  v_fmac_f32 v15, v103, v227
  v_cvt_pk_f16_f32 v18, v8, v9
  v_cvt_pk_f16_f32 v34, v12, v13
  v_cvt_pk_f16_f32 v19, v10, v11
  v_cvt_pk_f16_f32 v35, v14, v15
  v_xor_b32 v50, 0x80008000, v34
  v_xor_b32 v51, 0x80008000, v35
  ds_read_b128 v[224:227], v4 offset:24576
  ds_read_b128 v[228:231], v4 offset:25600
  s_waitcnt lgkmcnt(4)
  v_mul_f32 v8, v72, v232
  v_mul_f32 v12, v72, v236
  v_mul_f32 v9, v73, v233
  v_mul_f32 v13, v73, v237
  v_mul_f32 v10, v74, v234
  v_mul_f32 v14, v74, v238
  v_mul_f32 v11, v75, v235
  v_mul_f32 v15, v75, v239
  v_fma_f32 v8, -v104, v236, v8
  v_fmac_f32 v12, v104, v232
  v_fma_f32 v9, -v105, v237, v9
  v_fmac_f32 v13, v105, v233
  v_fma_f32 v10, -v106, v238, v10
  v_fmac_f32 v14, v106, v234
  v_fma_f32 v11, -v107, v239, v11
  v_fmac_f32 v15, v107, v235
  v_cvt_pk_f16_f32 v20, v8, v9
  v_cvt_pk_f16_f32 v36, v12, v13
  v_cvt_pk_f16_f32 v21, v10, v11
  v_cvt_pk_f16_f32 v37, v14, v15
  v_xor_b32 v52, 0x80008000, v36
  v_xor_b32 v53, 0x80008000, v37
  ds_read_b128 v[232:235], v4 offset:26624
  ds_read_b128 v[236:239], v4 offset:27648
  s_waitcnt lgkmcnt(4)
  v_mul_f32 v8, v76, v216
  v_mul_f32 v12, v76, v220
  v_mul_f32 v9, v77, v217
  v_mul_f32 v13, v77, v221
  v_mul_f32 v10, v78, v218
  v_mul_f32 v14, v78, v222
  v_mul_f32 v11, v79, v219
  v_mul_f32 v15, v79, v223
  v_fma_f32 v8, -v108, v220, v8
  v_fmac_f32 v12, v108, v216
  v_fma_f32 v9, -v109, v221, v9
  v_fmac_f32 v13, v109, v217
  v_fma_f32 v10, -v110, v222, v10
  v_fmac_f32 v14, v110, v218
  v_fma_f32 v11, -v111, v223, v11
  v_fmac_f32 v15, v111, v219
  v_cvt_pk_f16_f32 v22, v8, v9
  v_cvt_pk_f16_f32 v38, v12, v13
  v_cvt_pk_f16_f32 v23, v10, v11
  v_cvt_pk_f16_f32 v39, v14, v15
  v_xor_b32 v54, 0x80008000, v38
  v_xor_b32 v55, 0x80008000, v39
  ds_read_b128 v[216:219], v4 offset:28672
  ds_read_b128 v[220:223], v4 offset:29696
  s_waitcnt lgkmcnt(4)
  v_mul_f32 v8, v80, v224
  v_mul_f32 v12, v80, v228
  v_mul_f32 v9, v81, v225
  v_mul_f32 v13, v81, v229
  v_mul_f32 v10, v82, v226
  v_mul_f32 v14, v82, v230
  v_mul_f32 v11, v83, v227
  v_mul_f32 v15, v83, v231
  v_fma_f32 v8, -v112, v228, v8
  v_fmac_f32 v12, v112, v224
  v_fma_f32 v9, -v113, v229, v9
  v_fmac_f32 v13, v113, v225
  v_fma_f32 v10, -v114, v230, v10
  v_fmac_f32 v14, v114, v226
  v_fma_f32 v11, -v115, v231, v11
  v_fmac_f32 v15, v115, v227
  v_cvt_pk_f16_f32 v24, v8, v9
  v_cvt_pk_f16_f32 v40, v12, v13
  v_cvt_pk_f16_f32 v25, v10, v11
  v_cvt_pk_f16_f32 v41, v14, v15
  v_xor_b32 v56, 0x80008000, v40
  v_xor_b32 v57, 0x80008000, v41
  ds_read_b128 v[224:227], v4 offset:30720
  ds_read_b128 v[228:231], v4 offset:31744
  s_waitcnt lgkmcnt(4)
  v_mul_f32 v8, v84, v232
  v_mul_f32 v12, v84, v236
  v_mul_f32 v9, v85, v233
  v_mul_f32 v13, v85, v237
  v_mul_f32 v10, v86, v234
  v_mul_f32 v14, v86, v238
  v_mul_f32 v11, v87, v235
  v_mul_f32 v15, v87, v239
  v_fma_f32 v8, -v116, v236, v8
  v_fmac_f32 v12, v116, v232
  v_fma_f32 v9, -v117, v237, v9
  v_fmac_f32 v13, v117, v233
  v_fma_f32 v10, -v118, v238, v10
  v_fmac_f32 v14, v118, v234
  v_fma_f32 v11, -v119, v239, v11
  v_fmac_f32 v15, v119, v235
  v_cvt_pk_f16_f32 v26, v8, v9
  v_cvt_pk_f16_f32 v42, v12, v13
  v_cvt_pk_f16_f32 v27, v10, v11
  v_cvt_pk_f16_f32 v43, v14, v15
  v_xor_b32 v58, 0x80008000, v42
  v_xor_b32 v59, 0x80008000, v43
  s_waitcnt lgkmcnt(2)
  v_mul_f32 v8, v88, v216
  v_mul_f32 v12, v88, v220
  v_mul_f32 v9, v89, v217
  v_mul_f32 v13, v89, v221
  v_mul_f32 v10, v90, v218
  v_mul_f32 v14, v90, v222
  v_mul_f32 v11, v91, v219
  v_mul_f32 v15, v91, v223
  v_fma_f32 v8, -v120, v220, v8
  v_fmac_f32 v12, v120, v216
  v_fma_f32 v9, -v121, v221, v9
  v_fmac_f32 v13, v121, v217
  v_fma_f32 v10, -v122, v222, v10
  v_fmac_f32 v14, v122, v218
  v_fma_f32 v11, -v123, v223, v11
  v_fmac_f32 v15, v123, v219
  v_cvt_pk_f16_f32 v28, v8, v9
  v_cvt_pk_f16_f32 v44, v12, v13
  v_cvt_pk_f16_f32 v29, v10, v11
  v_cvt_pk_f16_f32 v45, v14, v15
  v_xor_b32 v60, 0x80008000, v44
  v_xor_b32 v61, 0x80008000, v45
  s_waitcnt lgkmcnt(0)
  v_mul_f32 v8, v92, v224
  v_mul_f32 v12, v92, v228
  v_mul_f32 v9, v93, v225
  v_mul_f32 v13, v93, v229
  v_mul_f32 v10, v94, v226
  v_mul_f32 v14, v94, v230
  v_mul_f32 v11, v95, v227
  v_mul_f32 v15, v95, v231
  v_fma_f32 v8, -v124, v228, v8
  v_fmac_f32 v12, v124, v224
  v_fma_f32 v9, -v125, v229, v9
  v_fmac_f32 v13, v125, v225
  v_fma_f32 v10, -v126, v230, v10
  v_fmac_f32 v14, v126, v226
  v_fma_f32 v11, -v127, v231, v11
  v_fmac_f32 v15, v127, v227
  v_cvt_pk_f16_f32 v30, v8, v9
  v_cvt_pk_f16_f32 v46, v12, v13
  v_cvt_pk_f16_f32 v31, v10, v11
  v_cvt_pk_f16_f32 v47, v14, v15
  v_xor_b32 v62, 0x80008000, v46
  v_xor_b32 v63, 0x80008000, v47
  ds_read_b128 v[184:187], v4 offset:0
  ds_read_b128 v[188:191], v4 offset:8192
  ds_read_b128 v[192:195], v4 offset:1024
  ds_read_b128 v[196:199], v4 offset:9216
  ds_read_b128 v[200:203], v4 offset:2048
  ds_read_b128 v[204:207], v4 offset:10240
  ds_read_b128 v[208:211], v4 offset:3072
  ds_read_b128 v[212:215], v4 offset:11264
  s_waitcnt lgkmcnt(6)
  v_mfma_f32_32x32x16_f16 v[64:79], v[184:187], v[16:19], 0
  v_mfma_f32_32x32x16_f16 v[96:111], v[188:191], v[16:19], 0
  v_mfma_f32_32x32x16_f16 v[64:79], v[188:191], v[48:51], v[64:79]
  v_mfma_f32_32x32x16_f16 v[96:111], v[184:187], v[32:35], v[96:111]
  ds_read_b128 v[184:187], v4 offset:4096
  ds_read_b128 v[188:191], v4 offset:12288
  s_waitcnt lgkmcnt(6)
  v_mfma_f32_32x32x16_f16 v[64:79], v[192:195], v[20:23], v[64:79]
  v_mfma_f32_32x32x16_f16 v[96:111], v[196:199], v[20:23], v[96:111]
  v_mfma_f32_32x32x16_f16 v[64:79], v[196:199], v[52:55], v[64:79]
  v_mfma_f32_32x32x16_f16 v[96:111], v[192:195], v[36:39], v[96:111]
  ds_read_b128 v[192:195], v4 offset:5120
  ds_read_b128 v[196:199], v4 offset:13312
  s_waitcnt lgkmcnt(6)
  v_mfma_f32_32x32x16_f16 v[64:79], v[200:203], v[24:27], v[64:79]
  v_mfma_f32_32x32x16_f16 v[96:111], v[204:207], v[24:27], v[96:111]
  v_mfma_f32_32x32x16_f16 v[64:79], v[204:207], v[56:59], v[64:79]
  v_mfma_f32_32x32x16_f16 v[96:111], v[200:203], v[40:43], v[96:111]
  ds_read_b128 v[200:203], v4 offset:6144
  ds_read_b128 v[204:207], v4 offset:14336
  s_waitcnt lgkmcnt(6)
  v_mfma_f32_32x32x16_f16 v[64:79], v[208:211], v[28:31], v[64:79]
  v_mfma_f32_32x32x16_f16 v[96:111], v[212:215], v[28:31], v[96:111]
  v_mfma_f32_32x32x16_f16 v[64:79], v[212:215], v[60:63], v[64:79]
  v_mfma_f32_32x32x16_f16 v[96:111], v[208:211], v[44:47], v[96:111]
  ds_read_b128 v[208:211], v4 offset:7168
  ds_read_b128 v[212:215], v4 offset:15360
  s_waitcnt lgkmcnt(6)
  v_mfma_f32_32x32x16_f16 v[80:95], v[184:187], v[16:19], 0
  v_mfma_f32_32x32x16_f16 v[112:127], v[188:191], v[16:19], 0
  v_mfma_f32_32x32x16_f16 v[80:95], v[188:191], v[48:51], v[80:95]
  v_mfma_f32_32x32x16_f16 v[112:127], v[184:187], v[32:35], v[112:127]
  s_waitcnt lgkmcnt(4)
  v_mfma_f32_32x32x16_f16 v[80:95], v[192:195], v[20:23], v[80:95]
  v_mfma_f32_32x32x16_f16 v[112:127], v[196:199], v[20:23], v[112:127]
  v_mfma_f32_32x32x16_f16 v[80:95], v[196:199], v[52:55], v[80:95]
  v_mfma_f32_32x32x16_f16 v[112:127], v[192:195], v[36:39], v[112:127]
  s_waitcnt lgkmcnt(2)
  v_mfma_f32_32x32x16_f16 v[80:95], v[200:203], v[24:27], v[80:95]
  v_mfma_f32_32x32x16_f16 v[112:127], v[204:207], v[24:27], v[112:127]
  v_mfma_f32_32x32x16_f16 v[80:95], v[204:207], v[56:59], v[80:95]
  v_mfma_f32_32x32x16_f16 v[112:127], v[200:203], v[40:43], v[112:127]
  s_waitcnt lgkmcnt(0)
  v_mfma_f32_32x32x16_f16 v[80:95], v[208:211], v[28:31], v[80:95]
  v_mfma_f32_32x32x16_f16 v[112:127], v[212:215], v[28:31], v[112:127]
  v_mfma_f32_32x32x16_f16 v[80:95], v[212:215], v[60:63], v[80:95]
  v_mfma_f32_32x32x16_f16 v[112:127], v[208:211], v[44:47], v[112:127]
  s_waitcnt vmcnt(0)
  v_lshlrev_b32 v216, 16, v128
  v_and_b32 v220, 0xffff0000, v128
  v_lshlrev_b32 v217, 16, v129
  v_and_b32 v221, 0xffff0000, v129
  v_lshlrev_b32 v218, 16, v130
  v_and_b32 v222, 0xffff0000, v130
  v_lshlrev_b32 v219, 16, v131
  v_and_b32 v223, 0xffff0000, v131
  v_mul_f32 v216, s56, v216
  v_mul_f32 v217, s56, v217
  v_mul_f32 v218, s56, v218
  v_mul_f32 v219, s56, v219
  v_mul_f32 v220, s56, v220
  v_mul_f32 v221, s56, v221
  v_mul_f32 v222, s56, v222
  v_mul_f32 v223, s56, v223
  v_mul_f32 v8, v64, v216
  v_mul_f32 v12, v64, v220
  v_mul_f32 v9, v65, v217
  v_mul_f32 v13, v65, v221
  v_mul_f32 v10, v66, v218
  v_mul_f32 v14, v66, v222
  v_mul_f32 v11, v67, v219
  v_mul_f32 v15, v67, v223
  v_fma_f32 v8, -v96, v220, v8
  v_fmac_f32 v12, v96, v216
  v_fma_f32 v9, -v97, v221, v9
  v_fmac_f32 v13, v97, v217
  v_fma_f32 v10, -v98, v222, v10
  v_fmac_f32 v14, v98, v218
  v_fma_f32 v11, -v99, v223, v11
  v_fmac_f32 v15, v99, v219
  v_cvt_pk_f16_f32 v16, v8, v9
  v_cvt_pk_f16_f32 v32, v12, v13
  v_cvt_pk_f16_f32 v17, v10, v11
  v_cvt_pk_f16_f32 v33, v14, v15
  v_xor_b32 v48, 0x80008000, v16
  v_xor_b32 v49, 0x80008000, v17
  v_lshlrev_b32 v224, 16, v132
  v_and_b32 v228, 0xffff0000, v132
  v_lshlrev_b32 v225, 16, v133
  v_and_b32 v229, 0xffff0000, v133
  v_lshlrev_b32 v226, 16, v134
  v_and_b32 v230, 0xffff0000, v134
  v_lshlrev_b32 v227, 16, v135
  v_and_b32 v231, 0xffff0000, v135
  v_mul_f32 v224, s56, v224
  v_mul_f32 v225, s56, v225
  v_mul_f32 v226, s56, v226
  v_mul_f32 v227, s56, v227
  v_mul_f32 v228, s56, v228
  v_mul_f32 v229, s56, v229
  v_mul_f32 v230, s56, v230
  v_mul_f32 v231, s56, v231
  v_mul_f32 v8, v68, v224
  v_mul_f32 v12, v68, v228
  v_mul_f32 v9, v69, v225
  v_mul_f32 v13, v69, v229
  v_mul_f32 v10, v70, v226
  v_mul_f32 v14, v70, v230
  v_mul_f32 v11, v71, v227
  v_mul_f32 v15, v71, v231
  v_fma_f32 v8, -v100, v228, v8
  v_fmac_f32 v12, v100, v224
  v_fma_f32 v9, -v101, v229, v9
  v_fmac_f32 v13, v101, v225
  v_fma_f32 v10, -v102, v230, v10
  v_fmac_f32 v14, v102, v226
  v_fma_f32 v11, -v103, v231, v11
  v_fmac_f32 v15, v103, v227
  v_cvt_pk_f16_f32 v18, v8, v9
  v_cvt_pk_f16_f32 v34, v12, v13
  v_cvt_pk_f16_f32 v19, v10, v11
  v_cvt_pk_f16_f32 v35, v14, v15
  v_xor_b32 v50, 0x80008000, v18
  v_xor_b32 v51, 0x80008000, v19
  v_lshlrev_b32 v232, 16, v136
  v_and_b32 v236, 0xffff0000, v136
  v_lshlrev_b32 v233, 16, v137
  v_and_b32 v237, 0xffff0000, v137
  v_lshlrev_b32 v234, 16, v138
  v_and_b32 v238, 0xffff0000, v138
  v_lshlrev_b32 v235, 16, v139
  v_and_b32 v239, 0xffff0000, v139
  v_mul_f32 v232, s56, v232
  v_mul_f32 v233, s56, v233
  v_mul_f32 v234, s56, v234
  v_mul_f32 v235, s56, v235
  v_mul_f32 v236, s56, v236
  v_mul_f32 v237, s56, v237
  v_mul_f32 v238, s56, v238
  v_mul_f32 v239, s56, v239
  v_mul_f32 v8, v72, v232
  v_mul_f32 v12, v72, v236
  v_mul_f32 v9, v73, v233
  v_mul_f32 v13, v73, v237
  v_mul_f32 v10, v74, v234
  v_mul_f32 v14, v74, v238
  v_mul_f32 v11, v75, v235
  v_mul_f32 v15, v75, v239
  v_fma_f32 v8, -v104, v236, v8
  v_fmac_f32 v12, v104, v232
  v_fma_f32 v9, -v105, v237, v9
  v_fmac_f32 v13, v105, v233
  v_fma_f32 v10, -v106, v238, v10
  v_fmac_f32 v14, v106, v234
  v_fma_f32 v11, -v107, v239, v11
  v_fmac_f32 v15, v107, v235
  v_cvt_pk_f16_f32 v20, v8, v9
  v_cvt_pk_f16_f32 v36, v12, v13
  v_cvt_pk_f16_f32 v21, v10, v11
  v_cvt_pk_f16_f32 v37, v14, v15
  v_xor_b32 v52, 0x80008000, v20
  v_xor_b32 v53, 0x80008000, v21
  v_lshlrev_b32 v216, 16, v140
  v_and_b32 v220, 0xffff0000, v140
  v_lshlrev_b32 v217, 16, v141
  v_and_b32 v221, 0xffff0000, v141
  v_lshlrev_b32 v218, 16, v142
  v_and_b32 v222, 0xffff0000, v142
  v_lshlrev_b32 v219, 16, v143
  v_and_b32 v223, 0xffff0000, v143
  v_mul_f32 v216, s56, v216
  v_mul_f32 v217, s56, v217
  v_mul_f32 v218, s56, v218
  v_mul_f32 v219, s56, v219
  v_mul_f32 v220, s56, v220
  v_mul_f32 v221, s56, v221
  v_mul_f32 v222, s56, v222
  v_mul_f32 v223, s56, v223
  v_mul_f32 v8, v76, v216
  v_mul_f32 v12, v76, v220
  v_mul_f32 v9, v77, v217
  v_mul_f32 v13, v77, v221
  v_mul_f32 v10, v78, v218
  v_mul_f32 v14, v78, v222
  v_mul_f32 v11, v79, v219
  v_mul_f32 v15, v79, v223
  v_fma_f32 v8, -v108, v220, v8
  v_fmac_f32 v12, v108, v216
  v_fma_f32 v9, -v109, v221, v9
  v_fmac_f32 v13, v109, v217
  v_fma_f32 v10, -v110, v222, v10
  v_fmac_f32 v14, v110, v218
  v_fma_f32 v11, -v111, v223, v11
  v_fmac_f32 v15, v111, v219
  v_cvt_pk_f16_f32 v22, v8, v9
  v_cvt_pk_f16_f32 v38, v12, v13
  v_cvt_pk_f16_f32 v23, v10, v11
  v_cvt_pk_f16_f32 v39, v14, v15
  v_xor_b32 v54, 0x80008000, v22
  v_xor_b32 v55, 0x80008000, v23
  v_lshlrev_b32 v224, 16, v144
  v_and_b32 v228, 0xffff0000, v144
  v_lshlrev_b32 v225, 16, v145
  v_and_b32 v229, 0xffff0000, v145
  v_lshlrev_b32 v226, 16, v146
  v_and_b32 v230, 0xffff0000, v146
  v_lshlrev_b32 v227, 16, v147
  v_and_b32 v231, 0xffff0000, v147
  v_mul_f32 v224, s56, v224
  v_mul_f32 v225, s56, v225
  v_mul_f32 v226, s56, v226
  v_mul_f32 v227, s56, v227
  v_mul_f32 v228, s56, v228
  v_mul_f32 v229, s56, v229
  v_mul_f32 v230, s56, v230
  v_mul_f32 v231, s56, v231
  v_mul_f32 v8, v80, v224
  v_mul_f32 v12, v80, v228
  v_mul_f32 v9, v81, v225
  v_mul_f32 v13, v81, v229
  v_mul_f32 v10, v82, v226
  v_mul_f32 v14, v82, v230
  v_mul_f32 v11, v83, v227
  v_mul_f32 v15, v83, v231
  v_fma_f32 v8, -v112, v228, v8
  v_fmac_f32 v12, v112, v224
  v_fma_f32 v9, -v113, v229, v9
  v_fmac_f32 v13, v113, v225
  v_fma_f32 v10, -v114, v230, v10
  v_fmac_f32 v14, v114, v226
  v_fma_f32 v11, -v115, v231, v11
  v_fmac_f32 v15, v115, v227
  v_cvt_pk_f16_f32 v24, v8, v9
  v_cvt_pk_f16_f32 v40, v12, v13
  v_cvt_pk_f16_f32 v25, v10, v11
  v_cvt_pk_f16_f32 v41, v14, v15
  v_xor_b32 v56, 0x80008000, v24
  v_xor_b32 v57, 0x80008000, v25
  v_lshlrev_b32 v232, 16, v148
  v_and_b32 v236, 0xffff0000, v148
  v_lshlrev_b32 v233, 16, v149
  v_and_b32 v237, 0xffff0000, v149
  v_lshlrev_b32 v234, 16, v150
  v_and_b32 v238, 0xffff0000, v150
  v_lshlrev_b32 v235, 16, v151
  v_and_b32 v239, 0xffff0000, v151
  v_mul_f32 v232, s56, v232
  v_mul_f32 v233, s56, v233
  v_mul_f32 v234, s56, v234
  v_mul_f32 v235, s56, v235
  v_mul_f32 v236, s56, v236
  v_mul_f32 v237, s56, v237
  v_mul_f32 v238, s56, v238
  v_mul_f32 v239, s56, v239
  v_mul_f32 v8, v84, v232
  v_mul_f32 v12, v84, v236
  v_mul_f32 v9, v85, v233
  v_mul_f32 v13, v85, v237
  v_mul_f32 v10, v86, v234
  v_mul_f32 v14, v86, v238
  v_mul_f32 v11, v87, v235
  v_mul_f32 v15, v87, v239
  v_fma_f32 v8, -v116, v236, v8
  v_fmac_f32 v12, v116, v232
  v_fma_f32 v9, -v117, v237, v9
  v_fmac_f32 v13, v117, v233
  v_fma_f32 v10, -v118, v238, v10
  v_fmac_f32 v14, v118, v234
  v_fma_f32 v11, -v119, v239, v11
  v_fmac_f32 v15, v119, v235
  v_cvt_pk_f16_f32 v26, v8, v9
  v_cvt_pk_f16_f32 v42, v12, v13
  v_cvt_pk_f16_f32 v27, v10, v11
  v_cvt_pk_f16_f32 v43, v14, v15
  v_xor_b32 v58, 0x80008000, v26
  v_xor_b32 v59, 0x80008000, v27
  v_lshlrev_b32 v216, 16, v152
  v_and_b32 v220, 0xffff0000, v152
  v_lshlrev_b32 v217, 16, v153
  v_and_b32 v221, 0xffff0000, v153
  v_lshlrev_b32 v218, 16, v154
  v_and_b32 v222, 0xffff0000, v154
  v_lshlrev_b32 v219, 16, v155
  v_and_b32 v223, 0xffff0000, v155
  v_mul_f32 v216, s56, v216
  v_mul_f32 v217, s56, v217
  v_mul_f32 v218, s56, v218
  v_mul_f32 v219, s56, v219
  v_mul_f32 v220, s56, v220
  v_mul_f32 v221, s56, v221
  v_mul_f32 v222, s56, v222
  v_mul_f32 v223, s56, v223
  v_mul_f32 v8, v88, v216
  v_mul_f32 v12, v88, v220
  v_mul_f32 v9, v89, v217
  v_mul_f32 v13, v89, v221
  v_mul_f32 v10, v90, v218
  v_mul_f32 v14, v90, v222
  v_mul_f32 v11, v91, v219
  v_mul_f32 v15, v91, v223
  v_fma_f32 v8, -v120, v220, v8
  v_fmac_f32 v12, v120, v216
  v_fma_f32 v9, -v121, v221, v9
  v_fmac_f32 v13, v121, v217
  v_fma_f32 v10, -v122, v222, v10
  v_fmac_f32 v14, v122, v218
  v_fma_f32 v11, -v123, v223, v11
  v_fmac_f32 v15, v123, v219
  v_cvt_pk_f16_f32 v28, v8, v9
  v_cvt_pk_f16_f32 v44, v12, v13
  v_cvt_pk_f16_f32 v29, v10, v11
  v_cvt_pk_f16_f32 v45, v14, v15
  v_xor_b32 v60, 0x80008000, v28
  v_xor_b32 v61, 0x80008000, v29
  v_lshlrev_b32 v224, 16, v156
  v_and_b32 v228, 0xffff0000, v156
  v_lshlrev_b32 v225, 16, v157
  v_and_b32 v229, 0xffff0000, v157
  v_lshlrev_b32 v226, 16, v158
  v_and_b32 v230, 0xffff0000, v158
  v_lshlrev_b32 v227, 16, v159
  v_and_b32 v231, 0xffff0000, v159
  v_mul_f32 v224, s56, v224
  v_mul_f32 v225, s56, v225
  v_mul_f32 v226, s56, v226
  v_mul_f32 v227, s56, v227
  v_mul_f32 v228, s56, v228
  v_mul_f32 v229, s56, v229
  v_mul_f32 v230, s56, v230
  v_mul_f32 v231, s56, v231
  v_mul_f32 v8, v92, v224
  v_mul_f32 v12, v92, v228
  v_mul_f32 v9, v93, v225
  v_mul_f32 v13, v93, v229
  v_mul_f32 v10, v94, v226
  v_mul_f32 v14, v94, v230
  v_mul_f32 v11, v95, v227
  v_mul_f32 v15, v95, v231
  v_fma_f32 v8, -v124, v228, v8
  v_fmac_f32 v12, v124, v224
  v_fma_f32 v9, -v125, v229, v9
  v_fmac_f32 v13, v125, v225
  v_fma_f32 v10, -v126, v230, v10
  v_fmac_f32 v14, v126, v226
  v_fma_f32 v11, -v127, v231, v11
  v_fmac_f32 v15, v127, v227
  v_cvt_pk_f16_f32 v30, v8, v9
  v_cvt_pk_f16_f32 v46, v12, v13
  v_cvt_pk_f16_f32 v31, v10, v11
  v_cvt_pk_f16_f32 v47, v14, v15
  v_xor_b32 v62, 0x80008000, v30
  v_xor_b32 v63, 0x80008000, v31
  ds_read_b128 v[184:187], v4 offset:0
  ds_read_b128 v[188:191], v4 offset:8192
  ds_read_b128 v[192:195], v4 offset:1024
  ds_read_b128 v[196:199], v4 offset:9216
  ds_read_b128 v[200:203], v4 offset:2048
  ds_read_b128 v[204:207], v4 offset:10240
  ds_read_b128 v[208:211], v4 offset:3072
  ds_read_b128 v[212:215], v4 offset:11264
  s_waitcnt lgkmcnt(6)
  v_mfma_f32_32x32x16_f16 v[64:79], v[16:19], v[184:187], 0
  v_mfma_f32_32x32x16_f16 v[96:111], v[32:35], v[184:187], 0
  v_mfma_f32_32x32x16_f16 v[64:79], v[32:35], v[188:191], v[64:79]
  v_mfma_f32_32x32x16_f16 v[96:111], v[48:51], v[188:191], v[96:111]
  ds_read_b128 v[184:187], v4 offset:4096
  ds_read_b128 v[188:191], v4 offset:12288
  s_waitcnt lgkmcnt(6)
  v_mfma_f32_32x32x16_f16 v[64:79], v[20:23], v[192:195], v[64:79]
  v_mfma_f32_32x32x16_f16 v[96:111], v[36:39], v[192:195], v[96:111]
  v_mfma_f32_32x32x16_f16 v[64:79], v[36:39], v[196:199], v[64:79]
  v_mfma_f32_32x32x16_f16 v[96:111], v[52:55], v[196:199], v[96:111]
  ds_read_b128 v[192:195], v4 offset:5120
  ds_read_b128 v[196:199], v4 offset:13312
  s_waitcnt lgkmcnt(6)
  v_mfma_f32_32x32x16_f16 v[64:79], v[24:27], v[200:203], v[64:79]
  v_mfma_f32_32x32x16_f16 v[96:111], v[40:43], v[200:203], v[96:111]
  v_mfma_f32_32x32x16_f16 v[64:79], v[40:43], v[204:207], v[64:79]
  v_mfma_f32_32x32x16_f16 v[96:111], v[56:59], v[204:207], v[96:111]
  ds_read_b128 v[200:203], v4 offset:6144
  ds_read_b128 v[204:207], v4 offset:14336
  s_waitcnt lgkmcnt(6)
  v_mfma_f32_32x32x16_f16 v[64:79], v[28:31], v[208:211], v[64:79]
  v_mfma_f32_32x32x16_f16 v[96:111], v[44:47], v[208:211], v[96:111]
  v_mfma_f32_32x32x16_f16 v[64:79], v[44:47], v[212:215], v[64:79]
  v_mfma_f32_32x32x16_f16 v[96:111], v[60:63], v[212:215], v[96:111]
  ds_read_b128 v[208:211], v4 offset:7168
  ds_read_b128 v[212:215], v4 offset:15360
  s_waitcnt lgkmcnt(6)
  v_mfma_f32_32x32x16_f16 v[80:95], v[16:19], v[184:187], 0
  v_mfma_f32_32x32x16_f16 v[112:127], v[32:35], v[184:187], 0
  v_mfma_f32_32x32x16_f16 v[80:95], v[32:35], v[188:191], v[80:95]
  v_mfma_f32_32x32x16_f16 v[112:127], v[48:51], v[188:191], v[112:127]
  s_waitcnt lgkmcnt(4)
  v_mfma_f32_32x32x16_f16 v[80:95], v[20:23], v[192:195], v[80:95]
  v_mfma_f32_32x32x16_f16 v[112:127], v[36:39], v[192:195], v[112:127]
  v_mfma_f32_32x32x16_f16 v[80:95], v[36:39], v[196:199], v[80:95]
  v_mfma_f32_32x32x16_f16 v[112:127], v[52:55], v[196:199], v[112:127]
  s_waitcnt lgkmcnt(2)
  v_mfma_f32_32x32x16_f16 v[80:95], v[24:27], v[200:203], v[80:95]
  v_mfma_f32_32x32x16_f16 v[112:127], v[40:43], v[200:203], v[112:127]
  v_mfma_f32_32x32x16_f16 v[80:95], v[40:43], v[204:207], v[80:95]
  v_mfma_f32_32x32x16_f16 v[112:127], v[56:59], v[204:207], v[112:127]
  s_waitcnt lgkmcnt(0)
  v_mfma_f32_32x32x16_f16 v[80:95], v[28:31], v[208:211], v[80:95]
  v_mfma_f32_32x32x16_f16 v[112:127], v[44:47], v[208:211], v[112:127]
  v_mfma_f32_32x32x16_f16 v[80:95], v[44:47], v[212:215], v[80:95]
  v_mfma_f32_32x32x16_f16 v[112:127], v[60:63], v[212:215], v[112:127]
  ds_read_b128 v[216:219], v4 offset:32768
  ds_read_b128 v[220:223], v4 offset:33792
  ds_read_b128 v[224:227], v4 offset:34816
  ds_read_b128 v[228:231], v4 offset:35840
  ds_read_b128 v[232:235], v4 offset:36864
  ds_read_b128 v[236:239], v4 offset:37888
  s_waitcnt lgkmcnt(4)
  v_mul_f32 v8, v64, v216
  v_mul_f32 v12, v64, v220
  v_mul_f32 v9, v65, v217
  v_mul_f32 v13, v65, v221
  v_mul_f32 v10, v66, v218
  v_mul_f32 v14, v66, v222
  v_mul_f32 v11, v67, v219
  v_mul_f32 v15, v67, v223
  v_fma_f32 v8, -v96, v220, v8
  v_fmac_f32 v12, v96, v216
  v_fma_f32 v9, -v97, v221, v9
  v_fmac_f32 v13, v97, v217
  v_fma_f32 v10, -v98, v222, v10
  v_fmac_f32 v14, v98, v218
  v_fma_f32 v11, -v99, v223, v11
  v_fmac_f32 v15, v99, v219
  v_cvt_pk_f16_f32 v16, v8, v9
  v_cvt_pk_f16_f32 v32, v12, v13
  v_cvt_pk_f16_f32 v17, v10, v11
  v_cvt_pk_f16_f32 v33, v14, v15
  ds_read_b128 v[216:219], v4 offset:38912
  ds_read_b128 v[220:223], v4 offset:39936
  s_waitcnt lgkmcnt(4)
  v_mul_f32 v8, v68, v224
  v_mul_f32 v12, v68, v228
  v_mul_f32 v9, v69, v225
  v_mul_f32 v13, v69, v229
  v_mul_f32 v10, v70, v226
  v_mul_f32 v14, v70, v230
  v_mul_f32 v11, v71, v227
  v_mul_f32 v15, v71, v231
  v_fma_f32 v8, -v100, v228, v8
  v_fmac_f32 v12, v100, v224
  v_fma_f32 v9, -v101, v229, v9
  v_fmac_f32 v13, v101, v225
  v_fma_f32 v10, -v102, v230, v10
  v_fmac_f32 v14, v102, v226
  v_fma_f32 v11, -v103, v231, v11
  v_fmac_f32 v15, v103, v227
  v_cvt_pk_f16_f32 v18, v8, v9
  v_cvt_pk_f16_f32 v34, v12, v13
  v_cvt_pk_f16_f32 v19, v10, v11
  v_cvt_pk_f16_f32 v35, v14, v15
  ds_read_b128 v[224:227], v4 offset:40960
  ds_read_b128 v[228:231], v4 offset:41984
  s_waitcnt lgkmcnt(4)
  v_mul_f32 v8, v72, v232
  v_mul_f32 v12, v72, v236
  v_mul_f32 v9, v73, v233
  v_mul_f32 v13, v73, v237
  v_mul_f32 v10, v74, v234
  v_mul_f32 v14, v74, v238
  v_mul_f32 v11, v75, v235
  v_mul_f32 v15, v75, v239
  v_fma_f32 v8, -v104, v236, v8
  v_fmac_f32 v12, v104, v232
  v_fma_f32 v9, -v105, v237, v9
  v_fmac_f32 v13, v105, v233
  v_fma_f32 v10, -v106, v238, v10
  v_fmac_f32 v14, v106, v234
  v_fma_f32 v11, -v107, v239, v11
  v_fmac_f32 v15, v107, v235
  v_cvt_pk_f16_f32 v20, v8, v9
  v_cvt_pk_f16_f32 v36, v12, v13
  v_cvt_pk_f16_f32 v21, v10, v11
  v_cvt_pk_f16_f32 v37, v14, v15
  ds_read_b128 v[232:235], v4 offset:43008
  ds_read_b128 v[236:239], v4 offset:44032
  s_waitcnt lgkmcnt(4)
  v_mul_f32 v8, v76, v216
  v_mul_f32 v12, v76, v220
  v_mul_f32 v9, v77, v217
  v_mul_f32 v13, v77, v221
  v_mul_f32 v10, v78, v218
  v_mul_f32 v14, v78, v222
  v_mul_f32 v11, v79, v219
  v_mul_f32 v15, v79, v223
  v_fma_f32 v8, -v108, v220, v8
  v_fmac_f32 v12, v108, v216
  v_fma_f32 v9, -v109, v221, v9
  v_fmac_f32 v13, v109, v217
  v_fma_f32 v10, -v110, v222, v10
  v_fmac_f32 v14, v110, v218
  v_fma_f32 v11, -v111, v223, v11
  v_fmac_f32 v15, v111, v219
  v_cvt_pk_f16_f32 v22, v8, v9
  v_cvt_pk_f16_f32 v38, v12, v13
  v_cvt_pk_f16_f32 v23, v10, v11
  v_cvt_pk_f16_f32 v39, v14, v15
  ds_read_b128 v[216:219], v4 offset:45056
  ds_read_b128 v[220:223], v4 offset:46080
  s_waitcnt lgkmcnt(4)
  v_mul_f32 v8, v80, v224
  v_mul_f32 v12, v80, v228
  v_mul_f32 v9, v81, v225
  v_mul_f32 v13, v81, v229
  v_mul_f32 v10, v82, v226
  v_mul_f32 v14, v82, v230
  v_mul_f32 v11, v83, v227
  v_mul_f32 v15, v83, v231
  v_fma_f32 v8, -v112, v228, v8
  v_fmac_f32 v12, v112, v224
  v_fma_f32 v9, -v113, v229, v9
  v_fmac_f32 v13, v113, v225
  v_fma_f32 v10, -v114, v230, v10
  v_fmac_f32 v14, v114, v226
  v_fma_f32 v11, -v115, v231, v11
  v_fmac_f32 v15, v115, v227
  v_cvt_pk_f16_f32 v24, v8, v9
  v_cvt_pk_f16_f32 v40, v12, v13
  v_cvt_pk_f16_f32 v25, v10, v11
  v_cvt_pk_f16_f32 v41, v14, v15
  ds_read_b128 v[224:227], v4 offset:47104
  ds_read_b128 v[228:231], v4 offset:48128
  s_waitcnt lgkmcnt(4)
  v_mul_f32 v8, v84, v232
  v_mul_f32 v12, v84, v236
  v_mul_f32 v9, v85, v233
  v_mul_f32 v13, v85, v237
  v_mul_f32 v10, v86, v234
  v_mul_f32 v14, v86, v238
  v_mul_f32 v11, v87, v235
  v_mul_f32 v15, v87, v239
  v_fma_f32 v8, -v116, v236, v8
  v_fmac_f32 v12, v116, v232
  v_fma_f32 v9, -v117, v237, v9
  v_fmac_f32 v13, v117, v233
  v_fma_f32 v10, -v118, v238, v10
  v_fmac_f32 v14, v118, v234
  v_fma_f32 v11, -v119, v239, v11
  v_fmac_f32 v15, v119, v235
  v_cvt_pk_f16_f32 v26, v8, v9
  v_cvt_pk_f16_f32 v42, v12, v13
  v_cvt_pk_f16_f32 v27, v10, v11
  v_cvt_pk_f16_f32 v43, v14, v15
  s_waitcnt lgkmcnt(2)
  v_mul_f32 v8, v88, v216
  v_mul_f32 v12, v88, v220
  v_mul_f32 v9, v89, v217
  v_mul_f32 v13, v89, v221
  v_mul_f32 v10, v90, v218
  v_mul_f32 v14, v90, v222
  v_mul_f32 v11, v91, v219
  v_mul_f32 v15, v91, v223
  v_fma_f32 v8, -v120, v220, v8
  v_fmac_f32 v12, v120, v216
  v_fma_f32 v9, -v121, v221, v9
  v_fmac_f32 v13, v121, v217
  v_fma_f32 v10, -v122, v222, v10
  v_fmac_f32 v14, v122, v218
  v_fma_f32 v11, -v123, v223, v11
  v_fmac_f32 v15, v123, v219
  v_cvt_pk_f16_f32 v28, v8, v9
  v_cvt_pk_f16_f32 v44, v12, v13
  v_cvt_pk_f16_f32 v29, v10, v11
  v_cvt_pk_f16_f32 v45, v14, v15
  s_waitcnt lgkmcnt(0)
  v_mul_f32 v8, v92, v224
  v_mul_f32 v12, v92, v228
  v_mul_f32 v9, v93, v225
  v_mul_f32 v13, v93, v229
  v_mul_f32 v10, v94, v226
  v_mul_f32 v14, v94, v230
  v_mul_f32 v11, v95, v227
  v_mul_f32 v15, v95, v231
  v_fma_f32 v8, -v124, v228, v8
  v_fmac_f32 v12, v124, v224
  v_fma_f32 v9, -v125, v229, v9
  v_fmac_f32 v13, v125, v225
  v_fma_f32 v10, -v126, v230, v10
  v_fmac_f32 v14, v126, v226
  v_fma_f32 v11, -v127, v231, v11
  v_fmac_f32 v15, v127, v227
  v_cvt_pk_f16_f32 v30, v8, v9
  v_cvt_pk_f16_f32 v46, v12, v13
  v_cvt_pk_f16_f32 v31, v10, v11
  v_cvt_pk_f16_f32 v47, v14, v15
  v_mfma_f32_32x32x16_f16 v[64:79], v[16:19], v[160:163], 0
  v_mfma_f32_32x32x16_f16 v[96:111], v[32:35], v[160:163], 0
  v_mfma_f32_32x32x16_f16 v[64:79], v[32:35], v[168:171], v[64:79]
  v_mfma_f32_32x32x16_f16 v[96:111], v[16:19], v[176:179], v[96:111]
  v_mfma_f32_32x32x16_f16 v[64:79], v[20:23], v[164:167], v[64:79]
  v_mfma_f32_32x32x16_f16 v[96:111], v[36:39], v[164:167], v[96:111]
  v_mfma_f32_32x32x16_f16 v[64:79], v[36:39], v[172:175], v[64:79]
  v_mfma_f32_32x32x16_f16 v[96:111], v[20:23], v[180:183], v[96:111]
  v_mfma_f32_32x32x16_f16 v[80:95], v[24:27], v[160:163], 0
  v_mfma_f32_32x32x16_f16 v[112:127], v[40:43], v[160:163], 0
  v_mfma_f32_32x32x16_f16 v[80:95], v[40:43], v[168:171], v[80:95]
  v_mfma_f32_32x32x16_f16 v[112:127], v[24:27], v[176:179], v[112:127]
  v_mfma_f32_32x32x16_f16 v[80:95], v[28:31], v[164:167], v[80:95]
  v_mfma_f32_32x32x16_f16 v[112:127], v[44:47], v[164:167], v[112:127]
  v_mfma_f32_32x32x16_f16 v[80:95], v[44:47], v[172:175], v[80:95]
  v_mfma_f32_32x32x16_f16 v[112:127], v[28:31], v[180:183], v[112:127]
  v_and_b32 v7, 16, v5
  v_bfe_u32 v8, v5, 2, 1
  v_lshl_add_u32 v7, v8, 3, v7
  v_add_u32 v7, v7, v6
  s_mov_b32 s53, 57344
  v_mul_lo_u32 v7, v7, s53
  v_bfe_u32 v8, v5, 3, 1
  v_lshl_add_u32 v7, v8, 6, v7
  v_and_b32 v8, 3, v5
  v_lshl_add_u32 v7, v8, 4, v7
  s_lshr_b32 s51, s48, 5
  s_add_u32 s51, s51, 16777216
  s_bfe_u32 s52, s48, 0x1000d
  s_lshl_b32 s52, s52, 6
  v_xor_b32 v9, s52, v7
  v_cvt_pk_f16_f32 v128, v64, v65
  v_cvt_pk_f16_f32 v129, v66, v67
  v_cvt_pk_f16_f32 v130, v68, v69
  v_cvt_pk_f16_f32 v131, v70, v71
  s_nop 0
  v_permlane32_swap_b32 v128, v130
  v_permlane32_swap_b32 v129, v131
  s_add_u32 s53, s51, 0
  buffer_store_dwordx4 v[128:131], v9, s[12:15], s53 offen sc1
  v_cvt_pk_f16_f32 v132, v72, v73
  v_cvt_pk_f16_f32 v133, v74, v75
  v_cvt_pk_f16_f32 v134, v76, v77
  v_cvt_pk_f16_f32 v135, v78, v79
  s_nop 0
  v_permlane32_swap_b32 v132, v134
  v_permlane32_swap_b32 v133, v135
  s_add_u32 s53, s51, 114688
  buffer_store_dwordx4 v[132:135], v9, s[12:15], s53 offen sc1
  v_cvt_pk_f16_f32 v136, v80, v81
  v_cvt_pk_f16_f32 v137, v82, v83
  v_cvt_pk_f16_f32 v138, v84, v85
  v_cvt_pk_f16_f32 v139, v86, v87
  s_nop 0
  v_permlane32_swap_b32 v136, v138
  v_permlane32_swap_b32 v137, v139
  s_add_u32 s53, s51, 229376
  buffer_store_dwordx4 v[136:139], v9, s[12:15], s53 offen sc1
  v_cvt_pk_f16_f32 v140, v88, v89
  v_cvt_pk_f16_f32 v141, v90, v91
  v_cvt_pk_f16_f32 v142, v92, v93
  v_cvt_pk_f16_f32 v143, v94, v95
  s_nop 0
  v_permlane32_swap_b32 v140, v142
  v_permlane32_swap_b32 v141, v143
  s_add_u32 s53, s51, 344064
  buffer_store_dwordx4 v[140:143], v9, s[12:15], s53 offen sc1
  s_cmp_lg_u32 s58, 0
  s_cbranch_scc1 L_FDONE
  s_lshr_b32 s51, s49, 5
  s_add_u32 s51, s51, 16777216
  s_bfe_u32 s52, s49, 0x1000d
  s_lshl_b32 s52, s52, 6
  v_xor_b32 v9, s52, v7
  v_cvt_pk_f16_f32 v144, v96, v97
  v_cvt_pk_f16_f32 v145, v98, v99
  v_cvt_pk_f16_f32 v146, v100, v101
  v_cvt_pk_f16_f32 v147, v102, v103
  s_nop 0
  v_permlane32_swap_b32 v144, v146
  v_permlane32_swap_b32 v145, v147
  s_add_u32 s53, s51, 0
  buffer_store_dwordx4 v[144:147], v9, s[12:15], s53 offen sc1
  v_cvt_pk_f16_f32 v148, v104, v105
  v_cvt_pk_f16_f32 v149, v106, v107
  v_cvt_pk_f16_f32 v150, v108, v109
  v_cvt_pk_f16_f32 v151, v110, v111
  s_nop 0
  v_permlane32_swap_b32 v148, v150
  v_permlane32_swap_b32 v149, v151
  s_add_u32 s53, s51, 114688
  buffer_store_dwordx4 v[148:151], v9, s[12:15], s53 offen sc1
  v_cvt_pk_f16_f32 v152, v112, v113
  v_cvt_pk_f16_f32 v153, v114, v115
  v_cvt_pk_f16_f32 v154, v116, v117
  v_cvt_pk_f16_f32 v155, v118, v119
  s_nop 0
  v_permlane32_swap_b32 v152, v154
  v_permlane32_swap_b32 v153, v155
  s_add_u32 s53, s51, 229376
  buffer_store_dwordx4 v[152:155], v9, s[12:15], s53 offen sc1
  v_cvt_pk_f16_f32 v156, v120, v121
  v_cvt_pk_f16_f32 v157, v122, v123
  v_cvt_pk_f16_f32 v158, v124, v125
  v_cvt_pk_f16_f32 v159, v126, v127
  s_nop 0
  v_permlane32_swap_b32 v156, v158
  v_permlane32_swap_b32 v157, v159
  s_add_u32 s53, s51, 344064
  buffer_store_dwordx4 v[156:159], v9, s[12:15], s53 offen sc1
L_FDONE:
  s_waitcnt vmcnt(0)
  v_mov_b32 v8, 156672
  v_mov_b32 v9, 1
  s_mov_b64 exec, 1
  ds_add_rtn_u32 v9, v8, v9
  s_waitcnt lgkmcnt(0)
  v_readfirstlane_b32 s49, v9
  s_cmp_eq_u32 s43, 0
  s_cselect_b32 s50, 7, 6
  s_cmp_lg_u32 s49, s50
  s_cbranch_scc1 L_NFY
  s_lshl_b32 s49, s43, 7
  s_add_u32 s49, s49, 20119552
  v_mov_b32 v249, s63
  buffer_store_dword v249, v248, s[12:15], s49 offen sc1
L_NFY:
  s_mov_b64 exec, -1
  s_endpgm
L_PFW:
  s_sub_u32 s58, s43, 1
  s_lshl_b32 s58, s58, 6
  v_add_u32 v13, s58, v1
  v_and_b32 v14, 2047, v13
  v_lshrrev_b32 v15, 11, v13
  v_min_u32 v15, 9, v15
  v_lshlrev_b32 v14, 12, v14
  v_lshl_add_u32 v14, v15, 7, v14
  buffer_load_dword v20, v14, s[24:27], 0 offen offset:2816
  v_add_u32 v13, 1984, v13
  v_and_b32 v14, 2047, v13
  v_lshrrev_b32 v15, 11, v13
  v_min_u32 v15, 9, v15
  v_lshlrev_b32 v14, 12, v14
  v_lshl_add_u32 v14, v15, 7, v14
  buffer_load_dword v21, v14, s[24:27], 0 offen offset:2816
  v_add_u32 v13, 1984, v13
  v_and_b32 v14, 2047, v13
  v_lshrrev_b32 v15, 11, v13
  v_min_u32 v15, 9, v15
  v_lshlrev_b32 v14, 12, v14
  v_lshl_add_u32 v14, v15, 7, v14
  buffer_load_dword v22, v14, s[24:27], 0 offen offset:2816
  v_add_u32 v13, 1984, v13
  v_and_b32 v14, 2047, v13
  v_lshrrev_b32 v15, 11, v13
  v_min_u32 v15, 9, v15
  v_lshlrev_b32 v14, 12, v14
  v_lshl_add_u32 v14, v15, 7, v14
  buffer_load_dword v23, v14, s[24:27], 0 offen offset:2816
  v_add_u32 v13, 1984, v13
  v_and_b32 v14, 2047, v13
  v_lshrrev_b32 v15, 11, v13
  v_min_u32 v15, 9, v15
  v_lshlrev_b32 v14, 12, v14
  v_lshl_add_u32 v14, v15, 7, v14
  buffer_load_dword v24, v14, s[24:27], 0 offen offset:2816
  v_add_u32 v13, 1984, v13
  v_and_b32 v14, 2047, v13
  v_lshrrev_b32 v15, 11, v13
  v_min_u32 v15, 9, v15
  v_lshlrev_b32 v14, 12, v14
  v_lshl_add_u32 v14, v15, 7, v14
  buffer_load_dword v25, v14, s[24:27], 0 offen offset:2816
  v_add_u32 v13, 1984, v13
  v_and_b32 v14, 2047, v13
  v_lshrrev_b32 v15, 11, v13
  v_min_u32 v15, 9, v15
  v_lshlrev_b32 v14, 12, v14
  v_lshl_add_u32 v14, v15, 7, v14
  buffer_load_dword v26, v14, s[24:27], 0 offen offset:2816
  v_add_u32 v13, 1984, v13
  v_and_b32 v14, 2047, v13
  v_lshrrev_b32 v15, 11, v13
  v_min_u32 v15, 9, v15
  v_lshlrev_b32 v14, 12, v14
  v_lshl_add_u32 v14, v15, 7, v14
  buffer_load_dword v27, v14, s[24:27], 0 offen offset:2816
  v_add_u32 v13, 1984, v13
  v_and_b32 v14, 2047, v13
  v_lshrrev_b32 v15, 11, v13
  v_min_u32 v15, 9, v15
  v_lshlrev_b32 v14, 12, v14
  v_lshl_add_u32 v14, v15, 7, v14
  buffer_load_dword v28, v14, s[24:27], 0 offen offset:2816
  v_add_u32 v13, 1984, v13
  v_and_b32 v14, 2047, v13
  v_lshrrev_b32 v15, 11, v13
  v_min_u32 v15, 9, v15
  v_lshlrev_b32 v14, 12, v14
  v_lshl_add_u32 v14, v15, 7, v14
  buffer_load_dword v29, v14, s[24:27], 0 offen offset:2816
  v_add_u32 v13, 1984, v13
  v_and_b32 v14, 2047, v13
  v_lshrrev_b32 v15, 11, v13
  v_min_u32 v15, 9, v15
  v_lshlrev_b32 v14, 12, v14
  v_lshl_add_u32 v14, v15, 7, v14
  buffer_load_dword v30, v14, s[24:27], 0 offen offset:2816
  v_add_u32 v13, 1984, v13
  s_endpgm
L_END:
  s_endpgm
.section .rodata,"a"
.p2align 6
.amdhsa_kernel recurrent_scan__spectral_gfnet__mixer_gmlp__prompt_kernel
  .amdhsa_next_free_vgpr 256
  .amdhsa_next_free_sgpr 102
  .amdhsa_accum_offset 256
  .amdhsa_group_segment_fixed_size 0
  .amdhsa_kernarg_size 88
  .amdhsa_user_sgpr_count 2
  .amdhsa_user_sgpr_kernarg_segment_ptr 1
  .amdhsa_system_sgpr_workgroup_id_x 1
  .amdhsa_float_denorm_mode_32 3
  .amdhsa_float_denorm_mode_16_64 3
.end_amdhsa_kernel

.section .rodata,"a"
.set FH0,15744
.set FL0,0
.set FH1,15744
.set FL1,46798
.set FH2,15744
.set FL2,47054
.set FH3,15744
.set FL3,47208
.set FH4,15744
.set FL4,47310
.set FH5,15743
.set FL5,14526
.set FH6,15743
.set FL6,14273
.set FH7,15743
.set FL7,47214
.set FH8,15742
.set FL8,14536
.set FH9,15742
.set FL9,46870
.set FH10,15741
.set FL10,14585
.set FH11,15741
.set FL11,46886
.set FH12,15740
.set FL12,14532
.set FH13,15740
.set FL13,47225
.set FH14,15739
.set FL14,14246
.set FH15,15738
.set FL15,14518
.set FH16,15738
.set FL16,47318
.set FH17,15737
.set FL17,47224
.set FH18,15736
.set FL18,47082
.set FH19,15735
.set FL19,46865
.set FH20,15734
.set FL20,46506
.set FH21,15733
.set FL21,46783
.set FH22,15732
.set FL22,47031
.set FH23,15731
.set FL23,47185
.set FH24,15730
.set FL24,47291
.set FH25,15728
.set FL25,14553
.set FH26,15727
.set FL26,14380
.set FH27,15726
.set FL27,47115
.set FH28,15725
.set FL28,47353
.set FH29,15723
.set FL29,14318
.set FH30,15722
.set FL30,47272
.set FH31,15720
.set FL31,14396
.set FH32,15719
.set FL32,47284
.set FH33,15717
.set FL33,14218
.set FH34,15715
.set FL34,14562
.set FH35,15714
.set FL35,47210
.set FH36,15712
.set FL36,14186
.set FH37,15710
.set FL37,14489
.set FH38,15708
.set FL38,14590
.set FH39,15707
.set FL39,47283
.set FH40,15705
.set FL40,47220
.set FH41,15703
.set FL41,47150
.set FH42,15701
.set FL42,47123
.set FH43,15699
.set FL43,47139
.set FH44,15697
.set FL44,47198
.set FH45,15695
.set FL45,47265
.set FH46,15693
.set FL46,47336
.set FH47,15690
.set FL47,14524
.set FH48,15688
.set FL48,14360
.set FH49,15686
.set FL49,47072
.set FH50,15684
.set FL50,47312
.set FH51,15681
.set FL51,14468
.set FH52,15679
.set FL52,47085
.set FH53,15676
.set FL53,14578
.set FH54,15674
.set FL54,14029
.set FH55,15672
.set FL55,47339
.set FH56,15669
.set FL56,13982
.set FH57,15666
.set FL57,14573
.set FH58,15664
.set FL58,47108
.set FH59,15661
.set FL59,14459
.set FH60,15659
.set FL60,47317
.set FH61,15656
.set FL61,47071
.set FH62,15653
.set FL62,14376
.set FH63,15650
.set FL63,14543
.set FH64,15648
.set FL64,47302
.set FH65,15645
.set FL65,47190
.set FH66,15642
.set FL66,46977
.set FH67,15639
.set FL67,14171
.set FH68,15636
.set FL68,14351
.set FH69,15633
.set FL69,14410
.set FH70,15630
.set FL70,14439
.set FH71,15627
.set FL71,14440
.set FH72,15624
.set FL72,14413
.set FH73,15621
.set FL73,14358
.set FH74,15618
.set FL74,14218
.set FH75,15614
.set FL75,46875
.set FH76,15608
.set FL76,47148
.set FH77,15601
.set FL77,14390
.set FH78,15595
.set FL78,46120
.set FH79,15589
.set FL79,47183
.set FH80,15582
.set FL80,14232
.set FH81,15576
.set FL81,47152
.set FH82,15569
.set FL82,14205
.set FH83,15563
.set FL83,47207
.set FH84,15556
.set FL84,46855
.set FH85,15549
.set FL85,14352
.set FH86,15543
.set FL86,47186
.set FH87,15536
.set FL87,46987
.set FH88,15529
.set FL88,14163
.set FH89,15522
.set FL89,14366
.set FH90,15515
.set FL90,14455
.set FH91,15509
.set FL91,47168
.set FH92,15502
.set FL92,47109
.set FH93,15495
.set FL93,47026
.set FH94,15488
.set FL94,46954
.set FH95,15474
.set FL95,46884
.set FH96,15460
.set FL96,46862
.set FH97,15446
.set FL97,46886
.set FH98,15432
.set FL98,46953
.set FH99,15418
.set FL99,47018
.set FH100,15404
.set FL100,47090
.set FH101,15389
.set FL101,14260
.set FH102,15375
.set FL102,14101
.set FH103,15361
.set FL103,46774
.set FH104,15333
.set FL104,14107
.set FH105,15305
.set FL105,46854
.set FH106,15276
.set FL106,13963
.set FH107,15247
.set FL107,14207
.set FH108,15206
.set FL108,46764
.set FH109,15148
.set FL109,13971
.set FH110,15078
.set FL110,46587
.set FH111,14950
.set FL111,46436
.set FH112,0
.set FL112,0
.set FH113,47718
.set FL113,13668
.set FH114,47846
.set FL114,13819
.set FH115,47916
.set FL115,46739
.set FH116,47974
.set FL116,13996
.set FH117,48015
.set FL117,46975
.set FH118,48044
.set FL118,46731
.set FH119,48073
.set FL119,14086
.set FH120,48101
.set FL120,46875
.set FH121,48129
.set FL121,14006
.set FH122,48143
.set FL122,46869
.set FH123,48157
.set FL123,47028
.set FH124,48172
.set FL124,14322
.set FH125,48186
.set FL125,14250
.set FH126,48200
.set FL126,14185
.set FH127,48214
.set FL127,14118
.set FH128,48228
.set FL128,14094
.set FH129,48242
.set FL129,14116
.set FH130,48256
.set FL130,14186
.set FH131,48263
.set FL131,14258
.set FH132,48270
.set FL132,14341
.set FH133,48277
.set FL133,14400
.set FH134,48283
.set FL134,47223
.set FH135,48290
.set FL135,47134
.set FH136,48297
.set FL136,46931
.set FH137,48304
.set FL137,14219
.set FH138,48311
.set FL138,14418
.set FH139,48317
.set FL139,47120
.set FH140,48324
.set FL140,14087
.set FH141,48331
.set FL141,14439
.set FH142,48337
.set FL142,46973
.set FH143,48344
.set FL143,14384
.set FH144,48350
.set FL144,47000
.set FH145,48357
.set FL145,14415
.set FH146,48363
.set FL146,13352
.set FH147,48369
.set FL147,47158
.set FH148,48376
.set FL148,14380
.set FH149,48382
.set FL149,14107
.set FH150,48386
.set FL150,46986
.set FH151,48389
.set FL151,47126
.set FH152,48392
.set FL152,47181
.set FH153,48395
.set FL153,47208
.set FH154,48398
.set FL154,47207
.set FH155,48401
.set FL155,47178
.set FH156,48404
.set FL156,47119
.set FH157,48407
.set FL157,46939
.set FH158,48410
.set FL158,14209
.set FH159,48413
.set FL159,14422
.set FH160,48416
.set FL160,14534
.set FH161,48418
.set FL161,47311
.set FH162,48421
.set FL162,47144
.set FH163,48424
.set FL163,14303
.set FH164,48427
.set FL164,14549
.set FH165,48429
.set FL165,47227
.set FH166,48432
.set FL166,14340
.set FH167,48434
.set FL167,47341
.set FH168,48437
.set FL168,46750
.set FH169,48440
.set FL169,14571
.set FH170,48442
.set FL170,46797
.set FH171,48444
.set FL171,47346
.set FH172,48447
.set FL172,14317
.set FH173,48449
.set FL173,47236
.set FH174,48452
.set FL174,14544
.set FH175,48454
.set FL175,14304
.set FH176,48456
.set FL176,47128
.set FH177,48458
.set FL177,47292
.set FH178,48461
.set FL178,14568
.set FH179,48463
.set FL179,14497
.set FH180,48465
.set FL180,14430
.set FH181,48467
.set FL181,14371
.set FH182,48469
.set FL182,14355
.set FH183,48471
.set FL183,14382
.set FH184,48473
.set FL184,14452
.set FH185,48475
.set FL185,14515
.set FH186,48476
.set FL186,47358
.set FH187,48478
.set FL187,47257
.set FH188,48480
.set FL188,46954
.set FH189,48482
.set FL189,14442
.set FH190,48483
.set FL190,47330
.set FH191,48485
.set FL191,46986
.set FH192,48487
.set FL192,14516
.set FH193,48488
.set FL193,47164
.set FH194,48490
.set FL194,14504
.set FH195,48491
.set FL195,47086
.set FH196,48493
.set FL196,14585
.set FH197,48494
.set FL197,14347
.set FH198,48495
.set FL198,47148
.set FH199,48496
.set FL199,47321
.set FH200,48498
.set FL200,14523
.set FH201,48499
.set FL201,14417
.set FH202,48500
.set FL202,14263
.set FH203,48501
.set FL203,14015
.set FH204,48502
.set FL204,13738
.set FH205,48503
.set FL205,14097
.set FH206,48504
.set FL206,14314
.set FH207,48505
.set FL207,14456
.set FH208,48506
.set FL208,14550
.set FH209,48506
.set FL209,47286
.set FH210,48507
.set FL210,47014
.set FH211,48508
.set FL211,14457
.set FH212,48508
.set FL212,47300
.set FH213,48509
.set FL213,14118
.set FH214,48509
.set FL214,47353
.set FH215,48510
.set FL215,14102
.set FH216,48510
.set FL216,47304
.set FH217,48511
.set FL217,14446
.set FH218,48511
.set FL218,47041
.set FH219,48511
.set FL219,47294
.set FH220,48512
.set FL220,14542
.set FH221,48512
.set FL221,14440
.set FH222,48512
.set FL222,14286
.set FH223,48512
.set FL223,14030
.set FH224,48512
.set FL224,0
.set FH225,48512
.set FL225,14030
.set FH226,48512
.set FL226,14286
.set FH227,48512
.set FL227,14440
.set FH228,48512
.set FL228,14542
.set FH229,48511
.set FL229,47294
.set FH230,48511
.set FL230,47041
.set FH231,48511
.set FL231,14446
.set FH232,48510
.set FL232,47304
.set FH233,48510
.set FL233,14102
.set FH234,48509
.set FL234,47353
.set FH235,48509
.set FL235,14118
.set FH236,48508
.set FL236,47300
.set FH237,48508
.set FL237,14457
.set FH238,48507
.set FL238,47014
.set FH239,48506
.set FL239,47286
.set FH240,48506
.set FL240,14550
.set FH241,48505
.set FL241,14456
.set FH242,48504
.set FL242,14314
.set FH243,48503
.set FL243,14097
.set FH244,48502
.set FL244,13738
.set FH245,48501
.set FL245,14015
.set FH246,48500
.set FL246,14263
.set FH247,48499
.set FL247,14417
.set FH248,48498
.set FL248,14523
.set FH249,48496
.set FL249,47321
.set FH250,48495
.set FL250,47148
.set FH251,48494
.set FL251,14347
.set FH252,48493
.set FL252,14585
.set FH253,48491
.set FL253,47086
.set FH254,48490
.set FL254,14504
.set FH255,48488
.set FL255,47164
.set FH256,48487
.set FL256,14516
.set FH257,48485
.set FL257,46986
.set FH258,48483
.set FL258,47330
.set FH259,48482
.set FL259,14442
.set FH260,48480
.set FL260,46954
.set FH261,48478
.set FL261,47257
.set FH262,48476
.set FL262,47358
.set FH263,48475
.set FL263,14515
.set FH264,48473
.set FL264,14452
.set FH265,48471
.set FL265,14382
.set FH266,48469
.set FL266,14355
.set FH267,48467
.set FL267,14371
.set FH268,48465
.set FL268,14430
.set FH269,48463
.set FL269,14497
.set FH270,48461
.set FL270,14568
.set FH271,48458
.set FL271,47292
.set FH272,48456
.set FL272,47128
.set FH273,48454
.set FL273,14304
.set FH274,48452
.set FL274,14544
.set FH275,48449
.set FL275,47236
.set FH276,48447
.set FL276,14317
.set FH277,48444
.set FL277,47346
.set FH278,48442
.set FL278,46797
.set FH279,48440
.set FL279,14571
.set FH280,48437
.set FL280,46750
.set FH281,48434
.set FL281,47341
.set FH282,48432
.set FL282,14340
.set FH283,48429
.set FL283,47227
.set FH284,48427
.set FL284,14549
.set FH285,48424
.set FL285,14303
.set FH286,48421
.set FL286,47144
.set FH287,48418
.set FL287,47311
.set FH288,48416
.set FL288,14534
.set FH289,48413
.set FL289,14422
.set FH290,48410
.set FL290,14209
.set FH291,48407
.set FL291,46939
.set FH292,48404
.set FL292,47119
.set FH293,48401
.set FL293,47178
.set FH294,48398
.set FL294,47207
.set FH295,48395
.set FL295,47208
.set FH296,48392
.set FL296,47181
.set FH297,48389
.set FL297,47126
.set FH298,48386
.set FL298,46986
.set FH299,48382
.set FL299,14107
.set FH300,48376
.set FL300,14380
.set FH301,48369
.set FL301,47158
.set FH302,48363
.set FL302,13352
.set FH303,48357
.set FL303,14415
.set FH304,48350
.set FL304,47000
.set FH305,48344
.set FL305,14384
.set FH306,48337
.set FL306,46973
.set FH307,48331
.set FL307,14439
.set FH308,48324
.set FL308,14087
.set FH309,48317
.set FL309,47120
.set FH310,48311
.set FL310,14418
.set FH311,48304
.set FL311,14219
.set FH312,48297
.set FL312,46931
.set FH313,48290
.set FL313,47134
.set FH314,48283
.set FL314,47223
.set FH315,48277
.set FL315,14400
.set FH316,48270
.set FL316,14341
.set FH317,48263
.set FL317,14258
.set FH318,48256
.set FL318,14186
.set FH319,48242
.set FL319,14116
.set FH320,48228
.set FL320,14094
.set FH321,48214
.set FL321,14118
.set FH322,48200
.set FL322,14185
.set FH323,48186
.set FL323,14250
.set FH324,48172
.set FL324,14322
.set FH325,48157
.set FL325,47028
.set FH326,48143
.set FL326,46869
.set FH327,48129
.set FL327,14006
.set FH328,48101
.set FL328,46875
.set FH329,48073
.set FL329,14086
.set FH330,48044
.set FL330,46731
.set FH331,48015
.set FL331,46975
.set FH332,47974
.set FL332,13996
.set FH333,47916
.set FL333,46739
.set FH334,47846
.set FL334,13819
.set FH335,47718
.set FL335,13668
.set FH336,0
.set FL336,0
.set FH337,14950
.set FL337,46436
.set FH338,15078
.set FL338,46587
.set FH339,15148
.set FL339,13971
.set FH340,15206
.set FL340,46764
.set FH341,15247
.set FL341,14207
.set FH342,15276
.set FL342,13963
.set FH343,15305
.set FL343,46854
.set FH344,15333
.set FL344,14107
.set FH345,15361
.set FL345,46774
.set FH346,15375
.set FL346,14101
.set FH347,15389
.set FL347,14260
.set FH348,15404
.set FL348,47090
.set FH349,15418
.set FL349,47018
.set FH350,15432
.set FL350,46953
.set FH351,15446
.set FL351,46886
.set FH352,15460
.set FL352,46862
.set FH353,15474
.set FL353,46884
.set FH354,15488
.set FL354,46954
.set FH355,15495
.set FL355,47026
.set FH356,15502
.set FL356,47109
.set FH357,15509
.set FL357,47168
.set FH358,15515
.set FL358,14455
.set FH359,15522
.set FL359,14366
.set FH360,15529
.set FL360,14163
.set FH361,15536
.set FL361,46987
.set FH362,15543
.set FL362,47186
.set FH363,15549
.set FL363,14352
.set FH364,15556
.set FL364,46855
.set FH365,15563
.set FL365,47207
.set FH366,15569
.set FL366,14205
.set FH367,15576
.set FL367,47152
.set FH368,15582
.set FL368,14232
.set FH369,15589
.set FL369,47183
.set FH370,15595
.set FL370,46120
.set FH371,15601
.set FL371,14390
.set FH372,15608
.set FL372,47148
.set FH373,15614
.set FL373,46875
.set FH374,15618
.set FL374,14218
.set FH375,15621
.set FL375,14358
.set FH376,15624
.set FL376,14413
.set FH377,15627
.set FL377,14440
.set FH378,15630
.set FL378,14439
.set FH379,15633
.set FL379,14410
.set FH380,15636
.set FL380,14351
.set FH381,15639
.set FL381,14171
.set FH382,15642
.set FL382,46977
.set FH383,15645
.set FL383,47190
.set FH384,15648
.set FL384,47302
.set FH385,15650
.set FL385,14543
.set FH386,15653
.set FL386,14376
.set FH387,15656
.set FL387,47071
.set FH388,15659
.set FL388,47317
.set FH389,15661
.set FL389,14459
.set FH390,15664
.set FL390,47108
.set FH391,15666
.set FL391,14573
.set FH392,15669
.set FL392,13982
.set FH393,15672
.set FL393,47339
.set FH394,15674
.set FL394,14029
.set FH395,15676
.set FL395,14578
.set FH396,15679
.set FL396,47085
.set FH397,15681
.set FL397,14468
.set FH398,15684
.set FL398,47312
.set FH399,15686
.set FL399,47072
.set FH400,15688
.set FL400,14360
.set FH401,15690
.set FL401,14524
.set FH402,15693
.set FL402,47336
.set FH403,15695
.set FL403,47265
.set FH404,15697
.set FL404,47198
.set FH405,15699
.set FL405,47139
.set FH406,15701
.set FL406,47123
.set FH407,15703
.set FL407,47150
.set FH408,15705
.set FL408,47220
.set FH409,15707
.set FL409,47283
.set FH410,15708
.set FL410,14590
.set FH411,15710
.set FL411,14489
.set FH412,15712
.set FL412,14186
.set FH413,15714
.set FL413,47210
.set FH414,15715
.set FL414,14562
.set FH415,15717
.set FL415,14218
.set FH416,15719
.set FL416,47284
.set FH417,15720
.set FL417,14396
.set FH418,15722
.set FL418,47272
.set FH419,15723
.set FL419,14318
.set FH420,15725
.set FL420,47353
.set FH421,15726
.set FL421,47115
.set FH422,15727
.set FL422,14380
.set FH423,15728
.set FL423,14553
.set FH424,15730
.set FL424,47291
.set FH425,15731
.set FL425,47185
.set FH426,15732
.set FL426,47031
.set FH427,15733
.set FL427,46783
.set FH428,15734
.set FL428,46506
.set FH429,15735
.set FL429,46865
.set FH430,15736
.set FL430,47082
.set FH431,15737
.set FL431,47224
.set FH432,15738
.set FL432,47318
.set FH433,15738
.set FL433,14518
.set FH434,15739
.set FL434,14246
.set FH435,15740
.set FL435,47225
.set FH436,15740
.set FL436,14532
.set FH437,15741
.set FL437,46886
.set FH438,15741
.set FL438,14585
.set FH439,15742
.set FL439,46870
.set FH440,15742
.set FL440,14536
.set FH441,15743
.set FL441,47214
.set FH442,15743
.set FL442,14273
.set FH443,15743
.set FL443,14526
.set FH444,15744
.set FL444,47310
.set FH445,15744
.set FL445,47208
.set FH446,15744
.set FL446,47054
.set FH447,15744
.set FL447,46798
.altmacro
.macro EMH q0_,q1_,q2_,q3_,q4_,q5_,q6_,q7_
.long FH\q0_|(FH\q1_<<16),FH\q2_|(FH\q3_<<16),FH\q4_|(FH\q5_<<16),FH\q6_|(FH\q7_<<16)
.endm
.macro EML q0_,q1_,q2_,q3_,q4_,q5_,q6_,q7_
.long FL\q0_|(FL\q1_<<16),FL\q2_|(FL\q3_<<16),FL\q4_|(FL\q5_<<16),FL\q6_|(FL\q7_<<16)
.endm
.p2align 8
TAB_FT:
.set ff, 0
.rept 392
.set pp, 0
.rept 2
.set ll, 0
.rept 64
.set kc, (ff/56)*64+((ff>>1)&1)*32+(ll&31)
.set d0, ((((ff%56)>>2)*2)+(ff&1))*16+(ll>>5)*8
.set kk, (kc>>1)+224*(kc==1)*(-1)
.set bb, d0*kk+(kc&1)*112*(1+(kc==1))
.if pp==0
EMH %(bb%448),%((bb+kk)%448),%((bb+2*kk)%448),%((bb+3*kk)%448),%((bb+4*kk)%448),%((bb+5*kk)%448),%((bb+6*kk)%448),%((bb+7*kk)%448)
.else
EML %(bb%448),%((bb+kk)%448),%((bb+2*kk)%448),%((bb+3*kk)%448),%((bb+4*kk)%448),%((bb+5*kk)%448),%((bb+6*kk)%448),%((bb+7*kk)%448)
.endif
.set ll, ll+1
.endr
.set pp, pp+1
.endr
.set ff, ff+1
.endr
.noaltmacro
.section .rodata,"a"
.p2align 8
TAB_FFT:
.quad 0x3000300030003000,0x3000300030003000,0x2fa82fd92ff63000,0x2b8b2c722d132da8,0x2ea72f642fd93000,0xac72aa1fa63e0000,0x2d132ea72fa83000,0xaff6afd9af0eada8
.quad 0x2a1f2da82f643000,0xaa1fada8af64b000,0x22462c722f0e3000,0x2d13263ea8a5ada8,0xa63e2a1f2ea73000,0x2fd92f642c728000,0xab8b263e2e2f3000,0x28a52ea72ff62da8
.quad 0xada800002da83000,0xada800002da83000,0xaf0ea63e2d133000,0xafa8aea7a2462da8,0xafd9aa1f2c723000,0xa63eaf64aea70000,0xaff6ac722b8b3000,0x2e2fa63eafa8ada8
.quad 0xaf64ada82a1f3000,0x2f642da8aa1fb000,0xae2faea728a53000,0x22462fd92b8bada8,0xac72af64263e3000,0xaea72a1f2fd98000,0xa8a5afd922463000,0xaf0eac722e2f2da8
.quad 0x8000b00000003000,0x8000b00000003000,0x28a5afd9a2463000,0x2f0eac72ae2f2da8,0x2c72af64a63e3000,0x2ea72a1fafd90000,0x2e2faea7a8a53000,0xa2462fd9ab8bada8
.quad 0x2f64ada8aa1f3000,0xaf642da82a1fb000,0x2ff6ac72ab8b3000,0xae2fa63e2fa8ada8,0x2fd9aa1fac723000,0x263eaf642ea78000,0x2f0ea63ead133000,0x2fa8aea722462da8
.quad 0x2da88000ada83000,0x2da88000ada83000,0x2b8b263eae2f3000,0xa8a52ea7aff62da8,0x263e2a1faea73000,0xafd92f64ac720000,0xa2462c72af0e3000,0xad13263e28a5ada8
.quad 0xaa1f2da8af643000,0x2a1fada82f64b000,0xad132ea7afa83000,0x2ff6afd92f0eada8,0xaea72f64afd93000,0x2c72aa1f263e8000,0xafa82fd9aff63000,0xab8b2c72ad132da8
.quad 0x3000300030003000,0x3000300030003000,0x2e2f2ea72f0e2f64,0x2246263e28a52a1f,0x263e2a1f2c722da8,0xafd9af64aea7ada8,0xab8ba63e22462a1f,0xa8a5ac72ae2faf64
.quad 0xaf64ada8aa1f0000,0x2f642da82a1f8000,0xafa8afd9ae2faa1f,0x2b8b2ea72ff62f64,0xac72af64afd9ada8,0xaea7aa1f263e2da8,0x2246ac72afa8af64,0xad13afd9af0eaa1f
.quad 0x2da88000ada8b000,0x2da88000ada8b000,0x2ff62c72a8a5af64,0x2e2f2fd92b8baa1f,0x2ea72f64263eada8,0xac722a1f2fd92da8,0x28a52fd92d13aa1f,0xaf0eaea722462f64
.quad 0xaa1f2da82f648000,0x2a1fada8af640000,0xaf0e263e2ff62a1f,0x2fa82c72ad13af64,0xafd9aa1f2ea72da8,0xa63e2f642c72ada8,0xad13aea72b8b2f64,0xaff6a63e2fa82a1f
.quad 0x8000b00000003000,0x8000b00000003000,0x2d13aea7ab8b2f64,0x2ff6a63eafa82a1f,0x2fd9aa1faea72da8,0x263e2f64ac72ada8,0x2f0e263eaff62a1f,0xafa82c722d13af64
.quad 0x2a1f2da8af640000,0xaa1fada82f648000,0xa8a52fd9ad13aa1f,0x2f0eaea7a2462f64,0xaea72f64a63eada8,0x2c722a1fafd92da8,0xaff62c7228a5af64,0xae2f2fd9ab8baa1f
.quad 0xada800002da8b000,0xada800002da8b000,0xa246ac722fa8af64,0x2d13afd92f0eaa1f,0x2c72af642fd9ada8,0x2ea7aa1fa63e2da8,0x2fa8afd92e2faa1f,0xab8b2ea7aff62f64
.quad 0x2f64ada82a1f8000,0xaf642da8aa1f0000,0x2b8ba63ea2462a1f,0x28a5ac722e2faf64,0xa63e2a1fac722da8,0x2fd9af642ea7ada8,0xae2f2ea7af0e2f64,0xa246263ea8a52a1f
.quad 0x3000300030003000,0x3000300030003000,0xa8a5a63ea2460000,0xaf0eaea7ae2fada8,0xaea7af64afd9b000,0x2c722a1f263e8000,0x2e2f2c7228a58000,0xa246263e2b8b2da8
.quad 0x2a1f2da82f643000,0xaa1fada8af64b000,0xaff6aea7ab8b0000,0x2e2f2fd92fa82da8,0x263eaa1faea7b000,0xafd9af64ac720000,0x2f0e2fd92d138000,0x2fa82c72a246ada8
.quad 0xada800002da83000,0xada800002da83000,0xab8bafd9ae2f0000,0x28a5ac72aff6ada8,0x2fd92a1fac72b000,0x263e2f642ea78000,0xa2462ea72f0e8000,0xad13afd9a8a52da8
.quad 0xaf64ada82a1f3000,0x2f642da8aa1fb000,0x2d13ac72afa80000,0xaff6a63e2f0e2da8,0x2c722f64a63eb000,0x2ea7aa1fafd90000,0xafa8263e2ff68000,0xab8b2ea72d13ada8
.quad 0x8000b00000003000,0x8000b00000003000,0x2fa8263eaff60000,0x2b8b2ea7ad13ada8,0xac722f64263eb000,0xaea7aa1f2fd98000,0xad13ac722fa88000,0x2ff6a63eaf0e2da8
.quad 0x2f64ada8aa1f3000,0xaf642da82a1fb000,0x22462ea7af0e0000,0x2d13afd928a52da8,0xafd92a1f2c72b000,0xa63e2f64aea70000,0x2b8bafd92e2f8000,0xa8a5ac722ff6ada8
.quad 0x2da88000ada83000,0x2da88000ada83000,0xaf0e2fd9ad130000,0xafa82c722246ada8,0xa63eaa1f2ea7b000,0x2fd9af642c728000,0x2ff6aea72b8b8000,0xae2f2fd9afa82da8
.quad 0xaa1f2da8af643000,0x2a1fada82f64b000,0xae2f2c72a8a50000,0x2246263eab8b2da8,0x2ea7af642fd9b000,0xac722a1fa63e0000,0x28a5a63e22468000,0x2f0eaea72e2fada8
.quad 0x3000300030003000,0x3000300030003000,0xad13ac72ab8baa1f,0xaff6afd9afa8af64,0xa63eaa1fac72ada8,0x2fd92f642ea72da8,0x2f0e2fd92ff62f64,0xafa8aea7ad13aa1f
.quad 0xaf64ada8aa1f0000,0x2f642da82a1f8000,0x28a5a63ead13af64,0xaf0eac72a2462a1f,0x2c722f642fd92da8,0x2ea72a1fa63eada8,0xaff6aea7a8a52a1f,0xae2fa63e2b8b2f64
.quad 0x2da88000ada8b000,0x2da88000ada8b000,0x22462ea72fa82a1f,0xad13263e2f0e2f64,0xaea7af64a63e2da8,0x2c72aa1fafd9ada8,0x2fa8263eae2faf64,0xab8b2c722ff62a1f
.quad 0xaa1f2da82f648000,0x2a1fada8af640000,0xab8bafd9a2462f64,0xa8a52ea72e2faa1f,0x2fd92a1faea7ada8,0x263eaf64ac722da8,0xae2f2c722f0eaa1f,0xa2462fd928a5af64
.quad 0x8000b00000003000,0x8000b00000003000,0x2e2f2c72af0eaa1f,0x22462fd9a8a5af64,0xafd92a1f2ea7ada8,0xa63eaf642c722da8,0x2b8bafd922462f64,0x28a52ea7ae2faa1f
.quad 0x2a1f2da8af640000,0xaa1fada82f648000,0xafa8263e2e2faf64,0x2b8b2c72aff62a1f,0x2ea7af64263e2da8,0xac72aa1f2fd9ada8,0xa2462ea7afa82a1f,0x2d13263eaf0e2f64
.quad 0xada800002da8b000,0xada800002da8b000,0x2ff6aea728a52a1f,0x2e2fa63eab8b2f64,0xac722f64afd92da8,0xaea72a1f263eada8,0xa8a5a63e2d13af64,0x2f0eac7222462a1f
.quad 0x2f64ada82a1f8000,0xaf642da8aa1f0000,0xaf0e2fd9aff62f64,0x2fa8aea72d13aa1f,0x263eaa1f2c72ada8,0xafd92f64aea72da8,0x2d13ac722b8baa1f,0x2ff6afd92fa8af64
.quad 0x3000300030003000,0x3000300030003000,0xafa8afd9aff6b000,0xab8bac72ad13ada8,0x2ea72f642fd93000,0xac72aa1fa63e0000,0xad13aea7afa8b000,0x2ff62fd92f0e2da8
.quad 0x2a1f2da82f643000,0xaa1fada8af64b000,0xa246ac72af0eb000,0xad13a63e28a52da8,0xa63e2a1f2ea73000,0x2fd92f642c728000,0x2b8ba63eae2fb000,0xa8a5aea7aff6ada8
.quad 0xada800002da83000,0xada800002da83000,0x2f0e263ead13b000,0x2fa82ea72246ada8,0xafd9aa1f2c723000,0xa63eaf64aea70000,0x2ff62c72ab8bb000,0xae2f263e2fa82da8
.quad 0xaf64ada82a1f3000,0x2f642da8aa1fb000,0x2e2f2ea7a8a5b000,0xa246afd9ab8b2da8,0xac72af64263e3000,0xaea72a1f2fd98000,0x28a52fd9a246b000,0x2f0e2c72ae2fada8
.quad 0x8000b00000003000,0x8000b00000003000,0xa8a52fd92246b000,0xaf0e2c722e2fada8,0x2c72af64a63e3000,0x2ea72a1fafd90000,0xae2f2ea728a5b000,0x2246afd92b8b2da8
.quad 0x2f64ada8aa1f3000,0xaf642da82a1fb000,0xaff62c722b8bb000,0x2e2f263eafa82da8,0x2fd9aa1fac723000,0x263eaf642ea78000,0xaf0e263e2d13b000,0xafa82ea7a246ada8
.quad 0x2da88000ada83000,0x2da88000ada83000,0xab8ba63e2e2fb000,0x28a5aea72ff6ada8,0x263e2a1faea73000,0xafd92f64ac720000,0x2246ac722f0eb000,0x2d13a63ea8a52da8
.quad 0xaa1f2da8af643000,0x2a1fada82f64b000,0x2d13aea72fa8b000,0xaff62fd9af0e2da8,0xaea72f64afd93000,0x2c72aa1f263e8000,0x2fa8afd92ff6b000,0x2b8bac722d13ada8
.quad 0x3000300030003000,0x3000300030003000,0xae2faea7af0eaf64,0xa246a63ea8a5aa1f,0x263e2a1f2c722da8,0xafd9af64aea7ada8,0x2b8b263ea246aa1f,0x28a52c722e2f2f64
.quad 0xaf64ada8aa1f0000,0x2f642da82a1f8000,0x2fa82fd92e2f2a1f,0xab8baea7aff6af64,0xac72af64afd9ada8,0xaea7aa1f263e2da8,0xa2462c722fa82f64,0x2d132fd92f0e2a1f
.quad 0x2da88000ada8b000,0x2da88000ada8b000,0xaff6ac7228a52f64,0xae2fafd9ab8b2a1f,0x2ea72f64263eada8,0xac722a1f2fd92da8,0xa8a5afd9ad132a1f,0x2f0e2ea7a246af64
.quad 0xaa1f2da82f648000,0x2a1fada8af640000,0x2f0ea63eaff6aa1f,0xafa8ac722d132f64,0xafd9aa1f2ea72da8,0xa63e2f642c72ada8,0x2d132ea7ab8baf64,0x2ff6263eafa8aa1f
.quad 0x8000b00000003000,0x8000b00000003000,0xad132ea72b8baf64,0xaff6263e2fa8aa1f,0x2fd9aa1faea72da8,0x263e2f64ac72ada8,0xaf0ea63e2ff6aa1f,0x2fa8ac72ad132f64
.quad 0x2a1f2da8af640000,0xaa1fada82f648000,0x28a5afd92d132a1f,0xaf0e2ea72246af64,0xaea72f64a63eada8,0x2c722a1fafd92da8,0x2ff6ac72a8a52f64,0x2e2fafd92b8b2a1f
.quad 0xada800002da8b000,0xada800002da8b000,0x22462c72afa82f64,0xad132fd9af0e2a1f,0x2c72af642fd9ada8,0x2ea7aa1fa63e2da8,0xafa82fd9ae2f2a1f,0x2b8baea72ff6af64
.quad 0x2f64ada82a1f8000,0xaf642da8aa1f0000,0xab8b263e2246aa1f,0xa8a52c72ae2f2f64,0xa63e2a1fac722da8,0x2fd9af642ea7ada8,0x2e2faea72f0eaf64,0x2246a63e28a5aa1f
.quad 0x3000300030003000,0x3000300030003000,0x28a5263e22468000,0x2f0e2ea72e2f2da8,0xaea7af64afd9b000,0x2c722a1f263e8000,0xae2fac72a8a50000,0x2246a63eab8bada8
.quad 0x2a1f2da82f643000,0xaa1fada8af64b000,0x2ff62ea72b8b8000,0xae2fafd9afa8ada8,0x263eaa1faea7b000,0xafd9af64ac720000,0xaf0eafd9ad130000,0xafa8ac7222462da8
.quad 0xada800002da83000,0xada800002da83000,0x2b8b2fd92e2f8000,0xa8a52c722ff62da8,0x2fd92a1fac72b000,0x263e2f642ea78000,0x2246aea7af0e0000,0x2d132fd928a5ada8
.quad 0xaf64ada82a1f3000,0x2f642da8aa1fb000,0xad132c722fa88000,0x2ff6263eaf0eada8,0x2c722f64a63eb000,0x2ea7aa1fafd90000,0x2fa8a63eaff60000,0x2b8baea7ad132da8
.quad 0x8000b00000003000,0x8000b00000003000,0xafa8a63e2ff68000,0xab8baea72d132da8,0xac722f64263eb000,0xaea7aa1f2fd98000,0x2d132c72afa80000,0xaff6263e2f0eada8
.quad 0x2f64ada8aa1f3000,0xaf642da82a1fb000,0xa246aea72f0e8000,0xad132fd9a8a5ada8,0xafd92a1f2c72b000,0xa63e2f64aea70000,0xab8b2fd9ae2f0000,0x28a52c72aff62da8
.quad 0x2da88000ada83000,0x2da88000ada83000,0x2f0eafd92d138000,0x2fa8ac72a2462da8,0xa63eaa1f2ea7b000,0x2fd9af642c728000,0xaff62ea7ab8b0000,0x2e2fafd92fa8ada8
.quad 0xaa1f2da8af643000,0x2a1fada82f64b000,0x2e2fac7228a58000,0xa246a63e2b8bada8,0x2ea7af642fd9b000,0xac722a1fa63e0000,0xa8a5263ea2460000,0xaf0e2ea7ae2f2da8
.quad 0x3000300030003000,0x3000300030003000,0x2d132c722b8b2a1f,0x2ff62fd92fa82f64,0xa63eaa1fac72ada8,0x2fd92f642ea72da8,0xaf0eafd9aff6af64,0x2fa82ea72d132a1f
.quad 0xaf64ada8aa1f0000,0x2f642da82a1f8000,0xa8a5263e2d132f64,0x2f0e2c722246aa1f,0x2c722f642fd92da8,0x2ea72a1fa63eada8,0x2ff62ea728a5aa1f,0x2e2f263eab8baf64
.quad 0x2da88000ada8b000,0x2da88000ada8b000,0xa246aea7afa8aa1f,0x2d13a63eaf0eaf64,0xaea7af64a63e2da8,0x2c72aa1fafd9ada8,0xafa8a63e2e2f2f64,0x2b8bac72aff6aa1f
.quad 0xaa1f2da82f648000,0x2a1fada8af640000,0x2b8b2fd92246af64,0x28a5aea7ae2f2a1f,0x2fd92a1faea7ada8,0x263eaf64ac722da8,0x2e2fac72af0e2a1f,0x2246afd9a8a52f64
.quad 0x8000b00000003000,0x8000b00000003000,0xae2fac722f0e2a1f,0xa246afd928a52f64,0xafd92a1f2ea7ada8,0xa63eaf642c722da8,0xab8b2fd9a246af64,0xa8a5aea72e2f2a1f
.quad 0x2a1f2da8af640000,0xaa1fada82f648000,0x2fa8a63eae2f2f64,0xab8bac722ff6aa1f,0x2ea7af64263e2da8,0xac72aa1f2fd9ada8,0x2246aea72fa8aa1f,0xad13a63e2f0eaf64
.quad 0xada800002da8b000,0xada800002da8b000,0xaff62ea7a8a5aa1f,0xae2f263e2b8baf64,0xac722f64afd92da8,0xaea72a1f263eada8,0x28a5263ead132f64,0xaf0e2c72a246aa1f
.quad 0x2f64ada82a1f8000,0xaf642da8aa1f0000,0x2f0eafd92ff6af64,0xafa82ea7ad132a1f,0x263eaa1f2c72ada8,0xafd92f64aea72da8,0xad132c72ab8b2a1f,0xaff62fd9afa82f64
.quad 0xb0003000b0003000,0xb0003000b0003000,0xafa82fd9aff63000,0xab8b2c72ad132da8,0xaea72f64afd93000,0x2c72aa1f263e0000,0xad132ea7afa83000,0x2ff6afd92f0eada8
.quad 0xaa1f2da8af643000,0x2a1fada82f64b000,0xa2462c72af0e3000,0xad13263e28a5ada8,0x263e2a1faea73000,0xafd92f64ac728000,0x2b8b263eae2f3000,0xa8a52ea7aff62da8
.quad 0x2da80000ada83000,0x2da80000ada83000,0x2f0ea63ead133000,0x2fa8aea722462da8,0x2fd9aa1fac723000,0x263eaf642ea70000,0x2ff6ac72ab8b3000,0xae2fa63e2fa8ada8
.quad 0x2f64ada8aa1f3000,0xaf642da82a1fb000,0x2e2faea7a8a53000,0xa2462fd9ab8bada8,0x2c72af64a63e3000,0x2ea72a1fafd98000,0x28a5afd9a2463000,0x2f0eac72ae2f2da8
.quad 0xb00080003000,0xb00080003000,0xa8a5afd922463000,0xaf0eac722e2f2da8,0xac72af64263e3000,0xaea72a1f2fd90000,0xae2faea728a53000,0x22462fd92b8bada8
.quad 0xaf64ada82a1f3000,0x2f642da8aa1fb000,0xaff6ac722b8b3000,0x2e2fa63eafa8ada8,0xafd9aa1f2c723000,0xa63eaf64aea78000,0xaf0ea63e2d133000,0xafa8aea7a2462da8
.quad 0xada880002da83000,0xada880002da83000,0xab8b263e2e2f3000,0x28a52ea72ff62da8,0xa63e2a1f2ea73000,0x2fd92f642c720000,0x22462c722f0e3000,0x2d13263ea8a5ada8
.quad 0x2a1f2da82f643000,0xaa1fada8af64b000,0x2d132ea72fa83000,0xaff6afd9af0eada8,0x2ea72f642fd93000,0xac72aa1fa63e8000,0x2fa82fd92ff63000,0x2b8b2c722d132da8
.quad 0xb0003000b0003000,0xb0003000b0003000,0xae2f2ea7af0e2f64,0xa246263ea8a52a1f,0xa63e2a1fac722da8,0x2fd9af642ea7ada8,0x2b8ba63ea2462a1f,0x28a5ac722e2faf64
.quad 0x2f64ada82a1f0000,0xaf642da8aa1f8000,0x2fa8afd92e2faa1f,0xab8b2ea7aff62f64,0x2c72af642fd9ada8,0x2ea7aa1fa63e2da8,0xa246ac722fa8af64,0x2d13afd92f0eaa1f
.quad 0xada880002da8b000,0xada880002da8b000,0xaff62c7228a5af64,0xae2f2fd9ab8baa1f,0xaea72f64a63eada8,0x2c722a1fafd92da8,0xa8a52fd9ad13aa1f,0x2f0eaea7a2462f64
.quad 0x2a1f2da8af648000,0xaa1fada82f640000,0x2f0e263eaff62a1f,0xafa82c722d13af64,0x2fd9aa1faea72da8,0x263e2f64ac72ada8,0x2d13aea7ab8b2f64,0x2ff6a63eafa82a1f
.quad 0xb00080003000,0xb00080003000,0xad13aea72b8b2f64,0xaff6a63e2fa82a1f,0xafd9aa1f2ea72da8,0xa63e2f642c72ada8,0xaf0e263e2ff62a1f,0x2fa82c72ad13af64
.quad 0xaa1f2da82f640000,0x2a1fada8af648000,0x28a52fd92d13aa1f,0xaf0eaea722462f64,0x2ea72f64263eada8,0xac722a1f2fd92da8,0x2ff62c72a8a5af64,0x2e2f2fd92b8baa1f
.quad 0x2da80000ada8b000,0x2da80000ada8b000,0x2246ac72afa8af64,0xad13afd9af0eaa1f,0xac72af64afd9ada8,0xaea7aa1f263e2da8,0xafa8afd9ae2faa1f,0x2b8b2ea72ff62f64
.quad 0xaf64ada8aa1f8000,0x2f642da82a1f0000,0xab8ba63e22462a1f,0xa8a5ac72ae2faf64,0x263e2a1f2c722da8,0xafd9af64aea7ada8,0x2e2f2ea72f0e2f64,0x2246263e28a52a1f
.quad 0xb0003000b0003000,0xb0003000b0003000,0x28a5a63e22460000,0x2f0eaea72e2fada8,0x2ea7af642fd9b000,0xac722a1fa63e8000,0xae2f2c72a8a58000,0x2246263eab8b2da8
.quad 0xaa1f2da8af643000,0x2a1fada82f64b000,0x2ff6aea72b8b0000,0xae2f2fd9afa82da8,0xa63eaa1f2ea7b000,0x2fd9af642c720000,0xaf0e2fd9ad138000,0xafa82c722246ada8
.quad 0x2da80000ada83000,0x2da80000ada83000,0x2b8bafd92e2f0000,0xa8a5ac722ff6ada8,0xafd92a1f2c72b000,0xa63e2f64aea78000,0x22462ea7af0e8000,0x2d13afd928a52da8
.quad 0x2f64ada8aa1f3000,0xaf642da82a1fb000,0xad13ac722fa80000,0x2ff6a63eaf0e2da8,0xac722f64263eb000,0xaea7aa1f2fd90000,0x2fa8263eaff68000,0x2b8b2ea7ad13ada8
.quad 0xb00080003000,0xb00080003000,0xafa8263e2ff60000,0xab8b2ea72d13ada8,0x2c722f64a63eb000,0x2ea7aa1fafd98000,0x2d13ac72afa88000,0xaff6a63e2f0e2da8
.quad 0xaf64ada82a1f3000,0x2f642da8aa1fb000,0xa2462ea72f0e0000,0xad13afd9a8a52da8,0x2fd92a1fac72b000,0x263e2f642ea70000,0xab8bafd9ae2f8000,0x28a5ac72aff6ada8
.quad 0xada880002da83000,0xada880002da83000,0x2f0e2fd92d130000,0x2fa82c72a246ada8,0x263eaa1faea7b000,0xafd9af64ac728000,0xaff6aea7ab8b8000,0x2e2f2fd92fa82da8
.quad 0x2a1f2da82f643000,0xaa1fada8af64b000,0x2e2f2c7228a50000,0xa246263e2b8b2da8,0xaea7af64afd9b000,0x2c722a1f263e0000,0xa8a5a63ea2468000,0xaf0eaea7ae2fada8
.quad 0xb0003000b0003000,0xb0003000b0003000,0x2d13ac722b8baa1f,0x2ff6afd92fa8af64,0x263eaa1f2c72ada8,0xafd92f64aea72da8,0xaf0e2fd9aff62f64,0x2fa8aea72d13aa1f
.quad 0x2f64ada82a1f0000,0xaf642da8aa1f8000,0xa8a5a63e2d13af64,0x2f0eac7222462a1f,0xac722f64afd92da8,0xaea72a1f263eada8,0x2ff6aea728a52a1f,0x2e2fa63eab8b2f64
.quad 0xada880002da8b000,0xada880002da8b000,0xa2462ea7afa82a1f,0x2d13263eaf0e2f64,0x2ea7af64263e2da8,0xac72aa1f2fd9ada8,0xafa8263e2e2faf64,0x2b8b2c72aff62a1f
.quad 0x2a1f2da8af648000,0xaa1fada82f640000,0x2b8bafd922462f64,0x28a52ea7ae2faa1f,0xafd92a1f2ea7ada8,0xa63eaf642c722da8,0x2e2f2c72af0eaa1f,0x22462fd9a8a5af64
.quad 0xb00080003000,0xb00080003000,0xae2f2c722f0eaa1f,0xa2462fd928a5af64,0x2fd92a1faea7ada8,0x263eaf64ac722da8,0xab8bafd9a2462f64,0xa8a52ea72e2faa1f
.quad 0xaa1f2da82f640000,0x2a1fada8af648000,0x2fa8263eae2faf64,0xab8b2c722ff62a1f,0xaea7af64a63e2da8,0x2c72aa1fafd9ada8,0x22462ea72fa82a1f,0xad13263e2f0e2f64
.quad 0x2da80000ada8b000,0x2da80000ada8b000,0xaff6aea7a8a52a1f,0xae2fa63e2b8b2f64,0x2c722f642fd92da8,0x2ea72a1fa63eada8,0x28a5a63ead13af64,0xaf0eac72a2462a1f
.quad 0xaf64ada8aa1f8000,0x2f642da82a1f0000,0x2f0e2fd92ff62f64,0xafa8aea7ad13aa1f,0xa63eaa1fac72ada8,0x2fd92f642ea72da8,0xad13ac72ab8baa1f,0xaff6afd9afa8af64
.quad 0xb0003000b0003000,0xb0003000b0003000,0x2fa8afd92ff6b000,0x2b8bac722d13ada8,0xaea72f64afd93000,0x2c72aa1f263e0000,0x2d13aea72fa8b000,0xaff62fd9af0e2da8
.quad 0xaa1f2da8af643000,0x2a1fada82f64b000,0x2246ac722f0eb000,0x2d13a63ea8a52da8,0x263e2a1faea73000,0xafd92f64ac728000,0xab8ba63e2e2fb000,0x28a5aea72ff6ada8
.quad 0x2da80000ada83000,0x2da80000ada83000,0xaf0e263e2d13b000,0xafa82ea7a246ada8,0x2fd9aa1fac723000,0x263eaf642ea70000,0xaff62c722b8bb000,0x2e2f263eafa82da8
.quad 0x2f64ada8aa1f3000,0xaf642da82a1fb000,0xae2f2ea728a5b000,0x2246afd92b8b2da8,0x2c72af64a63e3000,0x2ea72a1fafd98000,0xa8a52fd92246b000,0xaf0e2c722e2fada8
.quad 0xb00080003000,0xb00080003000,0x28a52fd9a246b000,0x2f0e2c72ae2fada8,0xac72af64263e3000,0xaea72a1f2fd90000,0x2e2f2ea7a8a5b000,0xa246afd9ab8b2da8
.quad 0xaf64ada82a1f3000,0x2f642da8aa1fb000,0x2ff62c72ab8bb000,0xae2f263e2fa82da8,0xafd9aa1f2c723000,0xa63eaf64aea78000,0x2f0e263ead13b000,0x2fa82ea72246ada8
.quad 0xada880002da83000,0xada880002da83000,0x2b8ba63eae2fb000,0xa8a5aea7aff6ada8,0xa63e2a1f2ea73000,0x2fd92f642c720000,0xa246ac72af0eb000,0xad13a63e28a52da8
.quad 0x2a1f2da82f643000,0xaa1fada8af64b000,0xad13aea7afa8b000,0x2ff62fd92f0e2da8,0x2ea72f642fd93000,0xac72aa1fa63e8000,0xafa8afd9aff6b000,0xab8bac72ad13ada8
.quad 0xb0003000b0003000,0xb0003000b0003000,0x2e2faea72f0eaf64,0x2246a63e28a5aa1f,0xa63e2a1fac722da8,0x2fd9af642ea7ada8,0xab8b263e2246aa1f,0xa8a52c72ae2f2f64
.quad 0x2f64ada82a1f0000,0xaf642da8aa1f8000,0xafa82fd9ae2f2a1f,0x2b8baea72ff6af64,0x2c72af642fd9ada8,0x2ea7aa1fa63e2da8,0x22462c72afa82f64,0xad132fd9af0e2a1f
.quad 0xada880002da8b000,0xada880002da8b000,0x2ff6ac72a8a52f64,0x2e2fafd92b8b2a1f,0xaea72f64a63eada8,0x2c722a1fafd92da8,0x28a5afd92d132a1f,0xaf0e2ea72246af64
.quad 0x2a1f2da8af648000,0xaa1fada82f640000,0xaf0ea63e2ff6aa1f,0x2fa8ac72ad132f64,0x2fd9aa1faea72da8,0x263e2f64ac72ada8,0xad132ea72b8baf64,0xaff6263e2fa8aa1f
.quad 0xb00080003000,0xb00080003000,0x2d132ea7ab8baf64,0x2ff6263eafa8aa1f,0xafd9aa1f2ea72da8,0xa63e2f642c72ada8,0x2f0ea63eaff6aa1f,0xafa8ac722d132f64
.quad 0xaa1f2da82f640000,0x2a1fada8af648000,0xa8a5afd9ad132a1f,0x2f0e2ea7a246af64,0x2ea72f64263eada8,0xac722a1f2fd92da8,0xaff6ac7228a52f64,0xae2fafd9ab8b2a1f
.quad 0x2da80000ada8b000,0x2da80000ada8b000,0xa2462c722fa82f64,0x2d132fd92f0e2a1f,0xac72af64afd9ada8,0xaea7aa1f263e2da8,0x2fa82fd92e2f2a1f,0xab8baea7aff6af64
.quad 0xaf64ada8aa1f8000,0x2f642da82a1f0000,0x2b8b263ea246aa1f,0x28a52c722e2f2f64,0x263e2a1f2c722da8,0xafd9af64aea7ada8,0xae2faea7af0eaf64,0xa246a63ea8a5aa1f
.quad 0xb0003000b0003000,0xb0003000b0003000,0xa8a5263ea2468000,0xaf0e2ea7ae2f2da8,0x2ea7af642fd9b000,0xac722a1fa63e8000,0x2e2fac7228a50000,0xa246a63e2b8bada8
.quad 0xaa1f2da8af643000,0x2a1fada82f64b000,0xaff62ea7ab8b8000,0x2e2fafd92fa8ada8,0xa63eaa1f2ea7b000,0x2fd9af642c720000,0x2f0eafd92d130000,0x2fa8ac72a2462da8
.quad 0x2da80000ada83000,0x2da80000ada83000,0xab8b2fd9ae2f8000,0x28a52c72aff62da8,0xafd92a1f2c72b000,0xa63e2f64aea78000,0xa246aea72f0e0000,0xad132fd9a8a5ada8
.quad 0x2f64ada8aa1f3000,0xaf642da82a1fb000,0x2d132c72afa88000,0xaff6263e2f0eada8,0xac722f64263eb000,0xaea7aa1f2fd90000,0xafa8a63e2ff60000,0xab8baea72d132da8
.quad 0xb00080003000,0xb00080003000,0x2fa8a63eaff68000,0x2b8baea7ad132da8,0x2c722f64a63eb000,0x2ea7aa1fafd98000,0xad132c722fa80000,0x2ff6263eaf0eada8
.quad 0xaf64ada82a1f3000,0x2f642da8aa1fb000,0x2246aea7af0e8000,0x2d132fd928a5ada8,0x2fd92a1fac72b000,0x263e2f642ea70000,0x2b8b2fd92e2f0000,0xa8a52c722ff62da8
.quad 0xada880002da83000,0xada880002da83000,0xaf0eafd9ad138000,0xafa8ac7222462da8,0x263eaa1faea7b000,0xafd9af64ac728000,0x2ff62ea72b8b0000,0xae2fafd9afa8ada8
.quad 0x2a1f2da82f643000,0xaa1fada8af64b000,0xae2fac72a8a58000,0x2246a63eab8bada8,0xaea7af64afd9b000,0x2c722a1f263e0000,0x28a5263e22460000,0x2f0e2ea72e2f2da8
.quad 0xb0003000b0003000,0xb0003000b0003000,0xad132c72ab8b2a1f,0xaff62fd9afa82f64,0x263eaa1f2c72ada8,0xafd92f64aea72da8,0x2f0eafd92ff6af64,0xafa82ea7ad132a1f
.quad 0x2f64ada82a1f0000,0xaf642da8aa1f8000,0x28a5263ead132f64,0xaf0e2c72a246aa1f,0xac722f64afd92da8,0xaea72a1f263eada8,0xaff62ea7a8a5aa1f,0xae2f263e2b8baf64
.quad 0xada880002da8b000,0xada880002da8b000,0x2246aea72fa8aa1f,0xad13a63e2f0eaf64,0x2ea7af64263e2da8,0xac72aa1f2fd9ada8,0x2fa8a63eae2f2f64,0xab8bac722ff6aa1f
.quad 0x2a1f2da8af648000,0xaa1fada82f640000,0xab8b2fd9a246af64,0xa8a5aea72e2f2a1f,0xafd92a1f2ea7ada8,0xa63eaf642c722da8,0xae2fac722f0e2a1f,0xa246afd928a52f64
.quad 0xb00080003000,0xb00080003000,0x2e2fac72af0e2a1f,0x2246afd9a8a52f64,0x2fd92a1faea7ada8,0x263eaf64ac722da8,0x2b8b2fd92246af64,0x28a5aea7ae2f2a1f
.quad 0xaa1f2da82f640000,0x2a1fada8af648000,0xafa8a63e2e2f2f64,0x2b8bac72aff6aa1f,0xaea7af64a63e2da8,0x2c72aa1fafd9ada8,0xa246aea7afa8aa1f,0x2d13a63eaf0eaf64
.quad 0x2da80000ada8b000,0x2da80000ada8b000,0x2ff62ea728a5aa1f,0x2e2f263eab8baf64,0x2c722f642fd92da8,0x2ea72a1fa63eada8,0xa8a5263e2d132f64,0x2f0e2c722246aa1f
.quad 0xaf64ada8aa1f8000,0x2f642da82a1f0000,0xaf0eafd9aff6af64,0x2fa82ea72d132a1f,0xa63eaa1fac72ada8,0x2fd92f642ea72da8,0x2d132c722b8b2a1f,0x2ff62fd92fa82f64
.quad 0x8000800080008000,0x8000800080008000,0xa8a5a63ea2468000,0xaf0eaea7ae2fada8,0xac72aa1fa63e8000,0xaea7af64afd9b000,0xae2fac72a8a58000,0x2246a63eab8bada8
.quad 0xaf64ada8aa1f8000,0x2f642da82a1f8000,0xaff6aea7ab8b8000,0x2e2f2fd92fa82da8,0xafd9af64ac728000,0xa63e2a1f2ea73000,0xaf0eafd9ad138000,0xafa8ac7222462da8
.quad 0xada8b000ada88000,0xada8b000ada88000,0xab8bafd9ae2f8000,0x28a5ac72aff6ada8,0xa63eaf64aea78000,0x2fd92a1fac72b000,0x2246aea7af0e8000,0x2d132fd928a5ada8
.quad 0x2a1fada8af648000,0xaa1f2da82f648000,0x2d13ac72afa88000,0xaff6a63e2f0e2da8,0x2ea7aa1fafd98000,0xac72af64263e3000,0x2fa8a63eaff68000,0x2b8baea7ad132da8
.quad 0x30008000b0008000,0x30008000b0008000,0x2fa8263eaff68000,0x2b8b2ea7ad13ada8,0x2ea72a1fafd98000,0xac722f64263eb000,0x2d132c72afa88000,0xaff6263e2f0eada8
.quad 0x2a1f2da8af648000,0xaa1fada82f648000,0x22462ea7af0e8000,0x2d13afd928a52da8,0xa63e2f64aea78000,0x2fd9aa1fac723000,0xab8b2fd9ae2f8000,0x28a52c72aff62da8
.quad 0xada83000ada88000,0xada83000ada88000,0xaf0e2fd9ad138000,0xafa82c722246ada8,0xafd92f64ac728000,0xa63eaa1f2ea7b000,0xaff62ea7ab8b8000,0x2e2fafd92fa8ada8
.quad 0xaf642da8aa1f8000,0x2f64ada82a1f8000,0xae2f2c72a8a58000,0x2246263eab8b2da8,0xac722a1fa63e8000,0xaea72f64afd93000,0xa8a5263ea2468000,0xaf0e2ea7ae2f2da8
.quad 0x8000800080008000,0x8000800080008000,0xad13ac72ab8baa1f,0xaff6afd9afa8af64,0xafd9af64aea7ada8,0xa63eaa1fac72ada8,0xaf0eafd9aff6af64,0x2fa82ea72d132a1f
.quad 0xaa1fada8af64b000,0x2a1f2da82f643000,0x28a5a63ead13af64,0xaf0eac72a2462a1f,0x2ea72a1fa63eada8,0xac72af64afd9ada8,0x2ff62ea728a5aa1f,0x2e2f263eab8baf64
.quad 0x2da830002da88000,0x2da830002da88000,0x22462ea72fa82a1f,0xad13263e2f0e2f64,0xac722a1f2fd92da8,0xaea7af64a63e2da8,0xafa8a63e2e2f2f64,0x2b8bac72aff6aa1f
.quad 0xaf64ada82a1f3000,0x2f642da8aa1fb000,0xab8bafd9a2462f64,0xa8a52ea72e2faa1f,0x263eaf64ac722da8,0xafd9aa1f2ea72da8,0x2e2fac72af0e2a1f,0x2246afd9a8a52f64
.quad 0x30008000b0008000,0x30008000b0008000,0x2e2f2c72af0eaa1f,0x22462fd9a8a5af64,0x263e2f64ac72ada8,0xafd92a1f2ea7ada8,0xab8b2fd9a246af64,0xa8a5aea72e2f2a1f
.quad 0xaf642da82a1fb000,0x2f64ada8aa1f3000,0xafa8263e2e2faf64,0x2b8b2c72aff62a1f,0xac72aa1f2fd9ada8,0xaea72f64a63eada8,0x2246aea72fa8aa1f,0xad13a63e2f0eaf64
.quad 0x2da8b0002da88000,0x2da8b0002da88000,0x2ff6aea728a52a1f,0x2e2fa63eab8b2f64,0x2ea7aa1fa63e2da8,0xac722f64afd92da8,0x28a5263ead132f64,0xaf0e2c72a246aa1f
.quad 0xaa1f2da8af643000,0x2a1fada82f64b000,0xaf0e2fd9aff62f64,0x2fa8aea72d13aa1f,0xafd92f64aea72da8,0xa63e2a1fac722da8,0xad132c72ab8b2a1f,0xaff62fd9afa82f64
.quad 0x8000800080008000,0x8000800080008000,0xafa8afd9aff6b000,0xab8bac72ad13ada8,0x2c722a1f263e8000,0x2ea72f642fd93000,0x2d132ea72fa83000,0xaff6afd9af0eada8
.quad 0xaf64ada8aa1f8000,0x2f642da82a1f8000,0xa246ac72af0eb000,0xad13a63e28a52da8,0x2fd92f642c728000,0x263eaa1faea7b000,0xab8b263e2e2f3000,0x28a52ea72ff62da8
.quad 0xada8b000ada88000,0xada8b000ada88000,0x2f0e263ead13b000,0x2fa82ea72246ada8,0x263e2f642ea78000,0xafd9aa1f2c723000,0xaff6ac722b8b3000,0x2e2fa63eafa8ada8
.quad 0x2a1fada8af648000,0xaa1f2da82f648000,0x2e2f2ea7a8a5b000,0xa246afd9ab8b2da8,0xaea72a1f2fd98000,0x2c722f64a63eb000,0xa8a5afd922463000,0xaf0eac722e2f2da8
.quad 0x30008000b0008000,0x30008000b0008000,0xa8a52fd92246b000,0xaf0e2c722e2fada8,0xaea7aa1f2fd98000,0x2c72af64a63e3000,0x2e2faea7a8a53000,0xa2462fd9ab8bada8
.quad 0x2a1f2da8af648000,0xaa1fada82f648000,0xaff62c722b8bb000,0x2e2f263eafa82da8,0x263eaf642ea78000,0xafd92a1f2c72b000,0x2f0ea63ead133000,0x2fa8aea722462da8
.quad 0xada83000ada88000,0xada83000ada88000,0xab8ba63e2e2fb000,0x28a5aea72ff6ada8,0x2fd9af642c728000,0x263e2a1faea73000,0xa2462c72af0e3000,0xad13263e28a5ada8
.quad 0xaf642da8aa1f8000,0x2f64ada82a1f8000,0x2d13aea72fa8b000,0xaff62fd9af0e2da8,0x2c72aa1f263e8000,0x2ea7af642fd9b000,0xafa82fd9aff63000,0xab8b2c72ad132da8
.quad 0x8000800080008000,0x8000800080008000,0xae2faea7af0eaf64,0xa246a63ea8a5aa1f,0x2fd92f642ea72da8,0x263e2a1f2c722da8,0xab8ba63e22462a1f,0xa8a5ac72ae2faf64
.quad 0xaa1fada8af64b000,0x2a1f2da82f643000,0x2fa82fd92e2f2a1f,0xab8baea7aff6af64,0xaea7aa1f263e2da8,0x2c722f642fd92da8,0x2246ac72afa8af64,0xad13afd9af0eaa1f
.quad 0x2da830002da88000,0x2da830002da88000,0xaff6ac7228a52f64,0xae2fafd9ab8b2a1f,0x2c72aa1fafd9ada8,0x2ea72f64263eada8,0x28a52fd92d13aa1f,0xaf0eaea722462f64
.quad 0xaf64ada82a1f3000,0x2f642da8aa1fb000,0x2f0ea63eaff6aa1f,0xafa8ac722d132f64,0xa63e2f642c72ada8,0x2fd92a1faea7ada8,0xad13aea72b8b2f64,0xaff6a63e2fa82a1f
.quad 0x30008000b0008000,0x30008000b0008000,0xad132ea72b8baf64,0xaff6263e2fa8aa1f,0xa63eaf642c722da8,0x2fd9aa1faea72da8,0x2f0e263eaff62a1f,0xafa82c722d13af64
.quad 0xaf642da82a1fb000,0x2f64ada8aa1f3000,0x28a5afd92d132a1f,0xaf0e2ea72246af64,0x2c722a1fafd92da8,0x2ea7af64263e2da8,0xaff62c7228a5af64,0xae2f2fd9ab8baa1f
.quad 0x2da8b0002da88000,0x2da8b0002da88000,0x22462c72afa82f64,0xad132fd9af0e2a1f,0xaea72a1f263eada8,0x2c72af642fd9ada8,0x2fa8afd92e2faa1f,0xab8b2ea7aff62f64
.quad 0xaa1f2da8af643000,0x2a1fada82f64b000,0xab8b263e2246aa1f,0xa8a52c72ae2f2f64,0x2fd9af642ea7ada8,0x263eaa1f2c72ada8,0xae2f2ea7af0e2f64,0xa246263ea8a52a1f
.quad 0x8000800080008000,0x8000800080008000,0x28a5263e22468000,0x2f0e2ea72e2f2da8,0xac72aa1fa63e8000,0xaea7af64afd9b000,0x2e2f2c7228a58000,0xa246263e2b8b2da8
.quad 0xaf64ada8aa1f8000,0x2f642da82a1f8000,0x2ff62ea72b8b8000,0xae2fafd9afa8ada8,0xafd9af64ac728000,0xa63e2a1f2ea73000,0x2f0e2fd92d138000,0x2fa82c72a246ada8
.quad 0xada8b000ada88000,0xada8b000ada88000,0x2b8b2fd92e2f8000,0xa8a52c722ff62da8,0xa63eaf64aea78000,0x2fd92a1fac72b000,0xa2462ea72f0e8000,0xad13afd9a8a52da8
.quad 0x2a1fada8af648000,0xaa1f2da82f648000,0xad132c722fa88000,0x2ff6263eaf0eada8,0x2ea7aa1fafd98000,0xac72af64263e3000,0xafa8263e2ff68000,0xab8b2ea72d13ada8
.quad 0x30008000b0008000,0x30008000b0008000,0xafa8a63e2ff68000,0xab8baea72d132da8,0x2ea72a1fafd98000,0xac722f64263eb000,0xad13ac722fa88000,0x2ff6a63eaf0e2da8
.quad 0x2a1f2da8af648000,0xaa1fada82f648000,0xa246aea72f0e8000,0xad132fd9a8a5ada8,0xa63e2f64aea78000,0x2fd9aa1fac723000,0x2b8bafd92e2f8000,0xa8a5ac722ff6ada8
.quad 0xada83000ada88000,0xada83000ada88000,0x2f0eafd92d138000,0x2fa8ac72a2462da8,0xafd92f64ac728000,0xa63eaa1f2ea7b000,0x2ff6aea72b8b8000,0xae2f2fd9afa82da8
.quad 0xaf642da8aa1f8000,0x2f64ada82a1f8000,0x2e2fac7228a58000,0xa246a63e2b8bada8,0xac722a1fa63e8000,0xaea72f64afd93000,0x28a5a63e22468000,0x2f0eaea72e2fada8
.quad 0x8000800080008000,0x8000800080008000,0x2d132c722b8b2a1f,0x2ff62fd92fa82f64,0xafd9af64aea7ada8,0xa63eaa1fac72ada8,0x2f0e2fd92ff62f64,0xafa8aea7ad13aa1f
.quad 0xaa1fada8af64b000,0x2a1f2da82f643000,0xa8a5263e2d132f64,0x2f0e2c722246aa1f,0x2ea72a1fa63eada8,0xac72af64afd9ada8,0xaff6aea7a8a52a1f,0xae2fa63e2b8b2f64
.quad 0x2da830002da88000,0x2da830002da88000,0xa246aea7afa8aa1f,0x2d13a63eaf0eaf64,0xac722a1f2fd92da8,0xaea7af64a63e2da8,0x2fa8263eae2faf64,0xab8b2c722ff62a1f
.quad 0xaf64ada82a1f3000,0x2f642da8aa1fb000,0x2b8b2fd92246af64,0x28a5aea7ae2f2a1f,0x263eaf64ac722da8,0xafd9aa1f2ea72da8,0xae2f2c722f0eaa1f,0xa2462fd928a5af64
.quad 0x30008000b0008000,0x30008000b0008000,0xae2fac722f0e2a1f,0xa246afd928a52f64,0x263e2f64ac72ada8,0xafd92a1f2ea7ada8,0x2b8bafd922462f64,0x28a52ea7ae2faa1f
.quad 0xaf642da82a1fb000,0x2f64ada8aa1f3000,0x2fa8a63eae2f2f64,0xab8bac722ff6aa1f,0xac72aa1f2fd9ada8,0xaea72f64a63eada8,0xa2462ea7afa82a1f,0x2d13263eaf0e2f64
.quad 0x2da8b0002da88000,0x2da8b0002da88000,0xaff62ea7a8a5aa1f,0xae2f263e2b8baf64,0x2ea7aa1fa63e2da8,0xac722f64afd92da8,0xa8a5a63e2d13af64,0x2f0eac7222462a1f
.quad 0xaa1f2da8af643000,0x2a1fada82f64b000,0x2f0eafd92ff6af64,0xafa82ea7ad132a1f,0xafd92f64aea72da8,0xa63e2a1fac722da8,0x2d13ac722b8baa1f,0x2ff6afd92fa8af64
.quad 0x8000800080008000,0x8000800080008000,0x2fa82fd92ff63000,0x2b8b2c722d132da8,0x2c722a1f263e8000,0x2ea72f642fd93000,0xad13aea7afa8b000,0x2ff62fd92f0e2da8
.quad 0xaf64ada8aa1f8000,0x2f642da82a1f8000,0x22462c722f0e3000,0x2d13263ea8a5ada8,0x2fd92f642c728000,0x263eaa1faea7b000,0x2b8ba63eae2fb000,0xa8a5aea7aff6ada8
.quad 0xada8b000ada88000,0xada8b000ada88000,0xaf0ea63e2d133000,0xafa8aea7a2462da8,0x263e2f642ea78000,0xafd9aa1f2c723000,0x2ff62c72ab8bb000,0xae2f263e2fa82da8
.quad 0x2a1fada8af648000,0xaa1f2da82f648000,0xae2faea728a53000,0x22462fd92b8bada8,0xaea72a1f2fd98000,0x2c722f64a63eb000,0x28a52fd9a246b000,0x2f0e2c72ae2fada8
.quad 0x30008000b0008000,0x30008000b0008000,0x28a5afd9a2463000,0x2f0eac72ae2f2da8,0xaea7aa1f2fd98000,0x2c72af64a63e3000,0xae2f2ea728a5b000,0x2246afd92b8b2da8
.quad 0x2a1f2da8af648000,0xaa1fada82f648000,0x2ff6ac72ab8b3000,0xae2fa63e2fa8ada8,0x263eaf642ea78000,0xafd92a1f2c72b000,0xaf0e263e2d13b000,0xafa82ea7a246ada8
.quad 0xada83000ada88000,0xada83000ada88000,0x2b8b263eae2f3000,0xa8a52ea7aff62da8,0x2fd9af642c728000,0x263e2a1faea73000,0x2246ac722f0eb000,0x2d13a63ea8a52da8
.quad 0xaf642da8aa1f8000,0x2f64ada82a1f8000,0xad132ea7afa83000,0x2ff6afd92f0eada8,0x2c72aa1f263e8000,0x2ea7af642fd9b000,0x2fa8afd92ff6b000,0x2b8bac722d13ada8
.quad 0x8000800080008000,0x8000800080008000,0x2e2f2ea72f0e2f64,0x2246263e28a52a1f,0x2fd92f642ea72da8,0x263e2a1f2c722da8,0x2b8b263ea246aa1f,0x28a52c722e2f2f64
.quad 0xaa1fada8af64b000,0x2a1f2da82f643000,0xafa8afd9ae2faa1f,0x2b8b2ea72ff62f64,0xaea7aa1f263e2da8,0x2c722f642fd92da8,0xa2462c722fa82f64,0x2d132fd92f0e2a1f
.quad 0x2da830002da88000,0x2da830002da88000,0x2ff62c72a8a5af64,0x2e2f2fd92b8baa1f,0x2c72aa1fafd9ada8,0x2ea72f64263eada8,0xa8a5afd9ad132a1f,0x2f0e2ea7a246af64
.quad 0xaf64ada82a1f3000,0x2f642da8aa1fb000,0xaf0e263e2ff62a1f,0x2fa82c72ad13af64,0xa63e2f642c72ada8,0x2fd92a1faea7ada8,0x2d132ea7ab8baf64,0x2ff6263eafa8aa1f
.quad 0x30008000b0008000,0x30008000b0008000,0x2d13aea7ab8b2f64,0x2ff6a63eafa82a1f,0xa63eaf642c722da8,0x2fd9aa1faea72da8,0xaf0ea63e2ff6aa1f,0x2fa8ac72ad132f64
.quad 0xaf642da82a1fb000,0x2f64ada8aa1f3000,0xa8a52fd9ad13aa1f,0x2f0eaea7a2462f64,0x2c722a1fafd92da8,0x2ea7af64263e2da8,0x2ff6ac72a8a52f64,0x2e2fafd92b8b2a1f
.quad 0x2da8b0002da88000,0x2da8b0002da88000,0xa246ac722fa8af64,0x2d13afd92f0eaa1f,0xaea72a1f263eada8,0x2c72af642fd9ada8,0xafa82fd9ae2f2a1f,0x2b8baea72ff6af64
.quad 0xaa1f2da8af643000,0x2a1fada82f64b000,0x2b8ba63ea2462a1f,0x28a5ac722e2faf64,0x2fd9af642ea7ada8,0x263eaa1f2c72ada8,0x2e2faea72f0eaf64,0x2246a63e28a5aa1f
.quad 0x8000800080008000,0x8000800080008000,0x28a5a63e22468000,0x2f0eaea72e2fada8,0x2c72aa1f263e8000,0x2ea7af642fd9b000,0x2e2fac7228a58000,0xa246a63e2b8bada8
.quad 0x2f64ada82a1f8000,0xaf642da8aa1f8000,0x2ff6aea72b8b8000,0xae2f2fd9afa82da8,0x2fd9af642c728000,0x263e2a1faea73000,0x2f0eafd92d138000,0x2fa8ac72a2462da8
.quad 0x2da8b0002da88000,0x2da8b0002da88000,0x2b8bafd92e2f8000,0xa8a5ac722ff6ada8,0x263eaf642ea78000,0xafd92a1f2c72b000,0xa246aea72f0e8000,0xad132fd9a8a5ada8
.quad 0xaa1fada82f648000,0x2a1f2da8af648000,0xad13ac722fa88000,0x2ff6a63eaf0e2da8,0xaea7aa1f2fd98000,0x2c72af64a63e3000,0xafa8a63e2ff68000,0xab8baea72d132da8
.quad 0xb000800030008000,0xb000800030008000,0xafa8263e2ff68000,0xab8b2ea72d13ada8,0xaea72a1f2fd98000,0x2c722f64a63eb000,0xad132c722fa88000,0x2ff6263eaf0eada8
.quad 0xaa1f2da82f648000,0x2a1fada8af648000,0xa2462ea72f0e8000,0xad13afd9a8a52da8,0x263e2f642ea78000,0xafd9aa1f2c723000,0x2b8b2fd92e2f8000,0xa8a52c722ff62da8
.quad 0x2da830002da88000,0x2da830002da88000,0x2f0e2fd92d138000,0x2fa82c72a246ada8,0x2fd92f642c728000,0x263eaa1faea7b000,0x2ff62ea72b8b8000,0xae2fafd9afa8ada8
.quad 0x2f642da82a1f8000,0xaf64ada8aa1f8000,0x2e2f2c7228a58000,0xa246263e2b8b2da8,0x2c722a1f263e8000,0x2ea72f642fd93000,0x28a5263e22468000,0x2f0e2ea72e2f2da8
.quad 0x8000800080008000,0x8000800080008000,0x2d13ac722b8baa1f,0x2ff6afd92fa8af64,0x2fd9af642ea7ada8,0x263eaa1f2c72ada8,0x2f0eafd92ff6af64,0xafa82ea7ad132a1f
.quad 0x2a1fada82f64b000,0xaa1f2da8af643000,0xa8a5a63e2d13af64,0x2f0eac7222462a1f,0xaea72a1f263eada8,0x2c72af642fd9ada8,0xaff62ea7a8a5aa1f,0xae2f263e2b8baf64
.quad 0xada83000ada88000,0xada83000ada88000,0xa2462ea7afa82a1f,0x2d13263eaf0e2f64,0x2c722a1fafd92da8,0x2ea7af64263e2da8,0x2fa8a63eae2f2f64,0xab8bac722ff6aa1f
.quad 0x2f64ada8aa1f3000,0xaf642da82a1fb000,0x2b8bafd922462f64,0x28a52ea7ae2faa1f,0xa63eaf642c722da8,0x2fd9aa1faea72da8,0xae2fac722f0e2a1f,0xa246afd928a52f64
.quad 0xb000800030008000,0xb000800030008000,0xae2f2c722f0eaa1f,0xa2462fd928a5af64,0xa63e2f642c72ada8,0x2fd92a1faea7ada8,0x2b8b2fd92246af64,0x28a5aea7ae2f2a1f
.quad 0x2f642da8aa1fb000,0xaf64ada82a1f3000,0x2fa8263eae2faf64,0xab8b2c722ff62a1f,0x2c72aa1fafd9ada8,0x2ea72f64263eada8,0xa246aea7afa8aa1f,0x2d13a63eaf0eaf64
.quad 0xada8b000ada88000,0xada8b000ada88000,0xaff6aea7a8a52a1f,0xae2fa63e2b8b2f64,0xaea7aa1f263e2da8,0x2c722f642fd92da8,0xa8a5263e2d132f64,0x2f0e2c722246aa1f
.quad 0x2a1f2da82f643000,0xaa1fada8af64b000,0x2f0e2fd92ff62f64,0xafa8aea7ad13aa1f,0x2fd92f642ea72da8,0x263e2a1f2c722da8,0x2d132c722b8b2a1f,0x2ff62fd92fa82f64
.quad 0x8000800080008000,0x8000800080008000,0x2fa8afd92ff6b000,0x2b8bac722d13ada8,0xac722a1fa63e8000,0xaea72f64afd93000,0xad132ea7afa83000,0x2ff6afd92f0eada8
.quad 0x2f64ada82a1f8000,0xaf642da8aa1f8000,0x2246ac722f0eb000,0x2d13a63ea8a52da8,0xafd92f64ac728000,0xa63eaa1f2ea7b000,0x2b8b263eae2f3000,0xa8a52ea7aff62da8
.quad 0x2da8b0002da88000,0x2da8b0002da88000,0xaf0e263e2d13b000,0xafa82ea7a246ada8,0xa63e2f64aea78000,0x2fd9aa1fac723000,0x2ff6ac72ab8b3000,0xae2fa63e2fa8ada8
.quad 0xaa1fada82f648000,0x2a1f2da8af648000,0xae2f2ea728a5b000,0x2246afd92b8b2da8,0x2ea72a1fafd98000,0xac722f64263eb000,0x28a5afd9a2463000,0x2f0eac72ae2f2da8
.quad 0xb000800030008000,0xb000800030008000,0x28a52fd9a246b000,0x2f0e2c72ae2fada8,0x2ea7aa1fafd98000,0xac72af64263e3000,0xae2faea728a53000,0x22462fd92b8bada8
.quad 0xaa1f2da82f648000,0x2a1fada8af648000,0x2ff62c72ab8bb000,0xae2f263e2fa82da8,0xa63eaf64aea78000,0x2fd92a1fac72b000,0xaf0ea63e2d133000,0xafa8aea7a2462da8
.quad 0x2da830002da88000,0x2da830002da88000,0x2b8ba63eae2fb000,0xa8a5aea7aff6ada8,0xafd9af64ac728000,0xa63e2a1f2ea73000,0x22462c722f0e3000,0x2d13263ea8a5ada8
.quad 0x2f642da82a1f8000,0xaf64ada8aa1f8000,0xad13aea7afa8b000,0x2ff62fd92f0e2da8,0xac72aa1fa63e8000,0xaea7af64afd9b000,0x2fa82fd92ff63000,0x2b8b2c722d132da8
.quad 0x8000800080008000,0x8000800080008000,0x2e2faea72f0eaf64,0x2246a63e28a5aa1f,0xafd92f64aea72da8,0xa63e2a1fac722da8,0x2b8ba63ea2462a1f,0x28a5ac722e2faf64
.quad 0x2a1fada82f64b000,0xaa1f2da8af643000,0xafa82fd9ae2f2a1f,0x2b8baea72ff6af64,0x2ea7aa1fa63e2da8,0xac722f64afd92da8,0xa246ac722fa8af64,0x2d13afd92f0eaa1f
.quad 0xada83000ada88000,0xada83000ada88000,0x2ff6ac72a8a52f64,0x2e2fafd92b8b2a1f,0xac72aa1f2fd9ada8,0xaea72f64a63eada8,0xa8a52fd9ad13aa1f,0x2f0eaea7a2462f64
.quad 0x2f64ada8aa1f3000,0xaf642da82a1fb000,0xaf0ea63e2ff6aa1f,0x2fa8ac72ad132f64,0x263e2f64ac72ada8,0xafd92a1f2ea7ada8,0x2d13aea7ab8b2f64,0x2ff6a63eafa82a1f
.quad 0xb000800030008000,0xb000800030008000,0x2d132ea7ab8baf64,0x2ff6263eafa8aa1f,0x263eaf64ac722da8,0xafd9aa1f2ea72da8,0xaf0e263e2ff62a1f,0x2fa82c72ad13af64
.quad 0x2f642da8aa1fb000,0xaf64ada82a1f3000,0xa8a5afd9ad132a1f,0x2f0e2ea7a246af64,0xac722a1f2fd92da8,0xaea7af64a63e2da8,0x2ff62c72a8a5af64,0x2e2f2fd92b8baa1f
.quad 0xada8b000ada88000,0xada8b000ada88000,0xa2462c722fa82f64,0x2d132fd92f0e2a1f,0x2ea72a1fa63eada8,0xac72af64afd9ada8,0xafa8afd9ae2faa1f,0x2b8b2ea72ff62f64
.quad 0x2a1f2da82f643000,0xaa1fada8af64b000,0x2b8b263ea246aa1f,0x28a52c722e2f2f64,0xafd9af64aea7ada8,0xa63eaa1fac72ada8,0x2e2f2ea72f0e2f64,0x2246263e28a52a1f
.quad 0x8000800080008000,0x8000800080008000,0xa8a5263ea2468000,0xaf0e2ea7ae2f2da8,0x2c72aa1f263e8000,0x2ea7af642fd9b000,0xae2f2c72a8a58000,0x2246263eab8b2da8
.quad 0x2f64ada82a1f8000,0xaf642da8aa1f8000,0xaff62ea7ab8b8000,0x2e2fafd92fa8ada8,0x2fd9af642c728000,0x263e2a1faea73000,0xaf0e2fd9ad138000,0xafa82c722246ada8
.quad 0x2da8b0002da88000,0x2da8b0002da88000,0xab8b2fd9ae2f8000,0x28a52c72aff62da8,0x263eaf642ea78000,0xafd92a1f2c72b000,0x22462ea7af0e8000,0x2d13afd928a52da8
.quad 0xaa1fada82f648000,0x2a1f2da8af648000,0x2d132c72afa88000,0xaff6263e2f0eada8,0xaea7aa1f2fd98000,0x2c72af64a63e3000,0x2fa8263eaff68000,0x2b8b2ea7ad13ada8
.quad 0xb000800030008000,0xb000800030008000,0x2fa8a63eaff68000,0x2b8baea7ad132da8,0xaea72a1f2fd98000,0x2c722f64a63eb000,0x2d13ac72afa88000,0xaff6a63e2f0e2da8
.quad 0xaa1f2da82f648000,0x2a1fada8af648000,0x2246aea7af0e8000,0x2d132fd928a5ada8,0x263e2f642ea78000,0xafd9aa1f2c723000,0xab8bafd9ae2f8000,0x28a5ac72aff6ada8
.quad 0x2da830002da88000,0x2da830002da88000,0xaf0eafd9ad138000,0xafa8ac7222462da8,0x2fd92f642c728000,0x263eaa1faea7b000,0xaff6aea7ab8b8000,0x2e2f2fd92fa82da8
.quad 0x2f642da82a1f8000,0xaf64ada8aa1f8000,0xae2fac72a8a58000,0x2246a63eab8bada8,0x2c722a1f263e8000,0x2ea72f642fd93000,0xa8a5a63ea2468000,0xaf0eaea7ae2fada8
.quad 0x8000800080008000,0x8000800080008000,0xad132c72ab8b2a1f,0xaff62fd9afa82f64,0x2fd9af642ea7ada8,0x263eaa1f2c72ada8,0xaf0e2fd9aff62f64,0x2fa8aea72d13aa1f
.quad 0x2a1fada82f64b000,0xaa1f2da8af643000,0x28a5263ead132f64,0xaf0e2c72a246aa1f,0xaea72a1f263eada8,0x2c72af642fd9ada8,0x2ff6aea728a52a1f,0x2e2fa63eab8b2f64
.quad 0xada83000ada88000,0xada83000ada88000,0x2246aea72fa8aa1f,0xad13a63e2f0eaf64,0x2c722a1fafd92da8,0x2ea7af64263e2da8,0xafa8263e2e2faf64,0x2b8b2c72aff62a1f
.quad 0x2f64ada8aa1f3000,0xaf642da82a1fb000,0xab8b2fd9a246af64,0xa8a5aea72e2f2a1f,0xa63eaf642c722da8,0x2fd9aa1faea72da8,0x2e2f2c72af0eaa1f,0x22462fd9a8a5af64
.quad 0xb000800030008000,0xb000800030008000,0x2e2fac72af0e2a1f,0x2246afd9a8a52f64,0xa63e2f642c72ada8,0x2fd92a1faea7ada8,0xab8bafd9a2462f64,0xa8a52ea72e2faa1f
.quad 0x2f642da8aa1fb000,0xaf64ada82a1f3000,0xafa8a63e2e2f2f64,0x2b8bac72aff6aa1f,0x2c72aa1fafd9ada8,0x2ea72f64263eada8,0x22462ea72fa82a1f,0xad13263e2f0e2f64
.quad 0xada8b000ada88000,0xada8b000ada88000,0x2ff62ea728a5aa1f,0x2e2f263eab8baf64,0xaea7aa1f263e2da8,0x2c722f642fd92da8,0x28a5a63ead13af64,0xaf0eac72a2462a1f
.quad 0x2a1f2da82f643000,0xaa1fada8af64b000,0xaf0eafd9aff6af64,0x2fa82ea72d132a1f,0x2fd92f642ea72da8,0x263e2a1f2c722da8,0xad13ac72ab8baa1f,0xaff6afd9afa8af64
.quad 0x8000800080008000,0x8000800080008000,0xafa82fd9aff63000,0xab8b2c72ad132da8,0xac722a1fa63e8000,0xaea72f64afd93000,0x2d13aea72fa8b000,0xaff62fd9af0e2da8
.quad 0x2f64ada82a1f8000,0xaf642da8aa1f8000,0xa2462c72af0e3000,0xad13263e28a5ada8,0xafd92f64ac728000,0xa63eaa1f2ea7b000,0xab8ba63e2e2fb000,0x28a5aea72ff6ada8
.quad 0x2da8b0002da88000,0x2da8b0002da88000,0x2f0ea63ead133000,0x2fa8aea722462da8,0xa63e2f64aea78000,0x2fd9aa1fac723000,0xaff62c722b8bb000,0x2e2f263eafa82da8
.quad 0xaa1fada82f648000,0x2a1f2da8af648000,0x2e2faea7a8a53000,0xa2462fd9ab8bada8,0x2ea72a1fafd98000,0xac722f64263eb000,0xa8a52fd92246b000,0xaf0e2c722e2fada8
.quad 0xb000800030008000,0xb000800030008000,0xa8a5afd922463000,0xaf0eac722e2f2da8,0x2ea7aa1fafd98000,0xac72af64263e3000,0x2e2f2ea7a8a5b000,0xa246afd9ab8b2da8
.quad 0xaa1f2da82f648000,0x2a1fada8af648000,0xaff6ac722b8b3000,0x2e2fa63eafa8ada8,0xa63eaf64aea78000,0x2fd92a1fac72b000,0x2f0e263ead13b000,0x2fa82ea72246ada8
.quad 0x2da830002da88000,0x2da830002da88000,0xab8b263e2e2f3000,0x28a52ea72ff62da8,0xafd9af64ac728000,0xa63e2a1f2ea73000,0xa246ac72af0eb000,0xad13a63e28a52da8
.quad 0x2f642da82a1f8000,0xaf64ada8aa1f8000,0x2d132ea72fa83000,0xaff6afd9af0eada8,0xac72aa1fa63e8000,0xaea7af64afd9b000,0xafa8afd9aff6b000,0xab8bac72ad13ada8
.quad 0x8000800080008000,0x8000800080008000,0xae2f2ea7af0e2f64,0xa246263ea8a52a1f,0xafd92f64aea72da8,0xa63e2a1fac722da8,0xab8b263e2246aa1f,0xa8a52c72ae2f2f64
.quad 0x2a1fada82f64b000,0xaa1f2da8af643000,0x2fa8afd92e2faa1f,0xab8b2ea7aff62f64,0x2ea7aa1fa63e2da8,0xac722f64afd92da8,0x22462c72afa82f64,0xad132fd9af0e2a1f
.quad 0xada83000ada88000,0xada83000ada88000,0xaff62c7228a5af64,0xae2f2fd9ab8baa1f,0xac72aa1f2fd9ada8,0xaea72f64a63eada8,0x28a5afd92d132a1f,0xaf0e2ea72246af64
.quad 0x2f64ada8aa1f3000,0xaf642da82a1fb000,0x2f0e263eaff62a1f,0xafa82c722d13af64,0x263e2f64ac72ada8,0xafd92a1f2ea7ada8,0xad132ea72b8baf64,0xaff6263e2fa8aa1f
.quad 0xb000800030008000,0xb000800030008000,0xad13aea72b8b2f64,0xaff6a63e2fa82a1f,0x263eaf64ac722da8,0xafd9aa1f2ea72da8,0x2f0ea63eaff6aa1f,0xafa8ac722d132f64
.quad 0x2f642da8aa1fb000,0xaf64ada82a1f3000,0x28a52fd92d13aa1f,0xaf0eaea722462f64,0xac722a1f2fd92da8,0xaea7af64a63e2da8,0xaff6ac7228a52f64,0xae2fafd9ab8b2a1f
.quad 0xada8b000ada88000,0xada8b000ada88000,0x2246ac72afa8af64,0xad13afd9af0eaa1f,0x2ea72a1fa63eada8,0xac72af64afd9ada8,0x2fa82fd92e2f2a1f,0xab8baea7aff6af64
.quad 0x2a1f2da82f643000,0xaa1fada8af64b000,0xab8ba63e22462a1f,0xa8a5ac72ae2faf64,0xafd9af64aea7ada8,0xa63eaa1fac72ada8,0xae2faea7af0eaf64,0xa246a63ea8a5aa1f
.quad 0x3f8000003f800000,0x3f8000003f800000,0x3f7fffb13f800000,0x3f7ffd393f7ffec4,0x3f7ffec43f800000,0x3f7ff4e63f7ffb11,0x3f7ffd393f800000,0x3f7fe7053f7ff4e6
.quad 0x3f7ffb113f800000,0x3f7fd3973f7fec43,0x3f7ff84a3f800000,0x3f7fba9e3f7fe129,0x3f7ff4e63f800000,0x3f7f9c183f7fd397,0x3f7ff0e33f800000,0x3f7f78083f7fc38f
.quad 0x3f7fec433f800000,0x3f7f4e6d3f7fb10f,0x3f7fe7053f800000,0x3f7f1f493f7f9c18,0x3f7fe1293f800000,0x3f7eea9d3f7f84ab,0x3f7fdaaf3f800000,0x3f7eb0693f7f6ac7
.quad 0x3f7fd3973f800000,0x3f7e70b03f7f4e6d,0x3f7fcbe23f800000,0x3f7e2b723f7f2f9d,0x3f7fc38f3f800000,0x3f7de0b13f7f0e58,0x3f7fba9e3f800000,0x3f7d906e3f7eea9d
.quad 0x3f7fb10f3f800000,0x3f7d3aac3f7ec46d,0x3f7fa6e33f800000,0x3f7cdf6c3f7e9bc9,0x3f7f9c183f800000,0x3f7c7eb03f7e70b0,0x3f7f90b13f800000,0x3f7c187a3f7e4323
.quad 0x3f7f84ab3f800000,0x3f7baccd3f7e1324,0x3f7f78083f800000,0x3f7b3bab3f7de0b1,0x3f7f6ac73f800000,0x3f7ac5163f7dabcc,0x3f7f5ce93f800000,0x3f7a49103f7d7474
.quad 0x3f7f4e6d3f800000,0x3f79c79d3f7d3aac,0x3f7f3f543f800000,0x3f7940c03f7cfe73,0x3f7f2f9d3f800000,0x3f78b47b3f7cbfc9,0x3f7f1f493f800000,0x3f7822d13f7c7eb0
.quad 0x3f7f0e583f800000,0x3f778bc53f7c3b28,0x3f7efcc93f800000,0x3f76ef5b3f7bf531,0x3f7eea9d3f800000,0x3f764d973f7baccd,0x3f7ed7d43f800000,0x3f75a67b3f7b61fc
.quad 0x3f8000003f800000,0x3f8000003f800000,0x3f7ff84a3f7ffb11,0x3f7ff0e33f7ff4e6,0x3f7fe1293f7fec43,0x3f7fc38f3f7fd397,0x3f7fba9e3f7fd397,0x3f7f78083f7f9c18
.quad 0x3f7f84ab3f7fb10f,0x3f7f0e583f7f4e6d,0x3f7f3f543f7f84ab,0x3f7e868b3f7eea9d,0x3f7eea9d3f7f4e6d,0x3f7de0b13f7e70b0,0x3f7e868b3f7f0e58,0x3f7d1cdd3f7de0b1
.quad 0x3f7e13243f7ec46d,0x3f7c3b283f7d3aac,0x3f7d906e3f7e70b0,0x3f7b3bab3f7c7eb0,0x3f7cfe733f7e1324,0x3f7a1e843f7baccd,0x3f7c5d3a3f7dabcc,0x3f78e3d63f7ac516
.quad 0x3f7baccd3f7d3aac,0x3f778bc53f79c79d,0x3f7aed373f7cbfc9,0x3f76167a3f78b47b,0x3f7a1e843f7c3b28,0x3f7484223f778bc5,0x3f7940c03f7baccd,0x3f72d4eb3f764d97
.quad 0x3f7853f83f7b14be,0x3f7109083f74fa0b,0x3f77583a3f7a7302,0x3f6f20b03f73913f,0x3f764d973f79c79d,0x3f6d1c1d3f721352,0x3f75341d3f791298,0x3f6afb8c3f708066
.quad 0x3f740bdd3f7853f8,0x3f68bf3c3f6ed89e,0x3f72d4eb3f778bc5,0x3f6667713f6d1c1d,0x3f718f573f76ba07,0x3f63f4733f6b4b0c,0x3f703b373f75dec6,0x3f61668a3f696591
.quad 0x3f6ed89e3f74fa0b,0x3f5ebe053f676bd8,0x3f6d67a13f740bdd,0x3f5bfb343f655e0b,0x3f6be8583f731447,0x3f591e6a3f633c5a,0x3f6a5ad93f721352,0x3f5627fe3f6106f2
.quad 0x3f68bf3c3f710908,0x3f5318493f5ebe05,0x3f6715993f6ff573,0x3f4fefa83f5c61c7,0x3f655e0b3f6ed89e,0x3f4cae793f59f26a,0x3f6398ac3f6db293,0x3f4955213f577026
.quad 0x8000000080000000,0x8000000080000000,0xbb490fc680000000,0xbc16cb58bbc90f88,0xbbc90f8880000000,0xbc96c9b6bc490e90,0xbc16cb5880000000,0xbce22a7abc96c9b6
.quad 0xbc490e9080000000,0xbd16c32cbcc90ab0,0xbc7b514b80000000,0xbd3c6dd5bcfb49ba,0xbc96c9b680000000,0xbd621469bd16c32c,0xbcafea6980000000,0xbd83db0abd2fe007
.quad 0xbcc90ab080000000,0xbd96a905bd48fb30,0xbce22a7a80000000,0xbda973babd621469,0xbcfb49ba80000000,0xbdbc3ac3bd7b2b74,0xbd0a342f80000000,0xbdcefdb7bd8a200a
.quad 0xbd16c32c80000000,0xbde1bc2ebd96a905,0xbd2351cb80000000,0xbdf475c0bda3308c,0xbd2fe00780000000,0xbe039502bdafb680,0xbd3c6dd580000000,0xbe0cec4abdbc3ac3
.quad 0xbd48fb3080000000,0xbe164083bdc8bd36,0xbd55880e80000000,0xbe1f917bbdd53db9,0xbd62146980000000,0xbe28defcbde1bc2e,0xbd6ea03880000000,0xbe3228d4bdee3876
.quad 0xbd7b2b7480000000,0xbe3b6ecfbdfab273,0xbd83db0a80000000,0xbe44b0b9be039502,0xbd8a200a80000000,0xbe4dee60be09cf86,0xbd9064b480000000,0xbe57278fbe1008b7
.quad 0xbd96a90580000000,0xbe605c13be164083,0xbd9cecf980000000,0xbe698bbabe1c76de,0xbda3308c80000000,0xbe72b651be22abb6,0xbda973ba80000000,0xbe7bdba4be28defc
.quad 0xbdafb68080000000,0xbe827dc0be2f10a2,0xbdb5f8da80000000,0xbe870adabe354098,0xbdbc3ac380000000,0xbe8b9507be3b6ecf,0xbdc27c3980000000,0xbe901c2cbe419b37
.quad 0x8000000080000000,0x8000000080000000,0xbc7b514bbc490e90,0xbcafea69bc96c9b6,0xbcfb49babcc90ab0,0xbd2fe007bd16c32c,0xbd3c6dd5bd16c32c,0xbd83db0abd621469
.quad 0xbd7b2b74bd48fb30,0xbdafb680bd96a905,0xbd9cecf9bd7b2b74,0xbddb7d37bdbc3ac3,0xbdbc3ac3bd96a905,0xbe039502bde1bc2e,0xbddb7d37bdafb680,0xbe195be0be039502
.quad 0xbdfab273bdc8bd36,0xbe2f10a2be164083,0xbe0cec4abde1bc2e,0xbe44b0b9be28defc,0xbe1c76debdfab273,0xbe5a3997be3b6ecf,0xbe2bf804be09cf86,0xbe6fa8b2be4dee60
.quad 0xbe3b6ecfbe164083,0xbe827dc0be605c13,0xbe4ada4fbe22abb6,0xbe8d17c0be72b651,0xbe5a3997be2f10a2,0xbe97a117be827dc0,0xbe698bbabe3b6ecf,0xbea21887be8b9507
.quad 0xbe78cfccbe47c5c2,0xbeac7cd4be94a031,0xbe840270be541501,0xbeb6ccc3be9d9e78,0xbe8b9507be605c13,0xbec1071ebea68f12,0xbe931f35be6c9a7f,0xbecb2aaebeaf713a
.quad 0xbe9aa086be78cfcc,0xbed53641beb8442a,0xbea21887be827dc0,0xbedf28a9bec1071e,0xbea986c4be888e93,0xbee900b7bec9b953,0xbeb0eacbbe8e9a22,0xbef2bd43bed25a09
.quad 0xbeb8442abe94a031,0xbefc5d27bedae880,0xbebf926fbe9aa086,0xbf02ef9fbee363fa,0xbec6d529bea09ae5,0xbf07a136beebcbbb,0xbece0beabea68f12,0xbf0c42c9bef41f07
.quad 0xbed53641beac7cd4,0xbf10d3cdbefc5d27,0xbedc53c1beb263ef,0xbf1553b7bf0242b1,0xbee363fabeb8442a,0xbf19c200bf064b82,0xbeea6681bebe1d4a,0xbf1e1e22bf0a48ad
.quad 0x3f8000003f800000,0x3f8000003f800000,0x3f7fe7053f7fec43,0x3f7fdaaf3f7fe129,0x3f7f9c183f7fb10f,0x3f7f6ac73f7f84ab,0x3f7f1f493f7f4e6d,0x3f7eb0693f7eea9d
.quad 0x3f7e70b03f7ec46d,0x3f7dabcc3f7e1324,0x3f7d906e3f7e1324,0x3f7c5d3a3f7cfe73,0x3f7c7eb03f7d3aac,0x3f7ac5163f7baccd,0x3f7b3bab3f7c3b28,0x3f78e3d63f7a1e84
.quad 0x3f79c79d3f7b14be,0x3f76ba073f7853f8,0x3f7822d13f79c79d,0x3f74484b3f764d97,0x3f764d973f7853f8,0x3f718f573f740bdd,0x3f74484b3f76ba07,0x3f6e8ff83f718f57
.quad 0x3f7213523f74fa0b,0x3f6b4b0c3f6ed89e,0x3f6faf1b3f731447,0x3f67c1873f6be858,0x3f6d1c1d3f710908,0x3f63f4733f68bf3c,0x3f6a5ad93f6ed89e,0x3f5fe4e93f655e0b
.quad 0x3f676bd83f6c835e,0x3f5b941a3f61c598,0x3f644fac3f6a09a7,0x3f5703483f5df6be,0x3f6106f23f676bd8,0x3f5233c63f59f26a,0x3f5d924d3f64aa59,0x3f4d26fd3f55b993
.quad 0x3f59f26a3f61c598,0x3f47de653f514d3d,0x3f5627fe3f5ebe05,0x3f425b893f4cae79,0x3f5233c63f5b941a,0x3f3ca0033f47de65,0x3f4e16893f584853,0x3f36ad7f3f42de29
.quad 0x3f49d1123f54db31,0x3f3085bb3f3daef9,0x3f4564393f514d3d,0x3f2a2a803f385216,0x3f40d0da3f4d9f02,0x3f239da93f32c8c9,0x3f3c17d93f49d112,0x3f1ce11f3f2d1469
.quad 0x3f373a233f45e403,0x3f15f6d93f273656,0x3f3238aa3f41d870,0x3f0ee0db3f212ff9,0x3f2d14693f3daef9,0x3f07a1363f1b02c6,0x3f27ce613f396842,0x3f003a063f14b039
.quad 0x3f8000003f800000,0x3f8000003f800000,0x3f7fcbe23f7fd397,0x3f7fba9e3f7fc38f,0x3f7f2f9d3f7f4e6d,0x3f7eea9d3f7f0e58,0x3f7e2b723f7e70b0,0x3f7d906e3f7de0b1
.quad 0x3f7cbfc93f7d3aac,0x3f7baccd3f7c3b28,0x3f7aed373f7baccd,0x3f7940c03f7a1e84,0x3f78b47b3f79c79d,0x3f764d973f778bc5,0x3f76167a3f778bc5,0x3f72d4eb3f748422
.quad 0x3f7314473f74fa0b,0x3f6ed89e3f710908,0x3f6faf1b3f721352,0x3f6a5ad93f6d1c1d,0x3f6be8583f6ed89e,0x3f655e0b3f68bf3c,0x3f67c1873f6b4b0c,0x3f5fe4e93f63f473
.quad 0x3f633c5a3f676bd8,0x3f59f26a3f5ebe05,0x3f5e5aa63f633c5a,0x3f5389c73f591e6a,0x3f591e6a3f5ebe05,0x3f4cae793f531849,0x3f5389c73f59f26a,0x3f4564393f4cae79
.quad 0x3f4d9f023f54db31,0x3f3daef93f45e403,0x3f4760853f4f7a1f,0x3f3592e73f3ebc1b,0x3f40d0da3f49d112,0x3f2d14693f373a23,0x3f39f2ac3f43e200,0x3f24381a3f2f61a5
.quad 0x3f32c8c93f3daef9,0x3f1b02c63f273656,0x3f2b561b3f373a23,0x3f11796b3f1ebc12,0x3f239da93f3085bb,0x3f07a1363f15f6d9,0x3f1ba2993f299415,0x3efafef73f0cead0
.quad 0x3f13682a3f226799,0x3ee633753f039c3d,0x3f0af1b73f1b02c6,0x3ed0eb2a3ef41f07,0x3f0242b13f13682a,0x3ebb31a03ee0924f,0x3ef2bd433f0b9a6b,0x3ea5129f3ecc9b8b
.quad 0x3ee0924f3f039c3d,0x3e8e9a223eb8442a,0x3ece0bea3ef6e0cb,0x3e6fa8b23ea395c5,0x3ebb31a03ee63375,0x3e419b373e8e9a22,0x3ea80b1f3ed53641,0x3e1324ca3e72b651
.quad 0x8000000080000000,0x8000000080000000,0xbce22a7abcc90ab0,0xbd0a342fbcfb49ba,0xbd621469bd48fb30,0xbd8a200abd7b2b74,0xbda973babd96a905,0xbdcefdb7bdbc3ac3
.quad 0xbde1bc2ebdc8bd36,0xbe09cf86bdfab273,0xbe0cec4abdfab273,0xbe2bf804be1c76de,0xbe28defcbe164083,0xbe4dee60be3b6ecf,0xbe44b0b9be2f10a2,0xbe6fa8b2be5a3997
.quad 0xbe605c13be47c5c2,0xbe888e93be78cfcc,0xbe7bdba4be605c13,0xbe9920febe8b9507,0xbe8b9507be78cfcc,0xbea986c4be9aa086,0xbe9920febe888e93,0xbeb9bb1ebea986c4
.quad 0xbea68f12be94a031,0xbec9b953beb8442a,0xbeb3dca5bea09ae5,0xbed97cb9bec6d529,0xbec1071ebeac7cd4,0xbee900b7bed53641,0xbece0beabeb8442a,0xbef840c8bee363fa
.quad 0xbedae880bec3ef15,0xbf039c3dbef15aea,0xbee79a5dbecf7bca,0xbf0af1b7beff17b2,0xbef41f07bedae880,0xbf121eb0bf064b82,0xbf003a06bee63375,0xbf19210fbf0cead0
.quad 0xbf064b82bef15aea,0xbf1ff6cbbf13682a,0xbf0c42c9befc5d27,0xbf269de3bf19c200,0xbf121eb0bf039c3d,0xbf2d1469bf1ff6cb,0xbf17de12bf08f59b,0xbf33587abf26050a
.quad 0xbf1d7fd1bf0e39da,0xbf396842bf2beb4a,0xbf2302d3bf13682a,0xbf3f41fcbf31a81d,0xbf286605bf187fc0,0xbf44e3f5bf373a23,0xbf2da859bf1d7fd1,0xbf4a4c87bf3ca003
.quad 0xbf32c8c9bf226799,0xbf4f7a1fbf41d870,0xbf37c655bf273656,0xbf546b3bbf46e22a,0xbf3ca003bf2beb4a,0xbf591e6abf4bbbf8,0xbf4154e1bf3085bb,0xbf5d924dbf5064af
.quad 0x8000000080000000,0x8000000080000000,0xbd2351cbbd16c32c,0xbd3c6dd5bd2fe007,0xbda3308cbd96a905,0xbdbc3ac3bdafb680,0xbdf475c0bde1bc2e,0xbe0cec4abe039502
.quad 0xbe22abb6be164083,0xbe3b6ecfbe2f10a2,0xbe4ada4fbe3b6ecf,0xbe698bbabe5a3997,0xbe72b651be605c13,0xbe8b9507be827dc0,0xbe8d17c0be827dc0,0xbea21887be97a117
.quad 0xbea09ae5be94a031,0xbeb8442abeac7cd4,0xbeb3dca5bea68f12,0xbece0beabec1071e,0xbec6d529beb8442a,0xbee363fabed53641,0xbed97cb9bec9b953,0xbef840c8bee900b7
.quad 0xbeebcbbbbedae880,0xbf064b82befc5d27,0xbefdbabbbeebcbbb,0xbf102dd5bf07a136,0xbf07a136befc5d27,0xbf19c200bf10d3cd,0xbf102dd5bf064b82,0xbf2302d3bf19c200
.quad 0xbf187fc0bf0e39da,0xbf2beb4abf226799,0xbf209393bf15f6d9,0xbf34768fbf2ac082,0xbf286605bf1d7fd1,0xbf3ca003bf32c8c9,0xbf2ff3e6bf24d225,0xbf446337bf3a7ca4
.quad 0xbf373a23bf2beb4a,0xbf4bbbf8bf41d870,0xbf3e35c5bf32c8c9,0xbf52a649bf48d8b3,0xbf44e3f5bf396842,0xbf591e6abf4f7a1f,0xbf4b41fabf3fc767,0xbf5f20dbbf55b993
.quad 0xbf514d3dbf45e403,0xbf64aa59bf5b941a,0xbf570348bf4bbbf8,0xbf69b7e4bf6106f2,0xbf5c61c7bf514d3d,0xbf6e46bebf660f88,0xbf61668abf5695e5,0xbf725470bf6aab7b
.quad 0xbf660f88bf5b941a,0xbf75dec6bf6ed89e,0xbf6a5ad9bf604621,0xbf78e3d6bf7294f8,0xbf6e46bebf64aa59,0xbf7b61fcbf75dec6,0xbf71d19fbf68bf3c,0xbf7d57debf78b47b
.quad 0x3f8000003f800000,0x3f8000003f800000,0x3f7fa6e33f7fb10f,0x3f7f90b13f7f9c18,0x3f7e9bc93f7ec46d,0x3f7e43233f7e70b0,0x3f7cdf6c3f7d3aac,0x3f7c187a3f7c7eb0
.quad 0x3f7a73023f7b14be,0x3f7912983f79c79d,0x3f77583a3f7853f8,0x3f75341d3f764d97,0x3f73913f3f74fa0b,0x3f7080663f721352,0x3f6f20b03f710908,0x3f6afb8c3f6d1c1d
.quad 0x3f6a09a73f6c835e,0x3f64aa593f676bd8,0x3f644fac3f676bd8,0x3f5d924d3f6106f2,0x3f5df6be3f61c598,0x3f55b9933f59f26a,0x3f5703483f5b941a,0x3f4d26fd3f5233c6
.quad 0x3f4f7a1f3f54db31,0x3f43e2003f49d112,0x3f4760853f4d9f02,0x3f39f2ac3f40d0da,0x3f3ebc1b3f45e403,0x3f2f61a53f373a23,0x3f3592e73f3daef9,0x3f24381a3f2d1469
.quad 0x3f2beb4a3f3504f3,0x3f187fc03f226799,0x3f21cbfb3f2beb4a,0x3f0c42c93f173c07,0x3f173c073f226799,0x3eff17b23f0b9a6b,0x3f0c42c93f187fc0,0x3ee4cbfe3eff17b2
.quad 0x3f00e7e43f0e39da,0x3ec9b9533ee63375,0x3eea66813f039c3d,0x3eadf73c3ecc9b8b,0x3ed25a093ef15aea,0x3e919ddd3eb263ef,0x3eb9bb1e3edae880,0x3e698bba3e97a117
.quad 0x3ea09ae53ec3ef15,0x3e2f10a23e78cfcc,0x3e870ada3eac7cd4,0x3de7fa9a3e419b37,0x3e5a39973e94a031,0x3d6214693e09cf86,0x3e25c58c3e78cfcc,0xbb490fc63da3308c
.quad 0x3de1bc2e3e47c5c2,0xbd7b2b743cc90ab0,0x3d6ea0383e164083,0xbdf475c0bcfb49ba,0x3bc90f883dc8bd36,0xbe354098bdafb680,0xbd3c6dd53d48fb30,0xbe6fa8b2be1008b7
.quad 0x3f8000003f800000,0x3f8000003f800000,0x3f7f78083f7f84ab,0x3f7f5ce93f7f6ac7,0x3f7de0b13f7e1324,0x3f7d74743f7dabcc,0x3f7b3bab3f7baccd,0x3f7a49103f7ac516
.quad 0x3f778bc53f7853f8,0x3f75dec63f76ba07,0x3f72d4eb3f740bdd,0x3f703b373f718f57,0x3f6d1c1d3f6ed89e,0x3f6965913f6b4b0c,0x3f6667713f68bf3c,0x3f61668a3f63f473
.quad 0x3f5ebe053f61c598,0x3f5848533f5b941a,0x3f5627fe3f59f26a,0x3f4e16893f5233c6,0x3f4cae793f514d3d,0x3f42de293f47de65,0x3f425b893f47de65,0x3f36ad7f3f3ca003
.quad 0x3f373a233f3daef9,0x3f2994153f3085bb,0x3f2b561b3f32c8c9,0x3f1ba2993f239da9,0x3f1ebc123f273656,0x3f0cead03f15f6d9,0x3f11796b3f1b02c6,0x3efafef73f07a136
.quad 0x3f039c3d3f0e39da,0x3edae8803ef15aea,0x3eea66813f00e7e4,0x3eb9bb1e3ed25a09,0x3ecc9b8b3ee63375,0x3e97a1173eb263ef,0x3eadf73c3ec9b953,0x3e698bba3e919ddd
.quad 0x3e8e9a223eac7cd4,0x3e22abb63e605c13,0x3e5d4b1a3e8e9a22,0x3db5f8da3e1c76de,0x3e1c76de3e605c13,0x3c96c9b63dafb680,0x3db5f8da3e22abb6,0xbd55880e3c96c9b6
.quad 0x3cc90ab03dc8bd36,0xbdfab273bd48fb30,0xbd2351cb3d16c32c,0xbe44b0b9bdee3876,0xbdd53db9bcc90ab0,0xbe8586cebe3b6ecf,0xbe2bf804bdafb680,0xbea80b1fbe7ee6e1
.quad 0xbe6c9a7fbe164083,0xbec9b953bea09ae5,0xbe9620d2be541501,0xbeea6681bec1071e,0xbeb554ecbe888e93,0xbf04f484bee0924f,0xbed3c867bea68f12,0xbf140c5fbeff17b2
.quad 0x8000000080000000,0x8000000080000000,0xbd55880ebd48fb30,0xbd6ea038bd621469,0xbdd53db9bdc8bd36,0xbdee3876bde1bc2e,0xbe1f917bbe164083,0xbe3228d4be28defc
.quad 0xbe541501be47c5c2,0xbe6c9a7fbe605c13,0xbe840270be78cfcc,0xbe931f35be8b9507,0xbe9d9e78be94a031,0xbeaf713abea68f12,0xbeb6ccc3beac7cd4,0xbecb2aaebec1071e
.quad 0xbecf7bcabec3ef15,0xbee63375bedae880,0xbee79a5dbedae880,0xbf003a06bef41f07,0xbeff17b2bef15aea,0xbf0cead0bf064b82,0xbf0af1b7bf039c3d,0xbf19210fbf121eb0
.quad 0xbf15f6d9bf0e39da,0xbf24d225bf1d7fd1,0xbf209393bf187fc0,0xbf2ff3e6bf286605,0xbf2ac082bf226799,0xbf3a7ca4bf32c8c9,0xbf34768fbf2beb4a,0xbf446337bf3ca003
.quad 0xbf3daef9bf3504f3,0xbf4d9f02bf45e403,0xbf466354bf3daef9,0xbf5627febf4e8d90,0xbf4e8d90bf45e403,0xbf5df6bebf5695e5,0xbf5627febf4d9f02,0xbf650479bf5df6be
.quad 0xbf5d2d53bf54db31,0xbf6b4b0cbf64aa59,0xbf6398acbf5b941a,0xbf70c501bf6aab7b,0xbf696591bf61c598,0xbf756d97bf6ff573,0xbf6e8ff8bf676bd8,0xbf7940c0bf748422
.quad 0xbf731447bf6c835e,0xbf7c3b28bf7853f8,0xbf76ef5bbf710908,0xbf7e5a38bf7b61fc,0xbf7a1e84bf74fa0b,0xbf7f9c18bf7dabcc,0xbf7c9f8abf7853f8,0xbf7fffb1bf7f2f9d
.quad 0xbf7e70b0bf7b14be,0xbf7f84abbf7fec43,0xbf7f90b1bf7d3aac,0xbf7e2b72bf7fe129,0xbf7ffec4bf7ec46d,0xbf7bf531bf7f0e58,0xbf7fba9ebf7fb10f,0xbf78e3d6bf7d7474
.quad 0x8000000080000000,0x8000000080000000,0xbd83db0abd7b2b74,0xbd9064b4bd8a200a,0xbe039502bdfab273,0xbe1008b7be09cf86,0xbe44b0b9be3b6ecf,0xbe57278fbe4dee60
.quad 0xbe827dc0be78cfcc,0xbe8e9a22be888e93,0xbea21887be9aa086,0xbeb0eacbbea986c4,0xbec1071ebeb8442a,0xbed25a09bec9b953,0xbedf28a9bed53641,0xbef2bd43bee900b7
.quad 0xbefc5d27bef15aea,0xbf08f59bbf039c3d,0xbf0c42c9bf064b82,0xbf17de12bf121eb0,0xbf19c200bf13682a,0xbf26050abf1ff6cb,0xbf269de3bf1ff6cb,0xbf33587abf2d1469
.quad 0xbf32c8c9bf2beb4a,0xbf3fc767bf396842,0xbf3e35c5bf373a23,0xbf4b41fabf44e3f5,0xbf48d8b3bf41d870,0xbf55b993bf4f7a1f,0xbf52a649bf4bbbf8,0xbf5f20dbbf591e6a
.quad 0xbf5b941abf54db31,0xbf676bd8bf61c598,0xbf6398acbf5d2d53,0xbf6e8ff8bf696591,0xbf6aab7bbf64aa59,0xbf748422bf6ff573,0xbf70c501bf6b4b0c,0xbf7940c0bf756d97
.quad 0xbf75dec6bf710908,0xbf7cbfc9bf79c79d,0xbf79f35ebf75dec6,0xbf7efcc9bf7cfe73,0xbf7cfe73bf79c79d,0xbf7ff4e6bf7f0e58,0xbf7efcc9bf7cbfc9,0xbf7fa6e3bf7ff4e6
.quad 0xbf7fec43bf7ec46d,0xbf7e1324bf7fb10f,0xbf7fcbe2bf7fd397,0xbf7b3babbf7e4323,0xbf7e9bc9bf7fec43,0xbf772417bf7baccd,0xbf7c5d3abf7f0e58,0xbf71d19fbf77f110
.quad 0xbf791298bf7d3aac,0xbf6b4b0cbf731447,0xbf74bf62bf7a7302,0xbf6398acbf6d1c1d,0xbf6f6830bf76ba07,0xbf5ac450bf660f88,0xbf6912aebf721352,0xbf50d937bf5df6be
.quad 0x3f8000003f800000,0x3f8000003f800000,0x3f7f3f543f7f4e6d,0x3f7f1f493f7f2f9d,0x3f7cfe733f7d3aac,0x3f7c7eb03f7cbfc9,0x3f7940c03f79c79d,0x3f7822d13f78b47b
.quad 0x3f740bdd3f74fa0b,0x3f7213523f731447,0x3f6d67a13f6ed89e,0x3f6a5ad93f6be858,0x3f655e0b3f676bd8,0x3f6106f23f633c5a,0x3f5bfb343f5ebe05,0x3f5627fe3f591e6a
.quad 0x3f514d3d3f54db31,0x3f49d1123f4d9f02,0x3f4564393f49d112,0x3f3c17d93f40d0da,0x3f3852163f3daef9,0x3f2d14693f32c8c9,0x3f2a2a803f3085bb,0x3f1ce11f3f239da9
.quad 0x3f1b02c63f226799,0x3f0b9a6b3f13682a,0x3f0af1b73f13682a,0x3ef2bd433f0242b1,0x3ef41f073f039c3d,0x3ecc9b8b3ee0924f,0x3ed0eb2a3ee63375,0x3ea5129f3ebb31a0
.quad 0x3eac7cd43ec3ef15,0x3e78cfcc3e94a031,0x3e870ada3ea09ae5,0x3e25c58c3e5a3997,0x3e419b373e78cfcc,0x3da3308c3e09cf86,0x3de7fa9a3e2f10a2,0xbb490fc63d621469
.quad 0x3d16c32c3dc8bd36,0xbdafb680bcc90ab0,0xbd2351cb3cc90ab0,0xbe2bf804bdd53db9,0xbdee3876bd48fb30,0xbe7ee6e1be3b6ecf,0xbe44b0b9bdfab273,0xbea80b1fbe8586ce
.quad 0xbe888e93be47c5c2,0xbecf7bcabeac7cd4,0xbeadf73cbe888e93,0xbef58035bed25a09,0xbed25a09beac7cd4,0xbf0cead0bef6e0cb,0xbef58035becf7bca,0xbf1e1e22bf0cead0
.quad 0xbf0b9a6bbef15aea,0xbf2e3bdebf1d7fd1,0xbf1ba299bf08f59b,0xbf3d27b8bf2d1469,0xbf2ac082bf187fc0,0xbf4ac77fbf3b8f3b,0xbf38dd65bf273656,0xbf570348bf48d8b3
.quad 0x3f8000003f800000,0x3f8000003f800000,0x3f7efcc93f7f0e58,0x3f7ed7d43f7eea9d,0x3f7bf5313f7c3b28,0x3f7b61fc3f7baccd,0x3f76ef5b3f778bc5,0x3f75a67b3f764d97
.quad 0x3f6ff5733f710908,0x3f6db2933f6ed89e,0x3f6715993f68bf3c,0x3f6398ac3f655e0b,0x3f5c61c73f5ebe05,0x3f5770263f59f26a,0x3f4fefa83f531849,0x3f4955213f4cae79
.quad 0x3f41d8703f45e403,0x3f3968423f3daef9,0x3f3238aa3f373a23,0x3f27ce613f2d1469,0x3f212ff93f273656,0x3f14b0393f1b02c6,0x3f0ee0db3f15f6d9,0x3f003a063f07a136
.quad 0x3ef6e0cb3f039c3d,0x3ed536413ee63375,0x3ece0bea3ee0924f,0x3ea80b1f3ebb31a0,0x3ea395c53eb8442a,0x3e72b6513e8e9a22,0x3e6fa8b23e8e9a22,0x3e1324ca3e419b37
.quad 0x3e1640833e47c5c2,0x3d48fb303dc8bd36,0x3d6ea0383de1bc2e,0xbd3c6dd53bc90f88,0xbcfb49ba3cc90ab0,0xbe1008b7bdafb680,0xbdf475c0bd7b2b74,0xbe6fa8b2be354098
.quad 0xbe541501be164083,0xbea68f12be888e93,0xbe9620d2be6c9a7f,0xbed3c867beb554ec,0xbec1071ebea09ae5,0xbeff17b2bee0924f,0xbeea6681bec9b953,0xbf140c5fbf04f484
.quad 0xbf08f59bbef15aea,0xbf273656bf187fc0,0xbf1ba299bf0b9a6b,0xbf38dd65bf2ac082,0xbf2d1469bf1d7fd1,0xbf48d8b3bf3b8f3b,0xbf3d27b8bf2e3bde,0xbf570348bf4ac77f
.quad 0xbf4bbbf8bf3daef9,0xbf633c5abf584853,0xbf58b3a1bf4bbbf8,0xbf6d67a1bf63f473,0xbf63f473bf584853,0xbf756d97bf6db293,0xbf6d67a1bf633c5a,0xbf7b3babbf756d97
.quad 0x8000000080000000,0x8000000080000000,0xbd9cecf9bd96a905,0xbda973babda3308c,0xbe1c76debe164083,0xbe28defcbe22abb6,0xbe698bbabe605c13,0xbe7bdba4be72b651
.quad 0xbe9aa086be94a031,0xbea68f12bea09ae5,0xbebf926fbeb8442a,0xbece0beabec6d529,0xbee363fabedae880,0xbef41f07beebcbbb,0xbf02ef9fbefc5d27,0xbf0c42c9bf07a136
.quad 0xbf13682abf0e39da,0xbf1d7fd1bf187fc0,0xbf2302d3bf1d7fd1,0xbf2da859bf286605,0xbf31a81dbf2beb4a,0xbf3ca003bf373a23,0xbf3f41fcbf396842,0xbf4a4c87bf44e3f5
.quad 0xbf4bbbf8bf45e403,0xbf5695e5bf514d3d,0xbf570348bf514d3d,0xbf61668abf5c61c7,0xbf6106f2bf5b941a,0xbf6aab7bbf660f88,0xbf69b7e4bf64aa59,0xbf725470bf6e46be
.quad 0xbf710908bf6c835e,0xbf7853f8bf74fa0b,0xbf76ef5bbf731447,0xbf7c9f8abf7a1e84,0xbf7b61fcbf7853f8,0xbf7f2f9dbf7dabcc,0xbf7e5a38bf7c3b28,0xbf7fffb1bf7f9c18
.quad 0xbf7fd397bf7ec46d,0xbf7f0e58bf7fec43,0xbf7fcbe2bf7fec43,0xbf7c5d3abf7e9bc9,0xbf7e4323bf7fb10f,0xbf77f110bf7baccd,0xbf7b3babbf7e1324,0xbf71d19fbf772417
.quad 0xbf76ba07bf7b14be,0xbf6a09a7bf710908,0xbf70c501bf76ba07,0xbf60a6cfbf696591,0xbf696591bf710908,0xbf55b993bf604621,0xbf60a6cfbf6a09a7,0xbf495521bf55b993
.quad 0xbf5695e5bf61c598,0xbf3b8f3bbf49d112,0xbf4b41fabf584853,0xbf2c800fbf3ca003,0xbf3ebc1bbf4d9f02,0xbf1c420cbf2e3bde,0xbf311722bf41d870,0xbf0af1b7bf1ebc12
.quad 0x8000000080000000,0x8000000080000000,0xbdb5f8dabdafb680,0xbdc27c39bdbc3ac3,0xbe354098be2f10a2,0xbe419b37be3b6ecf,0xbe870adabe827dc0,0xbe901c2cbe8b9507
.quad 0xbeb263efbeac7cd4,0xbebe1d4abeb8442a,0xbedc53c1bed53641,0xbeea6681bee363fa,0xbf0242b1befc5d27,0xbf0a48adbf064b82,0xbf1553b7bf10d3cd,0xbf1e1e22bf19c200
.quad 0xbf273656bf226799,0xbf3085bbbf2beb4a,0xbf37c655bf32c8c9,0xbf4154e1bf3ca003,0xbf46e22abf41d870,0xbf5064afbf4bbbf8,0xbf546b3bbf4f7a1f,0xbf5d924dbf591e6a
.quad 0xbf604621bf5b941a,0xbf68bf3cbf64aa59,0xbf6a5ad9bf660f88,0xbf71d19fbf6e46be,0xbf7294f8bf6ed89e,0xbf78b47bbf75dec6,0xbf78e3d6bf75dec6,0xbf7d57debf7b61fc
.quad 0xbf7d3aacbf7b14be,0xbf7fb10fbf7ec46d,0xbf7f90b1bf7e70b0,0xbf7fba9ebf7ffec4,0xbf7fe129bf7fec43,0xbf7d7474bf7f0e58,0xbf7e2b72bf7f84ab,0xbf78e3d6bf7bf531
.quad 0xbf7a7302bf7d3aac,0xbf721352bf76ba07,0xbf74bf62bf791298,0xbf6912aebf6f6830,0xbf6d1c1dbf731447,0xbf5df6bebf660f88,0xbf6398acbf6b4b0c,0xbf50d937bf5ac450
.quad 0xbf584853bf61c598,0xbf41d870bf4d9f02,0xbf4b41fabf5695e5,0xbf311722bf3ebc1b,0xbf3ca003bf49d112,0xbf1ebc12bf2e3bde,0xbf2c800fbf3b8f3b,0xbf0af1b7bf1c420c
.quad 0xbf1b02c6bf2beb4a,0xbeebcbbbbf08f59b,0xbf084b92bf1b02c6,0xbebf926fbee900b7,0xbee900b7bf08f59b,0xbe919dddbebe1d4a,0xbebf926fbeebcbbb,0xbe44b0b9be919ddd
.quad 0x3f8000003f800000,0x3f8000003f800000,0x3f7eb0693f7ec46d,0x3f7e868b3f7e9bc9,0x3f7ac5163f7b14be,0x3f7a1e843f7a7302,0x3f74484b3f74fa0b,0x3f72d4eb3f73913f
.quad 0x3f6b4b0c3f6c835e,0x3f68bf3c3f6a09a7,0x3f5fe4e93f61c598,0x3f5bfb343f5df6be,0x3f5233c63f54db31,0x3f4cae793f4f7a1f,0x3f425b893f45e403,0x3f3b06293f3ebc1b
.quad 0x3f3085bb3f3504f3,0x3f2736563f2beb4a,0x3f1ce11f3f226799,0x3f11796b3f173c07,0x3f07a1363f0e39da,0x3ef41f073f00e7e4,0x3ee1fb6a3ef15aea,0x3ec27b553ed25a09
.quad 0x3eb263ef3ec3ef15,0x3e8e9a223ea09ae5,0x3e80f8c03e94a031,0x3e3228d43e5a3997,0x3e1c76de3e47c5c2,0x3d8a200a3de1bc2e,0x3d55880e3dc8bd36,0xbd2351cb3bc90f88
.quad 0xbd48fb30248d3132,0xbe164083bdc8bd36,0xbe195be0bdc8bd36,0xbe80f8c0be4dee60,0xbe7ee6e1be47c5c2,0xbeb554ecbe9aa086,0xbeb0eacbbe94a031,0xbee79a5dbecc9b8b
.quad 0xbee0924fbec3ef15,0xbf0b9a6bbefc5d27,0xbf06f686bef15aea,0xbf21cbfbbf14b039,0xbf1c420cbf0e39da,0xbf36206cbf299415,0xbf2ff3e6bf226799,0xbf485bcabf3ca003
.quad 0xbf41d870bf3504f3,0xbf584853bf4d9f02,0xbf51c0c2bf45e403,0xbf65b710bf5c61c7,0xbf5f8327bf54db31,0xbf708066bf68bf3c,0xbf6afb8cbf61c598,0xbf788486bf7294f8
.quad 0xbf740bddbf6c835e,0xbf7dabccbf79c79d,0xbf7a9c59bf74fa0b,0xbf7fe705bf7e4323,0xbf7e9bc9bf7b14be,0xbf7f2f9dbf7ffb11,0xbf7fffb1bf7ec46d,0xbf7b87b2bf7eea9d
.quad 0x3f8000003f800000,0x3f8000003f800000,0x3f7e5a383f7e70b0,0x3f7e2b723f7e4323,0x3f796e4e3f79c79d,0x3f78b47b3f791298,0x3f714c7a3f721352,0x3f6faf1b3f708066
.quad 0x3f660f883f676bd8,0x3f633c5a3f64aa59,0x3f57dc7f3f59f26a,0x3f5389c73f55b993,0x3f46e22a3f49d112,0x3f40d0da3f43e200,0x3f33587a3f373a23,0x3f2b561b3f2f61a5
.quad 0x3f1d7fd13f226799,0x3f13682a3f187fc0,0x3f05a02c3f0b9a6b,0x3ef2bd433eff17b2,0x3ed8106b3ee63375,0x3ebb31a03ec9b953,0x3ea218873eb263ef,0x3e80f8c03e919ddd
.quad 0x3e5415013e78cfcc,0x3e09cf863e2f10a2,0x3dc27c393e09cf86,0x3c7b514b3d621469,0xbc96c9b63cc90ab0,0xbdd53db9bd7b2b74,0xbe06b26ebdafb680,0xbe636c83be354098
.quad 0xbe78cfccbe47c5c2,0xbeac7cd4be94a031,0xbeb3dca5be9aa086,0xbee4cbfebecc9b8b,0xbee900b7becf7bca,0xbf0cead0bf00e7e4,0xbf0d9281bf00e7e4,0xbf256bcbbf19c200
.quad 0xbf24d225bf187fc0,0xbf3b8f3bbf3085bb,0xbf39f2acbf2e3bde,0xbf4f0417bf44e3f5,0xbf4cae79bf41d870,0xbf5f8327bf5695e5,0xbf5cc7d1bf531849,0xbf6cd007bf655e0b
.quad 0xbf6a09a7bf61c598,0xbf76ba07bf710908,0xbf74484bbf6db293,0xbf7d1cddbf796e4e,0xbf7b61fcbf76ba07,0xbf7fe129bf7e70b0,0xbf7f3f54bf7cbfc9,0xbf7efcc9bf7ffec4
.quad 0xbf7fd397bf7fb10f,0xbf7a7302bf7e1324,0xbf7d1cddbf7f84ab,0xbf725470bf78b47b,0xbf772417bf7c3b28,0xbf66beccbf6ff573,0xbf6dfcf2bf75dec6,0xbf57dc7fbf63f473
.quad 0x8000000080000000,0x8000000080000000,0xbdcefdb7bdc8bd36,0xbddb7d37bdd53db9,0xbe4dee60be47c5c2,0xbe5a3997be541501,0xbe9920febe94a031,0xbea21887be9d9e78
.quad 0xbec9b953bec3ef15,0xbed53641becf7bca,0xbef840c8bef15aea,0xbf02ef9fbeff17b2,0xbf121eb0bf0e39da,0xbf19c200bf15f6d9,0xbf269de3bf226799,0xbf2ecef7bf2ac082
.quad 0xbf396842bf3504f3,0xbf41d870bf3daef9,0xbf4a4c87bf45e403,0xbf52a649bf4e8d90,0xbf591e6abf54db31,0xbf6106f2bf5d2d53,0xbf65b710bf61c598,0xbf6cd007bf696591
.quad 0xbf6ff573bf6c835e,0xbf75dec6bf731447,0xbf77beb7bf74fa0b,0xbf7c187abf7a1e84,0xbf7cfe73bf7b14be,0xbf7f6ac7bf7e70b0,0xbf7fa6e3bf7ec46d,0xbf7fcbe2bf7ffec4
.quad 0xbf7fb10fbf800000,0xbf7d3aacbf7ec46d,0xbf7d1cddbf7ec46d,0xbf77beb7bf7ac516,0xbf77f110bf7b14be,0xbf6f6830bf740bdd,0xbf703b37bf74fa0b,0xbf644facbf6aab7b
.quad 0xbf660f88bf6c835e,0xbf5695e5bf5ebe05,0xbf5988adbf61c598,0xbf466354bf5064af,0xbf4ac77fbf54db31,0xbf33e7bcbf3fc767,0xbf39f2acbf45e403,0xbf1f599fbf2d1469
.quad 0xbf273656bf3504f3,0xbf08f59bbf187fc0,0xbf12c39abf226799,0xbee1fb6abf0242b1,0xbef9a02dbf0e39da,0xbeaf713abed53641,0xbecb2aaebef15aea,0xbe75c35abea395c5
.quad 0xbe9aa086bec3ef15,0xbe09cf86be605c13,0xbe5101f1be94a031,0xbce22a7abdee3876,0xbdd53db9be47c5c2,0x3da3308cbc490e90,0xbb490fc6bdc8bd36,0x3e3e853e3dbc3ac3
.quad 0x8000000080000000,0x8000000080000000,0xbde7fa9abde1bc2e,0xbdf475c0bdee3876,0xbe667c66be605c13,0xbe72b651be6c9a7f,0xbeab0201bea68f12,0xbeb3dca5beaf713a
.quad 0xbee0924fbedae880,0xbeebcbbbbee63375,0xbf099f4ebf064b82,0xbf102dd5bf0cead0,0xbf212ff9bf1d7fd1,0xbf286605bf24d225,0xbf36ad7fbf32c8c9,0xbf3e35c5bf3a7ca4
.quad 0xbf49d112bf45e403,0xbf514d3dbf4d9f02,0xbf5a5ba0bf5695e5,0xbf61668abf5df6be,0xbf6816a8bf64aa59,0xbf6e46bebf6b4b0c,0xbf72d4ebbf6ff573,0xbf77beb7bf756d97
.quad 0xbf7a7302bf7853f8,0xbf7dabccbf7c3b28,0xbf7ed7d4bf7dabcc,0xbf7ff84abf7f9c18,0xbf7ff4e6bf7fec43,0xbf7e9bc9bf7f84ab,0xbf7dc68cbf7f0e58,0xbf799b43bf7bf531
.quad 0xbf7853f8bf7b14be,0xbf710908bf74fa0b,0xbf6faf1bbf740bdd,0xbf650479bf6aab7b,0xbf63f473bf6a09a7,0xbf55b993bf5d2d53,0xbf554aa4bf5d2d53,0xbf436051bf4cae79
.quad 0xbf43e200bf4d9f02,0xbf2e3bdebf396842,0xbf2ff3e6bf3b8f3b,0xbf16999fbf239da9,0xbf19c200bf273656,0xbef9a02dbf0b9a6b,0xbf019573bf10d3cd,0xbec27b55bee363fa
.quad 0xbecf7bcabef15aea,0xbe888e93beac7cd4,0xbe9920febebe1d4a,0xbe195be0be667c66,0xbe419b37be888e93,0xbcfb49babde1bc2e,0xbd9cecf9be22abb6,0x3db5f8da3bc90f88
.quad 0x3d16c32cbd48fb30,0x3e5415013dfab273,0x3e195be03d7b2b74,0x3ea5129f3e72b651,0x3e8586ce3e2f10a2,0x3eddbe793eb263ef,0x3ebca7af3e8e9a22,0x3f099f4e3ee900b7
.quad 0x3f8000003f800000,0x3f8000003f800000,0x3f7dfa383f7e1324,0x3f7dc68c3f7de0b1,0x3f77f1103f7853f8,0x3f7724173f778bc5,0x3f6dfcf23f6ed89e,0x3f6c36243f6d1c1d
.quad 0x3f6046213f61c598,0x3f5d2d533f5ebe05,0x3f4f04173f514d3d,0x3f4a4c873f4cae79,0x3f3a7ca43f3daef9,0x3f33e7bc3f373a23,0x3f2302d33f273656,0x3f1a62933f1ebc12
.quad 0x3f08f59b3f0e39da,0x3efc5d273f039c3d,0x3ed97cb93ee63375,0x3ebf926f3ecc9b8b,0x3e9d9e783eac7cd4,0x3e7ee6e13e8e9a22,0x3e3e853e3e605c13,0x3df475c03e1c76de
.quad 0x3d7b2b743dc8bd36,0xbc490e903cc90ab0,0xbd83db0abcc90ab0,0xbe1324cabdd53db9,0xbe419b37be164083,0xbe8b9507be6c9a7f,0xbe9f1cdfbe888e93,0xbecb2aaebeb554ec
.quad 0xbedae880bec3ef15,0xbf039c3dbef15aea,0xbf099f4ebefc5d27,0xbf1f599fbf14b039,0xbf239da9bf187fc0,0xbf385216bf2e3bde,0xbf3b0629bf3085bb,0xbf4e1689bf44e3f5
.quad 0xbf4f7a1fbf45e403,0xbf604621bf584853,0xbf60a6cfbf584853,0xbf6e8ff8bf6816a8,0xbf6e46bebf676bd8,0xbf78b47bbf740bdd,0xbf7822d1bf731447,0xbf7e868bbf7bf531
.quad 0xbf7e1324bf7b14be,0xbf7fec43bf7fb10f,0xbf7fffb1bf7f4e6d,0xbf7cdf6cbf7f2f9d,0xbf7de0b1bf7fb10f,0xbf756d97bf7a7302,0xbf77beb7bf7c3b28,0xbf69b7e4bf718f57
.quad 0xbf6db293bf74fa0b,0xbf59f26abf64aa59,0xbf5fe4e9bf6a09a7,0xbf466354bf53fac3,0xbf4e8d90bf5b941a,0xbf2f61a5bf3fc767,0xbf39f2acbf49d112,0xbf1553b7bf286605
.quad 0x3f8000003f800000,0x3f8000003f800000,0x3f7d906e3f7dabcc,0x3f7d57de3f7d7474,0x3f764d973f76ba07,0x3f756d973f75dec6,0x3f6a5ad93f6b4b0c,0x3f686b393f696591
.quad 0x3f59f26a3f5b941a,0x3f5695e53f584853,0x3f4564393f47de65,0x3f404c5c3f42de29,0x3f2d14693f3085bb,0x3f26050a3f299415,0x3f11796b3f15f6d9,0x3f084b923f0cead0
.quad 0x3ee633753ef15aea,0x3ecf7bca3edae880,0x3ea5129f3eb263ef,0x3e8a11f73e97a117,0x3e419b373e605c13,0x3e0395023e22abb6,0x3d55880e3dafb680,0xbc7b514b3c96c9b6
.quad 0xbdafb680bd48fb30,0xbe22abb6bdfab273,0xbe636c83be3b6ecf,0xbe9920febe8586ce,0xbeb554ecbea09ae5,0xbeddbe79bec9b953,0xbef58035bee0924f,0xbf0ee0dbbf04f484
.quad 0xbf187fc0bf0e39da,0xbf2beb4abf226799,0xbf33587abf299415,0xbf456439bf3ca003,0xbf4ac77fbf41d870,0xbf5ac450bf531849,0xbf5e5aa6bf5695e5,0xbf6b99fbbf655e0b
.quad 0xbf6db293bf676bd8,0xbf778bc5bf731447,0xbf788486bf740bdd,0xbf7e5a38bf7bf531,0xbf7e9bc9bf7c3b28,0xbf7fe129bf7fd397,0xbf7fdaafbf7fd397,0xbf7c187abf7e9bc9
.quad 0xbf7c3b28bf7ec46d,0xbf731447bf7853f8,0xbf73ced9bf791298,0xbf650479bf6d1c1d,0xbf66beccbf6ed89e,0xbf5233c6bf5d2d53,0xbf554aa4bf604621,0xbf3b0629bf48d8b3
.quad 0xbf3fc767bf4d9f02,0xbf1ff6cbbf3085bb,0xbf269de3bf373a23,0xbf019573bf14b039,0xbf0a48adbf1d7fd1,0xbec1071ebeebcbbb,0xbed6a399bf00e7e4,0xbe75c35abea986c4
.quad 0x8000000080000000,0x8000000080000000,0xbe007745bdfab273,0xbe06b26ebe039502,0xbe7ee6e1be78cfcc,0xbe8586cebe827dc0,0xbebca7afbeb8442a,0xbec5625cbec1071e
.quad 0xbef6e0cbbef15aea,0xbf00e7e4befc5d27,0xbf16999fbf13682a,0xbf1ce11fbf19c200,0xbf2f61a5bf2beb4a,0xbf36206cbf32c8c9,0xbf456439bf41d870,0xbf4c3578bf48d8b3
.quad 0xbf584853bf54db31,0xbf5ebe05bf5b941a,0xbf67c187bf64aa59,0xbf6d67a1bf6aab7b,0xbf73913fbf710908,0xbf77f110bf75dec6,0xbf7b87b2bf79c79d,0xbf7e2b72bf7cfe73
.quad 0xbf7f84abbf7ec46d,0xbf7ffb11bf7fec43,0xbf7f7808bf7fec43,0xbf7d57debf7e9bc9,0xbf7b61fcbf7d3aac,0xbf764d97bf791298,0xbf73530ebf76ba07,0xbf6afb8cbf6f6830
.quad 0xbf676bd8bf6c835e,0xbf5b941abf61c598,0xbf57dc7fbf5ebe05,0xbf485bcabf5064af,0xbf44e3f5bf4d9f02,0xbf31a81dbf3b8f3b,0xbf2ecef7bf396842,0xbf17de12bf239da9
.quad 0xbf15f6d9bf226799,0xbef6e0cbbf08f59b,0xbef58035bf08f59b,0xbeb9bb1ebed8106b,0xbebb31a0bedae880,0xbe72b651be9aa086,0xbe7bdba4bea09ae5,0xbddb7d37be354098
.quad 0xbdfab273be47c5c2,0x3cc90ab0bd48fb30,0x3b490fc6bd96a905,0x3e1f917b3da3308c,0x3e0395023d48fb30,0x3e919ddd3e541501,0x3e80f8c03e2f10a2,0x3ed0eb2a3ea986c4
.quad 0x3ebe1d4a3e94a031,0x3f064b823ee63375,0x3ef840c83ecf7bca,0x3f21cbfb3f0f8784,0x3f173c073f039c3d,0x3f3a7ca43f299415,0x3f2ff3e63f1d7fd1,0x3f4fefa83f40d0da
.quad 0x8000000080000000,0x8000000080000000,0xbe0cec4abe09cf86,0xbe1324cabe1008b7,0xbe8b9507be888e93,0xbe919dddbe8e9a22,0xbece0beabec9b953,0xbed6a399bed25a09
.quad 0xbf064b82bf039c3d,0xbf0b9a6bbf08f59b,0xbf2302d3bf1ff6cb,0xbf28fd41bf26050a,0xbf3ca003bf396842,0xbf42de29bf3fc767,0xbf52a649bf4f7a1f,0xbf58b3a1bf55b993
.quad 0xbf64aa59bf61c598,0xbf6a09a7bf676bd8,0xbf725470bf6ff573,0xbf76841bbf748422,0xbf7b61fcbf79c79d,0xbf7de0b1bf7cbfc9,0xbf7fa6e3bf7f0e58,0xbf7ff84abf7ff4e6
.quad 0xbf7f0e58bf7fb10f,0xbf7cbfc9bf7e1324,0xbf799b43bf7baccd,0xbf74484bbf772417,0xbf6f6830bf731447,0xbf66beccbf6b4b0c,0xbf60a6cfbf660f88,0xbf546b3bbf5ac450
.quad 0xbf4d9f02bf54db31,0xbf3daef9bf45e403,0xbf36ad7fbf3fc767,0xbf2302d3bf2d1469,0xbf1c420cbf273656,0xbf04f484bf10d3cd,0xbefdbabbbf0b9a6b,0xbec8477cbee363fa
.quad 0xbebe1d4abedae880,0xbe827dc0bea09ae5,0xbe75c35abe9aa086,0xbde7fa9abe354098,0xbdd53db9be2f10a2,0x3cfb49babd16c32c,0x3d0a342fbd16c32c,0x3e3228d43dd53db9
.quad 0x3e2f10a23dc8bd36,0x3ea09ae53e78cfcc,0x3e9c1faf3e6c9a7f,0x3ee4cbfe3ec1071e,0x3eddbe793eb8442a,0x3f121eb03f00e7e4,0x3f0d92813ef6e0cb,0x3f2ecef73f1ebc12
.quad 0x3f2994153f187fc0,0x3f47de653f396842,0x3f425b893f32c8c9,0x3f5cc7d13f5064af,0x3f5770263f49d112,0x3f6d1c1d3f633c5a,0x3f686b393f5d2d53,0x3f7884863f718f57
.quad 0x3f8000003f800000,0x3f8000003f800000,0x3f7d1cdd3f7d3aac,0x3f7cdf6c3f7cfe73,0x3f7484223f74fa0b,0x3f73913f3f740bdd,0x3f6667713f676bd8,0x3f644fac3f655e0b
.quad 0x3f5318493f54db31,0x3f4f7a1f3f514d3d,0x3f3b06293f3daef9,0x3f3592e73f385216,0x3f1ebc123f226799,0x3f173c073f1b02c6,0x3efdbabb3f039c3d,0x3eea66813ef41f07
.quad 0x3eb8442a3ec3ef15,0x3ea09ae53eac7cd4,0x3e5d4b1a3e78cfcc,0x3e25c58c3e419b37,0x3d8a200a3dc8bd36,0x3bc90f883d16c32c,0xbda973babd48fb30,0xbe195be0bdee3876
.quad 0xbe6c9a7fbe47c5c2,0xbe9aa086be888e93,0xbebf926fbeac7cd4,0xbee4cbfebed25a09,0xbf0242b1bef15aea,0xbf14b039bf0b9a6b,0xbf21cbfbbf187fc0,0xbf33587abf2ac082
.quad 0xbf3daef9bf3504f3,0xbf4d9f02bf45e403,0xbf554aa4bf4d9f02,0xbf62df7bbf5c61c7,0xbf6816a8bf61c598,0xbf7294f8bf6db293,0xbf75a67bbf710908,0xbf7c5d3abf796e4e
.quad 0xbf7dabccbf7b14be,0xbf7ffb11bf7f4e6d,0xbf7ff84abf7fb10f,0xbf7d57debf7f2f9d,0xbf7c7eb0bf7ec46d,0xbf748422bf791298,0xbf73530ebf7853f8,0xbf65b710bf6d1c1d
.quad 0xbf64aa59bf6c835e,0xbf514d3dbf5b941a,0xbf50d937bf5b941a,0xbf37c655bf44e3f5,0xbf385216bf45e403,0xbf19c200bf299415,0xbf1ba299bf2beb4a,0xbeeff7fbbf0a48ad
.quad 0xbef6e0cbbf0e39da,0xbea68f12becf7bca,0xbeb0eacbbedae880,0xbe3228d4be8586ce,0xbe4dee60be94a031,0xbc96c9b6bde1bc2e,0xbd55880ebe164083,0x3e0cec4a3d2fe007
.quad 0x3f8000003f800000,0x3f8000003f800000,0x3f7c9f8a3f7cbfc9,0x3f7c5d3a3f7c7eb0,0x3f7294f83f731447,0x3f718f573f721352,0x3f62241a3f633c5a,0x3f5fe4e93f6106f2
.quad 0x3f4bbbf83f4d9f02,0x3f47de653f49d112,0x3f2ff3e63f32c8c9,0x3f2a2a803f2d1469,0x3f0f87843f13682a,0x3f07a1363f0b9a6b,0x3ed6a3993ee0924f,0x3ec27b553ecc9b8b
.quad 0x3e888e933e94a031,0x3e605c133e78cfcc,0x3ddb7d373e09cf86,0x3d55880e3da3308c,0xbd621469bcc90ab0,0xbdee3876bdafb680,0xbe5d4b1abe3b6ecf,0xbe901c2cbe7ee6e1
.quad 0xbebe1d4abeac7cd4,0xbee0924fbecf7bca,0xbf044889bef6e0cb,0xbf1553b7bf0cead0,0xbf26050abf1d7fd1,0xbf36206cbf2e3bde,0xbf436051bf3b8f3b,0xbf51c0c2bf4ac77f
.quad 0xbf5b941abf54db31,0xbf676bd8bf61c598,0xbf6dfcf2bf68bf3c,0xbf76841bbf7294f8,0xbf7a1e84bf76ba07,0xbf7e9bc9bf7cbfc9,0xbf7fa6e3bf7e70b0,0xbf7f7808bf7ffec4
.quad 0xbf7e70b0bf7fb10f,0xbf791298bf7c3b28,0xbf76841bbf7a7302,0xbf6b99fbbf718f57,0xbf6816a8bf6ed89e,0xbf577026bf604621,0xbf5389c7bf5d2d53,0xbf3d27b8bf48d8b3
.quad 0xbf396842bf45e403,0xbf1d7fd1bf2beb4a,0xbf1a6293bf299415,0xbef2bd43bf0a48ad,0xbeee9479bf08f59b,0xbea395c5bec9b953,0xbea21887bec9b953,0xbe1f917bbe72b651
.quad 0xbe22abb6be78cfcc,0x3c490e90bd96a905,0x3b490fc6bdafb680,0x3e3857ec3dbc3ac3,0x3e28defc3d96a905,0x3eaf713a3e827dc0,0x3ea5129f3e6c9a7f,0x3efdbabb3ed25a09
.quad 0x8000000080000000,0x8000000080000000,0xbe195be0be164083,0xbe1f917bbe1c76de,0xbe97a117be94a031,0xbe9d9e78be9aa086,0xbedf28a9bedae880,0xbee79a5dbee363fa
.quad 0xbf10d3cdbf0e39da,0xbf15f6d9bf13682a,0xbf2ecef7bf2beb4a,0xbf34768fbf31a81d,0xbf48d8b3bf45e403,0xbf4e8d90bf4bbbf8,0xbf5e5aa6bf5b941a,0xbf6398acbf6106f2
.quad 0xbf6ed89ebf6c835e,0xbf731447bf710908,0xbf79f35ebf7853f8,0xbf7c9f8abf7b61fc,0xbf7f6ac7bf7ec46d,0xbf7ffec4bf7fd397,0xbf7f1f49bf7fb10f,0xbf7d1cddbf7e4323
.quad 0xbf791298bf7b14be,0xbf740bddbf76ba07,0xbf6d67a1bf710908,0xbf650479bf696591,0xbf5c61c7bf61c598,0xbf5064afbf5695e5,0xbf466354bf4d9f02,0xbf36ad7fbf3ebc1b
.quad 0xbf2beb4abf3504f3,0xbf187fc0bf226799,0xbf0d9281bf187fc0,0xbeed3063bf0242b1,0xbed8106bbef15aea,0xbea395c5bebe1d4a,0xbe901c2cbeac7cd4,0xbe2bf804be667c66
.quad 0xbe09cf86be47c5c2,0xbc490e90bd96a905,0x3c7b514bbd48fb30,0x3e1324ca3da3308c,0x3e28defc3dc8bd36,0x3e97a1173e6c9a7f,0x3e9f1cdf3e78cfcc,0x3ee1fb6a3ec1071e
.quad 0x3ee633753ec3ef15,0x3f13682a3f039c3d,0x3f140c5f3f039c3d,0x3f3238aa3f239da9,0x3f31a81d3f226799,0x3f4cae793f3fc767,0x3f4b41fa3f3daef9,0x3f62241a3f577026
.quad 0x3f6046213f54db31,0x3f7213523f6a09a7,0x3f703b373f676bd8,0x3f7c187a3f772417,0x3f7ac5163f74fa0b,0x3f7ff4e63f7e70b0,0x3f7fa6e33f7d3aac,0x3f7d906e3f7fc38f
.quad 0x8000000080000000,0x8000000080000000,0xbe25c58cbe22abb6,0xbe2bf804be28defc,0xbea395c5bea09ae5,0xbea986c4bea68f12,0xbeeff7fbbeebcbbb,0xbef840c8bef41f07
.quad 0xbf1b02c6bf187fc0,0xbf1ff6cbbf1d7fd1,0xbf39f2acbf373a23,0xbf3f41fcbf3ca003,0xbf53fac3bf514d3d,0xbf591e6abf5695e5,0xbf686b39bf660f88,0xbf6cd007bf6aab7b
.quad 0xbf76ba07bf74fa0b,0xbf79c79dbf7853f8,0xbf7e868bbf7dabcc,0xbf7fa6e3bf7f2f9d,0xbf7f9c18bf7fec43,0xbf7e4323bf7f0e58,0xbf79f35ebf7baccd,0xbf75a67bbf77f110
.quad 0xbf6db293bf710908,0xbf660f88bf6a09a7,0xbf5b2c79bf604621,0xbf4fefa8bf55b993,0xbf42de29bf49d112,0xbf33e7bcbf3b8f3b,0xbf256bcbbf2e3bde,0xbf12c39abf1c420c
.quad 0xbf039c3dbf0e39da,0xbedae880bef15aea,0xbebca7afbed53641,0xbe8a11f7bea395c5,0xbe5a3997be888e93,0xbdd53db9be22abb6,0xbd55880ebde1bc2e,0x3d83db0a3bc90f88
.quad 0x3de1bc2e3d48fb30,0x3e6c9a7f3e2f10a2,0x3e8a11f73e541501,0x3ec8477c3ea986c4,0x3ed8106b3eb8442a,0x3f0a48ad3ef6e0cb,0x3f102dd53f00e7e4,0x3f2c800f3f1ebc12
.quad 0x3f3085bb3f226799,0x3f49d1123f3daef9,0x3f4c35783f3fc767,0x3f61668a3f577026,0x3f6282103f584853,0x3f7294f83f6b4b0c,0x3f72d4eb3f6b4b0c,0x3f7cdf6c3f78b47b
.quad 0x3f7cbfc93f7853f8,0x3f7ffb113f7f4e6d,0x3f7fffb13f7f0e58,0x3f7bd14d3f7eea9d,0x3f7c7eb03f7f4e6d,0x3f7080663f778bc5,0x3f7254703f791298,0x3f5e5aa63f696591
.quad 0x3f8000003f800000,0x3f8000003f800000,0x3f7c187a3f7c3b28,0x3f7bd14d3f7bf531,0x3f7080663f710908,0x3f6f68303f6ff573,0x3f5d924d3f5ebe05,0x3f5b2c793f5c61c7
.quad 0x3f43e2003f45e403,0x3f3fc7673f41d870,0x3f24381a3f273656,0x3f1e1e223f212ff9,0x3eff17b23f039c3d,0x3eee94793ef6e0cb,0x3eadf73c3eb8442a,0x3e9920fe3ea395c5
.quad 0x3e2f10a23e47c5c2,0x3dfab2733e164083,0xbb490fc63cc90ab0,0xbd6ea038bcfb49ba,0xbe354098be164083,0xbe72b651be541501,0xbeb0eacbbea09ae5,0xbed0eb2abec1071e
.quad 0xbf00e7e4bef15aea,0xbf10d3cdbf08f59b,0xbf256bcbbf1d7fd1,0xbf34768fbf2d1469,0xbf44e3f5bf3daef9,0xbf5233c6bf4bbbf8,0xbf5e5aa6bf584853,0xbf6912aebf63f473
.quad 0xbf710908bf6c835e,0xbf7853f8bf74fa0b,0xbf7c5d3abf79c79d,0xbf7f7808bf7e4323,0xbf7ffec4bf7fb10f,0xbf7e4323bf7f84ab,0xbf7bd14dbf7e1324,0xbf74bf62bf78b47b
.quad 0xbf6ff573bf74fa0b,0xbf633c5abf6a09a7,0xbf5cc7d1bf64aa59,0xbf4a4c87bf53fac3,0xbf42de29bf4d9f02,0xbf2ac082bf373a23,0xbf2302d3bf3085bb,0xbf05a02cbf14b039
.quad 0xbefc5d27bf0e39da,0xbeb8442abedae880,0xbeab0201becf7bca,0xbe3e853ebe8586ce,0xbe28defcbe78cfcc,0xbbc90f88bdafb680,0x3c16cb58bd96a905,0x3e3228d43dbc3ac3
.quad 0x3e3b6ecf3dc8bd36,0x3eb263ef3e888e93,0x3eb3dca53e888e93,0x3f02ef9f3eddbe79,0x3f0242b13edae880,0x3f2866053f15f6d9,0x3f269de33f13682a,0x3f485bca3f385216
.quad 0x3f8000003f800000,0x3f8000003f800000,0x3f7b87b23f7baccd,0x3f7b3bab3f7b61fc,0x3f6e46be3f6ed89e,0x3f6d1c1d3f6db293,0x3f58b3a13f59f26a,0x3f5627fe3f577026
.quad 0x3f3b8f3b3f3daef9,0x3f373a233f396842,0x3f17de123f1b02c6,0x3f11796b3f14b039,0x3eddbe793ee63375,0x3ecc9b8b3ed53641,0x3e8402703e8e9a22,0x3e5d4b1a3e72b651
.quad 0x3d96a9053dc8bd36,0x3cc90ab03d48fb30,0xbde7fa9abdafb680,0xbe2bf804be1008b7,0xbe97a117be888e93,0xbeb554ecbea68f12,0xbeeff7fbbee0924f,0xbf06f686beff17b2
.quad 0xbf1ff6cbbf187fc0,0xbf2e3bdebf273656,0xbf425b89bf3b8f3b,0xbf4f0417bf48d8b3,0xbf5df6bebf584853,0xbf6816a8bf633c5a,0xbf71d19fbf6db293,0xbf788486bf756d97
.quad 0xbf7d3aacbf7b14be,0xbf7fb10fbf7ec46d,0xbf7fcbe2bf7ffb11,0xbf7d57debf7eea9d,0xbf796e4ebf7c3b28,0xbf718f57bf75dec6,0xbf6a5ad9bf6ff573,0xbf5cc7d1bf63f473
.quad 0xbf531849bf5b941a,0xbf3fc767bf49d112,0xbf34768fbf3fc767,0xbf1ba299bf286605,0xbf0f8784bf1d7fd1,0xbee363fabf00e7e4,0xbecb2aaebeebcbbb,0xbe870adabea986c4
.quad 0xbe605c13be94a031,0xbd96a905be164083,0xbd0a342fbde1bc2e,0x3df475c03d2fe007,0x3e1c76de3d96a905,0x3e9d9e783e6c9a7f,0x3eab02013e827dc0,0x3ef840c83ed25a09
.quad 0x3f00e7e43edae880,0x3f24d2253f13682a,0x3f27ce613f15f6d9,0x3f4760853f385216,0x3f48d8b33f396842,0x3f6282103f5695e5,0x3f62df7b3f5695e5,0x3f75341d3f6d1c1d
.quad 0x8000000080000000,0x8000000080000000,0xbe3228d4be2f10a2,0xbe3857ecbe354098,0xbeaf713abeac7cd4,0xbeb554ecbeb263ef,0xbf003a06befc5d27,0xbf044889bf0242b1
.quad 0xbf24d225bf226799,0xbf299415bf273656,0xbf446337bf41d870,0xbf495521bf46e22a,0xbf5df6bebf5b941a,0xbf628210bf604621,0xbf70c501bf6ed89e,0xbf74484bbf7294f8
.quad 0xbf7c3b28bf7b14be,0xbf7e1324bf7d3aac,0xbf7fffb1bf7fec43,0xbf7f90b1bf7fe129,0xbf7bf531bf7d3aac,0xbf78b47bbf7a7302,0xbf703b37bf731447,0xbf69b7e4bf6d1c1d
.quad 0xbf5d2d53bf61c598,0xbf531849bf584853,0xbf436051bf49d112,0xbf3592e7bf3ca003,0xbf239da9bf2beb4a,0xbf121eb0bf1b02c6,0xbefdbabbbf08f59b,0xbed3c867bee900b7
.quad 0xbeac7cd4bec3ef15,0xbe78cfccbe94a031,0xbe2bf804be605c13,0xbd83db0abdee3876,0x3bc90f88bd48fb30,0x3dee38763d7b2b74,0x3e3857ec3dfab273,0x3e9620d23e72b651
.quad 0x3eb263ef3e94a031,0x3eebcbbb3ecf7bca,0x3f0195733ee63375,0x3f1ce11f3f0f8784,0x3f26050a3f187fc0,0x3f3ebc1b3f32c8c9,0x3f4564393f396842,0x3f5a5ba03f5064af
.quad 0x3f5ebe053f54db31,0x3f6ed89e3f676bd8,0x3f714c7a3f6a09a7,0x3f7b87b23f772417,0x3f7c7eb03f7853f8,0x3f7ffec43f7f0e58,0x3f7ffd393f7f4e6d,0x3f7c187a3f7eea9d
.quad 0x3f7baccd3f7ec46d,0x3f6ff5733f76ba07,0x3f6faf1b3f76ba07,0x3f5bfb343f66becc,0x3f5c61c73f676bd8,0x3f40d0da3f4f7a1f,0x3f425b893f514d3d,0x3f1f599f3f31a81d
.quad 0x8000000080000000,0x8000000080000000,0xbe3e853ebe3b6ecf,0xbe44b0b9be419b37,0xbebb31a0beb8442a,0xbec1071ebebe1d4a,0xbf084b92bf064b82,0xbf0c42c9bf0a48ad
.quad 0xbf2e3bdebf2beb4a,0xbf32c8c9bf3085bb,0xbf4e1689bf4bbbf8,0xbf52a649bf5064af,0xbf66beccbf64aa59,0xbf6aab7bbf68bf3c,0xbf77583abf75dec6,0xbf79f35ebf78b47b
.quad 0xbf7f4e6dbf7ec46d,0xbf7fec43bf7fb10f,0xbf7e5a38bf7f0e58,0xbf7c5d3abf7d7474,0xbf748422bf76ba07,0xbf6f6830bf721352,0xbf62241abf660f88,0xbf5988adbf5df6be
.quad 0xbf47de65bf4d9f02,0xbf3b8f3bbf41d870,0xbf269de3bf2e3bde,0xbf16999fbf1ebc12,0xbeff17b2bf08f59b,0xbed8106bbeebcbbb,0xbea80b1fbebe1d4a,0xbe75c35abe919ddd
.quad 0xbe164083be47c5c2,0xbd48fb30bdc8bd36,0x3d2351cbbc490e90,0x3e1324ca3dbc3ac3,0x3e667c663e2f10a2,0x3ea986c43e8e9a22,0x3ece0bea3eb263ef,0x3f0195733ee900b7
.quad 0x3f10d3cd3f039c3d,0x3f2994153f1d7fd1,0x3f3592e73f299415,0x3f4b41fa3f40d0da,0x3f53fac33f49d112,0x3f655e0b3f5d2d53,0x3f6afb8c3f633c5a,0x3f76ef5b3f718f57
.quad 0x3f79c79d3f74fa0b,0x3f7f4e6d3f7d3aac,0x3f7fdaaf3f7e70b0,0x3f7e2b723f7fc38f,0x3f7cfe733f7f4e6d,0x3f73913f3f791298,0x3f714c7a3f778bc5,0x3f5fe4e93f696591
.quad 0x3f5d2d533f676bd8,0x3f43e2003f514d3d,0x3f4154e13f4f7a1f,0x3f2093933f31a81d,0x3f1ebc123f3085bb,0x3eee94793f0b9a6b,0x3eed30633f0b9a6b,0x3e931f353ec1071e
.quad 0x3f8000003f800000,0x3f8000003f800000,0x3f7fffb13f800000,0x3f7ffd393f7ffec4,0x3f7ffec43f800000,0x3f7ff4e63f7ffb11,0x3f7ffd393f800000,0x3f7fe7053f7ff4e6
.quad 0x3f7ffb113f800000,0x3f7fd3973f7fec43,0x3f7ff84a3f800000,0x3f7fba9e3f7fe129,0x3f7ff4e63f800000,0x3f7f9c183f7fd397,0x3f7ff0e33f800000,0x3f7f78083f7fc38f
.quad 0x3f7fec433f800000,0x3f7f4e6d3f7fb10f,0x3f7fe7053f800000,0x3f7f1f493f7f9c18,0x3f7fe1293f800000,0x3f7eea9d3f7f84ab,0x3f7fdaaf3f800000,0x3f7eb0693f7f6ac7
.quad 0x3f7fd3973f800000,0x3f7e70b03f7f4e6d,0x3f7fcbe23f800000,0x3f7e2b723f7f2f9d,0x3f7fc38f3f800000,0x3f7de0b13f7f0e58,0x3f7fba9e3f800000,0x3f7d906e3f7eea9d
.quad 0x3f7fb10f3f800000,0x3f7d3aac3f7ec46d,0x3f7fa6e33f800000,0x3f7cdf6c3f7e9bc9,0x3f7f9c183f800000,0x3f7c7eb03f7e70b0,0x3f7f90b13f800000,0x3f7c187a3f7e4323
.quad 0x3f7f84ab3f800000,0x3f7baccd3f7e1324,0x3f7f78083f800000,0x3f7b3bab3f7de0b1,0x3f7f6ac73f800000,0x3f7ac5163f7dabcc,0x3f7f5ce93f800000,0x3f7a49103f7d7474
.quad 0x3f7f4e6d3f800000,0x3f79c79d3f7d3aac,0x3f7f3f543f800000,0x3f7940c03f7cfe73,0x3f7f2f9d3f800000,0x3f78b47b3f7cbfc9,0x3f7f1f493f800000,0x3f7822d13f7c7eb0
.quad 0x3f7f0e583f800000,0x3f778bc53f7c3b28,0x3f7efcc93f800000,0x3f76ef5b3f7bf531,0x3f7eea9d3f800000,0x3f764d973f7baccd,0x3f7ed7d43f800000,0x3f75a67b3f7b61fc
.quad 0x3f8000003f800000,0x3f8000003f800000,0x3f7ff84a3f7ffb11,0x3f7ff0e33f7ff4e6,0x3f7fe1293f7fec43,0x3f7fc38f3f7fd397,0x3f7fba9e3f7fd397,0x3f7f78083f7f9c18
.quad 0x3f7f84ab3f7fb10f,0x3f7f0e583f7f4e6d,0x3f7f3f543f7f84ab,0x3f7e868b3f7eea9d,0x3f7eea9d3f7f4e6d,0x3f7de0b13f7e70b0,0x3f7e868b3f7f0e58,0x3f7d1cdd3f7de0b1
.quad 0x3f7e13243f7ec46d,0x3f7c3b283f7d3aac,0x3f7d906e3f7e70b0,0x3f7b3bab3f7c7eb0,0x3f7cfe733f7e1324,0x3f7a1e843f7baccd,0x3f7c5d3a3f7dabcc,0x3f78e3d63f7ac516
.quad 0x3f7baccd3f7d3aac,0x3f778bc53f79c79d,0x3f7aed373f7cbfc9,0x3f76167a3f78b47b,0x3f7a1e843f7c3b28,0x3f7484223f778bc5,0x3f7940c03f7baccd,0x3f72d4eb3f764d97
.quad 0x3f7853f83f7b14be,0x3f7109083f74fa0b,0x3f77583a3f7a7302,0x3f6f20b03f73913f,0x3f764d973f79c79d,0x3f6d1c1d3f721352,0x3f75341d3f791298,0x3f6afb8c3f708066
.quad 0x3f740bdd3f7853f8,0x3f68bf3c3f6ed89e,0x3f72d4eb3f778bc5,0x3f6667713f6d1c1d,0x3f718f573f76ba07,0x3f63f4733f6b4b0c,0x3f703b373f75dec6,0x3f61668a3f696591
.quad 0x3f6ed89e3f74fa0b,0x3f5ebe053f676bd8,0x3f6d67a13f740bdd,0x3f5bfb343f655e0b,0x3f6be8583f731447,0x3f591e6a3f633c5a,0x3f6a5ad93f721352,0x3f5627fe3f6106f2
.quad 0x3f68bf3c3f710908,0x3f5318493f5ebe05,0x3f6715993f6ff573,0x3f4fefa83f5c61c7,0x3f655e0b3f6ed89e,0x3f4cae793f59f26a,0x3f6398ac3f6db293,0x3f4955213f577026
.quad 0x0,0x0,0x3b490fc600000000,0x3c16cb583bc90f88,0x3bc90f8800000000,0x3c96c9b63c490e90,0x3c16cb5800000000,0x3ce22a7a3c96c9b6
.quad 0x3c490e9000000000,0x3d16c32c3cc90ab0,0x3c7b514b00000000,0x3d3c6dd53cfb49ba,0x3c96c9b600000000,0x3d6214693d16c32c,0x3cafea6900000000,0x3d83db0a3d2fe007
.quad 0x3cc90ab000000000,0x3d96a9053d48fb30,0x3ce22a7a00000000,0x3da973ba3d621469,0x3cfb49ba00000000,0x3dbc3ac33d7b2b74,0x3d0a342f00000000,0x3dcefdb73d8a200a
.quad 0x3d16c32c00000000,0x3de1bc2e3d96a905,0x3d2351cb00000000,0x3df475c03da3308c,0x3d2fe00700000000,0x3e0395023dafb680,0x3d3c6dd500000000,0x3e0cec4a3dbc3ac3
.quad 0x3d48fb3000000000,0x3e1640833dc8bd36,0x3d55880e00000000,0x3e1f917b3dd53db9,0x3d62146900000000,0x3e28defc3de1bc2e,0x3d6ea03800000000,0x3e3228d43dee3876
.quad 0x3d7b2b7400000000,0x3e3b6ecf3dfab273,0x3d83db0a00000000,0x3e44b0b93e039502,0x3d8a200a00000000,0x3e4dee603e09cf86,0x3d9064b400000000,0x3e57278f3e1008b7
.quad 0x3d96a90500000000,0x3e605c133e164083,0x3d9cecf900000000,0x3e698bba3e1c76de,0x3da3308c00000000,0x3e72b6513e22abb6,0x3da973ba00000000,0x3e7bdba43e28defc
.quad 0x3dafb68000000000,0x3e827dc03e2f10a2,0x3db5f8da00000000,0x3e870ada3e354098,0x3dbc3ac300000000,0x3e8b95073e3b6ecf,0x3dc27c3900000000,0x3e901c2c3e419b37
.quad 0x0,0x0,0x3c7b514b3c490e90,0x3cafea693c96c9b6,0x3cfb49ba3cc90ab0,0x3d2fe0073d16c32c,0x3d3c6dd53d16c32c,0x3d83db0a3d621469
.quad 0x3d7b2b743d48fb30,0x3dafb6803d96a905,0x3d9cecf93d7b2b74,0x3ddb7d373dbc3ac3,0x3dbc3ac33d96a905,0x3e0395023de1bc2e,0x3ddb7d373dafb680,0x3e195be03e039502
.quad 0x3dfab2733dc8bd36,0x3e2f10a23e164083,0x3e0cec4a3de1bc2e,0x3e44b0b93e28defc,0x3e1c76de3dfab273,0x3e5a39973e3b6ecf,0x3e2bf8043e09cf86,0x3e6fa8b23e4dee60
.quad 0x3e3b6ecf3e164083,0x3e827dc03e605c13,0x3e4ada4f3e22abb6,0x3e8d17c03e72b651,0x3e5a39973e2f10a2,0x3e97a1173e827dc0,0x3e698bba3e3b6ecf,0x3ea218873e8b9507
.quad 0x3e78cfcc3e47c5c2,0x3eac7cd43e94a031,0x3e8402703e541501,0x3eb6ccc33e9d9e78,0x3e8b95073e605c13,0x3ec1071e3ea68f12,0x3e931f353e6c9a7f,0x3ecb2aae3eaf713a
.quad 0x3e9aa0863e78cfcc,0x3ed536413eb8442a,0x3ea218873e827dc0,0x3edf28a93ec1071e,0x3ea986c43e888e93,0x3ee900b73ec9b953,0x3eb0eacb3e8e9a22,0x3ef2bd433ed25a09
.quad 0x3eb8442a3e94a031,0x3efc5d273edae880,0x3ebf926f3e9aa086,0x3f02ef9f3ee363fa,0x3ec6d5293ea09ae5,0x3f07a1363eebcbbb,0x3ece0bea3ea68f12,0x3f0c42c93ef41f07
.quad 0x3ed536413eac7cd4,0x3f10d3cd3efc5d27,0x3edc53c13eb263ef,0x3f1553b73f0242b1,0x3ee363fa3eb8442a,0x3f19c2003f064b82,0x3eea66813ebe1d4a,0x3f1e1e223f0a48ad
.quad 0x3f8000003f800000,0x3f8000003f800000,0x3f7fe7053f7fec43,0x3f7fdaaf3f7fe129,0x3f7f9c183f7fb10f,0x3f7f6ac73f7f84ab,0x3f7f1f493f7f4e6d,0x3f7eb0693f7eea9d
.quad 0x3f7e70b03f7ec46d,0x3f7dabcc3f7e1324,0x3f7d906e3f7e1324,0x3f7c5d3a3f7cfe73,0x3f7c7eb03f7d3aac,0x3f7ac5163f7baccd,0x3f7b3bab3f7c3b28,0x3f78e3d63f7a1e84
.quad 0x3f79c79d3f7b14be,0x3f76ba073f7853f8,0x3f7822d13f79c79d,0x3f74484b3f764d97,0x3f764d973f7853f8,0x3f718f573f740bdd,0x3f74484b3f76ba07,0x3f6e8ff83f718f57
.quad 0x3f7213523f74fa0b,0x3f6b4b0c3f6ed89e,0x3f6faf1b3f731447,0x3f67c1873f6be858,0x3f6d1c1d3f710908,0x3f63f4733f68bf3c,0x3f6a5ad93f6ed89e,0x3f5fe4e93f655e0b
.quad 0x3f676bd83f6c835e,0x3f5b941a3f61c598,0x3f644fac3f6a09a7,0x3f5703483f5df6be,0x3f6106f23f676bd8,0x3f5233c63f59f26a,0x3f5d924d3f64aa59,0x3f4d26fd3f55b993
.quad 0x3f59f26a3f61c598,0x3f47de653f514d3d,0x3f5627fe3f5ebe05,0x3f425b893f4cae79,0x3f5233c63f5b941a,0x3f3ca0033f47de65,0x3f4e16893f584853,0x3f36ad7f3f42de29
.quad 0x3f49d1123f54db31,0x3f3085bb3f3daef9,0x3f4564393f514d3d,0x3f2a2a803f385216,0x3f40d0da3f4d9f02,0x3f239da93f32c8c9,0x3f3c17d93f49d112,0x3f1ce11f3f2d1469
.quad 0x3f373a233f45e403,0x3f15f6d93f273656,0x3f3238aa3f41d870,0x3f0ee0db3f212ff9,0x3f2d14693f3daef9,0x3f07a1363f1b02c6,0x3f27ce613f396842,0x3f003a063f14b039
.quad 0x3f8000003f800000,0x3f8000003f800000,0x3f7fcbe23f7fd397,0x3f7fba9e3f7fc38f,0x3f7f2f9d3f7f4e6d,0x3f7eea9d3f7f0e58,0x3f7e2b723f7e70b0,0x3f7d906e3f7de0b1
.quad 0x3f7cbfc93f7d3aac,0x3f7baccd3f7c3b28,0x3f7aed373f7baccd,0x3f7940c03f7a1e84,0x3f78b47b3f79c79d,0x3f764d973f778bc5,0x3f76167a3f778bc5,0x3f72d4eb3f748422
.quad 0x3f7314473f74fa0b,0x3f6ed89e3f710908,0x3f6faf1b3f721352,0x3f6a5ad93f6d1c1d,0x3f6be8583f6ed89e,0x3f655e0b3f68bf3c,0x3f67c1873f6b4b0c,0x3f5fe4e93f63f473
.quad 0x3f633c5a3f676bd8,0x3f59f26a3f5ebe05,0x3f5e5aa63f633c5a,0x3f5389c73f591e6a,0x3f591e6a3f5ebe05,0x3f4cae793f531849,0x3f5389c73f59f26a,0x3f4564393f4cae79
.quad 0x3f4d9f023f54db31,0x3f3daef93f45e403,0x3f4760853f4f7a1f,0x3f3592e73f3ebc1b,0x3f40d0da3f49d112,0x3f2d14693f373a23,0x3f39f2ac3f43e200,0x3f24381a3f2f61a5
.quad 0x3f32c8c93f3daef9,0x3f1b02c63f273656,0x3f2b561b3f373a23,0x3f11796b3f1ebc12,0x3f239da93f3085bb,0x3f07a1363f15f6d9,0x3f1ba2993f299415,0x3efafef73f0cead0
.quad 0x3f13682a3f226799,0x3ee633753f039c3d,0x3f0af1b73f1b02c6,0x3ed0eb2a3ef41f07,0x3f0242b13f13682a,0x3ebb31a03ee0924f,0x3ef2bd433f0b9a6b,0x3ea5129f3ecc9b8b
.quad 0x3ee0924f3f039c3d,0x3e8e9a223eb8442a,0x3ece0bea3ef6e0cb,0x3e6fa8b23ea395c5,0x3ebb31a03ee63375,0x3e419b373e8e9a22,0x3ea80b1f3ed53641,0x3e1324ca3e72b651
.quad 0x0,0x0,0x3ce22a7a3cc90ab0,0x3d0a342f3cfb49ba,0x3d6214693d48fb30,0x3d8a200a3d7b2b74,0x3da973ba3d96a905,0x3dcefdb73dbc3ac3
.quad 0x3de1bc2e3dc8bd36,0x3e09cf863dfab273,0x3e0cec4a3dfab273,0x3e2bf8043e1c76de,0x3e28defc3e164083,0x3e4dee603e3b6ecf,0x3e44b0b93e2f10a2,0x3e6fa8b23e5a3997
.quad 0x3e605c133e47c5c2,0x3e888e933e78cfcc,0x3e7bdba43e605c13,0x3e9920fe3e8b9507,0x3e8b95073e78cfcc,0x3ea986c43e9aa086,0x3e9920fe3e888e93,0x3eb9bb1e3ea986c4
.quad 0x3ea68f123e94a031,0x3ec9b9533eb8442a,0x3eb3dca53ea09ae5,0x3ed97cb93ec6d529,0x3ec1071e3eac7cd4,0x3ee900b73ed53641,0x3ece0bea3eb8442a,0x3ef840c83ee363fa
.quad 0x3edae8803ec3ef15,0x3f039c3d3ef15aea,0x3ee79a5d3ecf7bca,0x3f0af1b73eff17b2,0x3ef41f073edae880,0x3f121eb03f064b82,0x3f003a063ee63375,0x3f19210f3f0cead0
.quad 0x3f064b823ef15aea,0x3f1ff6cb3f13682a,0x3f0c42c93efc5d27,0x3f269de33f19c200,0x3f121eb03f039c3d,0x3f2d14693f1ff6cb,0x3f17de123f08f59b,0x3f33587a3f26050a
.quad 0x3f1d7fd13f0e39da,0x3f3968423f2beb4a,0x3f2302d33f13682a,0x3f3f41fc3f31a81d,0x3f2866053f187fc0,0x3f44e3f53f373a23,0x3f2da8593f1d7fd1,0x3f4a4c873f3ca003
.quad 0x3f32c8c93f226799,0x3f4f7a1f3f41d870,0x3f37c6553f273656,0x3f546b3b3f46e22a,0x3f3ca0033f2beb4a,0x3f591e6a3f4bbbf8,0x3f4154e13f3085bb,0x3f5d924d3f5064af
.quad 0x0,0x0,0x3d2351cb3d16c32c,0x3d3c6dd53d2fe007,0x3da3308c3d96a905,0x3dbc3ac33dafb680,0x3df475c03de1bc2e,0x3e0cec4a3e039502
.quad 0x3e22abb63e164083,0x3e3b6ecf3e2f10a2,0x3e4ada4f3e3b6ecf,0x3e698bba3e5a3997,0x3e72b6513e605c13,0x3e8b95073e827dc0,0x3e8d17c03e827dc0,0x3ea218873e97a117
.quad 0x3ea09ae53e94a031,0x3eb8442a3eac7cd4,0x3eb3dca53ea68f12,0x3ece0bea3ec1071e,0x3ec6d5293eb8442a,0x3ee363fa3ed53641,0x3ed97cb93ec9b953,0x3ef840c83ee900b7
.quad 0x3eebcbbb3edae880,0x3f064b823efc5d27,0x3efdbabb3eebcbbb,0x3f102dd53f07a136,0x3f07a1363efc5d27,0x3f19c2003f10d3cd,0x3f102dd53f064b82,0x3f2302d33f19c200
.quad 0x3f187fc03f0e39da,0x3f2beb4a3f226799,0x3f2093933f15f6d9,0x3f34768f3f2ac082,0x3f2866053f1d7fd1,0x3f3ca0033f32c8c9,0x3f2ff3e63f24d225,0x3f4463373f3a7ca4
.quad 0x3f373a233f2beb4a,0x3f4bbbf83f41d870,0x3f3e35c53f32c8c9,0x3f52a6493f48d8b3,0x3f44e3f53f396842,0x3f591e6a3f4f7a1f,0x3f4b41fa3f3fc767,0x3f5f20db3f55b993
.quad 0x3f514d3d3f45e403,0x3f64aa593f5b941a,0x3f5703483f4bbbf8,0x3f69b7e43f6106f2,0x3f5c61c73f514d3d,0x3f6e46be3f660f88,0x3f61668a3f5695e5,0x3f7254703f6aab7b
.quad 0x3f660f883f5b941a,0x3f75dec63f6ed89e,0x3f6a5ad93f604621,0x3f78e3d63f7294f8,0x3f6e46be3f64aa59,0x3f7b61fc3f75dec6,0x3f71d19f3f68bf3c,0x3f7d57de3f78b47b
.quad 0x3f8000003f800000,0x3f8000003f800000,0x3f7fa6e33f7fb10f,0x3f7f90b13f7f9c18,0x3f7e9bc93f7ec46d,0x3f7e43233f7e70b0,0x3f7cdf6c3f7d3aac,0x3f7c187a3f7c7eb0
.quad 0x3f7a73023f7b14be,0x3f7912983f79c79d,0x3f77583a3f7853f8,0x3f75341d3f764d97,0x3f73913f3f74fa0b,0x3f7080663f721352,0x3f6f20b03f710908,0x3f6afb8c3f6d1c1d
.quad 0x3f6a09a73f6c835e,0x3f64aa593f676bd8,0x3f644fac3f676bd8,0x3f5d924d3f6106f2,0x3f5df6be3f61c598,0x3f55b9933f59f26a,0x3f5703483f5b941a,0x3f4d26fd3f5233c6
.quad 0x3f4f7a1f3f54db31,0x3f43e2003f49d112,0x3f4760853f4d9f02,0x3f39f2ac3f40d0da,0x3f3ebc1b3f45e403,0x3f2f61a53f373a23,0x3f3592e73f3daef9,0x3f24381a3f2d1469
.quad 0x3f2beb4a3f3504f3,0x3f187fc03f226799,0x3f21cbfb3f2beb4a,0x3f0c42c93f173c07,0x3f173c073f226799,0x3eff17b23f0b9a6b,0x3f0c42c93f187fc0,0x3ee4cbfe3eff17b2
.quad 0x3f00e7e43f0e39da,0x3ec9b9533ee63375,0x3eea66813f039c3d,0x3eadf73c3ecc9b8b,0x3ed25a093ef15aea,0x3e919ddd3eb263ef,0x3eb9bb1e3edae880,0x3e698bba3e97a117
.quad 0x3ea09ae53ec3ef15,0x3e2f10a23e78cfcc,0x3e870ada3eac7cd4,0x3de7fa9a3e419b37,0x3e5a39973e94a031,0x3d6214693e09cf86,0x3e25c58c3e78cfcc,0xbb490fc63da3308c
.quad 0x3de1bc2e3e47c5c2,0xbd7b2b743cc90ab0,0x3d6ea0383e164083,0xbdf475c0bcfb49ba,0x3bc90f883dc8bd36,0xbe354098bdafb680,0xbd3c6dd53d48fb30,0xbe6fa8b2be1008b7
.quad 0x3f8000003f800000,0x3f8000003f800000,0x3f7f78083f7f84ab,0x3f7f5ce93f7f6ac7,0x3f7de0b13f7e1324,0x3f7d74743f7dabcc,0x3f7b3bab3f7baccd,0x3f7a49103f7ac516
.quad 0x3f778bc53f7853f8,0x3f75dec63f76ba07,0x3f72d4eb3f740bdd,0x3f703b373f718f57,0x3f6d1c1d3f6ed89e,0x3f6965913f6b4b0c,0x3f6667713f68bf3c,0x3f61668a3f63f473
.quad 0x3f5ebe053f61c598,0x3f5848533f5b941a,0x3f5627fe3f59f26a,0x3f4e16893f5233c6,0x3f4cae793f514d3d,0x3f42de293f47de65,0x3f425b893f47de65,0x3f36ad7f3f3ca003
.quad 0x3f373a233f3daef9,0x3f2994153f3085bb,0x3f2b561b3f32c8c9,0x3f1ba2993f239da9,0x3f1ebc123f273656,0x3f0cead03f15f6d9,0x3f11796b3f1b02c6,0x3efafef73f07a136
.quad 0x3f039c3d3f0e39da,0x3edae8803ef15aea,0x3eea66813f00e7e4,0x3eb9bb1e3ed25a09,0x3ecc9b8b3ee63375,0x3e97a1173eb263ef,0x3eadf73c3ec9b953,0x3e698bba3e919ddd
.quad 0x3e8e9a223eac7cd4,0x3e22abb63e605c13,0x3e5d4b1a3e8e9a22,0x3db5f8da3e1c76de,0x3e1c76de3e605c13,0x3c96c9b63dafb680,0x3db5f8da3e22abb6,0xbd55880e3c96c9b6
.quad 0x3cc90ab03dc8bd36,0xbdfab273bd48fb30,0xbd2351cb3d16c32c,0xbe44b0b9bdee3876,0xbdd53db9bcc90ab0,0xbe8586cebe3b6ecf,0xbe2bf804bdafb680,0xbea80b1fbe7ee6e1
.quad 0xbe6c9a7fbe164083,0xbec9b953bea09ae5,0xbe9620d2be541501,0xbeea6681bec1071e,0xbeb554ecbe888e93,0xbf04f484bee0924f,0xbed3c867bea68f12,0xbf140c5fbeff17b2
.quad 0x0,0x0,0x3d55880e3d48fb30,0x3d6ea0383d621469,0x3dd53db93dc8bd36,0x3dee38763de1bc2e,0x3e1f917b3e164083,0x3e3228d43e28defc
.quad 0x3e5415013e47c5c2,0x3e6c9a7f3e605c13,0x3e8402703e78cfcc,0x3e931f353e8b9507,0x3e9d9e783e94a031,0x3eaf713a3ea68f12,0x3eb6ccc33eac7cd4,0x3ecb2aae3ec1071e
.quad 0x3ecf7bca3ec3ef15,0x3ee633753edae880,0x3ee79a5d3edae880,0x3f003a063ef41f07,0x3eff17b23ef15aea,0x3f0cead03f064b82,0x3f0af1b73f039c3d,0x3f19210f3f121eb0
.quad 0x3f15f6d93f0e39da,0x3f24d2253f1d7fd1,0x3f2093933f187fc0,0x3f2ff3e63f286605,0x3f2ac0823f226799,0x3f3a7ca43f32c8c9,0x3f34768f3f2beb4a,0x3f4463373f3ca003
.quad 0x3f3daef93f3504f3,0x3f4d9f023f45e403,0x3f4663543f3daef9,0x3f5627fe3f4e8d90,0x3f4e8d903f45e403,0x3f5df6be3f5695e5,0x3f5627fe3f4d9f02,0x3f6504793f5df6be
.quad 0x3f5d2d533f54db31,0x3f6b4b0c3f64aa59,0x3f6398ac3f5b941a,0x3f70c5013f6aab7b,0x3f6965913f61c598,0x3f756d973f6ff573,0x3f6e8ff83f676bd8,0x3f7940c03f748422
.quad 0x3f7314473f6c835e,0x3f7c3b283f7853f8,0x3f76ef5b3f710908,0x3f7e5a383f7b61fc,0x3f7a1e843f74fa0b,0x3f7f9c183f7dabcc,0x3f7c9f8a3f7853f8,0x3f7fffb13f7f2f9d
.quad 0x3f7e70b03f7b14be,0x3f7f84ab3f7fec43,0x3f7f90b13f7d3aac,0x3f7e2b723f7fe129,0x3f7ffec43f7ec46d,0x3f7bf5313f7f0e58,0x3f7fba9e3f7fb10f,0x3f78e3d63f7d7474
.quad 0x0,0x0,0x3d83db0a3d7b2b74,0x3d9064b43d8a200a,0x3e0395023dfab273,0x3e1008b73e09cf86,0x3e44b0b93e3b6ecf,0x3e57278f3e4dee60
.quad 0x3e827dc03e78cfcc,0x3e8e9a223e888e93,0x3ea218873e9aa086,0x3eb0eacb3ea986c4,0x3ec1071e3eb8442a,0x3ed25a093ec9b953,0x3edf28a93ed53641,0x3ef2bd433ee900b7
.quad 0x3efc5d273ef15aea,0x3f08f59b3f039c3d,0x3f0c42c93f064b82,0x3f17de123f121eb0,0x3f19c2003f13682a,0x3f26050a3f1ff6cb,0x3f269de33f1ff6cb,0x3f33587a3f2d1469
.quad 0x3f32c8c93f2beb4a,0x3f3fc7673f396842,0x3f3e35c53f373a23,0x3f4b41fa3f44e3f5,0x3f48d8b33f41d870,0x3f55b9933f4f7a1f,0x3f52a6493f4bbbf8,0x3f5f20db3f591e6a
.quad 0x3f5b941a3f54db31,0x3f676bd83f61c598,0x3f6398ac3f5d2d53,0x3f6e8ff83f696591,0x3f6aab7b3f64aa59,0x3f7484223f6ff573,0x3f70c5013f6b4b0c,0x3f7940c03f756d97
.quad 0x3f75dec63f710908,0x3f7cbfc93f79c79d,0x3f79f35e3f75dec6,0x3f7efcc93f7cfe73,0x3f7cfe733f79c79d,0x3f7ff4e63f7f0e58,0x3f7efcc93f7cbfc9,0x3f7fa6e33f7ff4e6
.quad 0x3f7fec433f7ec46d,0x3f7e13243f7fb10f,0x3f7fcbe23f7fd397,0x3f7b3bab3f7e4323,0x3f7e9bc93f7fec43,0x3f7724173f7baccd,0x3f7c5d3a3f7f0e58,0x3f71d19f3f77f110
.quad 0x3f7912983f7d3aac,0x3f6b4b0c3f731447,0x3f74bf623f7a7302,0x3f6398ac3f6d1c1d,0x3f6f68303f76ba07,0x3f5ac4503f660f88,0x3f6912ae3f721352,0x3f50d9373f5df6be
.quad 0x3f8000003f800000,0x3f8000003f800000,0x3f7f3f543f7f4e6d,0x3f7f1f493f7f2f9d,0x3f7cfe733f7d3aac,0x3f7c7eb03f7cbfc9,0x3f7940c03f79c79d,0x3f7822d13f78b47b
.quad 0x3f740bdd3f74fa0b,0x3f7213523f731447,0x3f6d67a13f6ed89e,0x3f6a5ad93f6be858,0x3f655e0b3f676bd8,0x3f6106f23f633c5a,0x3f5bfb343f5ebe05,0x3f5627fe3f591e6a
.quad 0x3f514d3d3f54db31,0x3f49d1123f4d9f02,0x3f4564393f49d112,0x3f3c17d93f40d0da,0x3f3852163f3daef9,0x3f2d14693f32c8c9,0x3f2a2a803f3085bb,0x3f1ce11f3f239da9
.quad 0x3f1b02c63f226799,0x3f0b9a6b3f13682a,0x3f0af1b73f13682a,0x3ef2bd433f0242b1,0x3ef41f073f039c3d,0x3ecc9b8b3ee0924f,0x3ed0eb2a3ee63375,0x3ea5129f3ebb31a0
.quad 0x3eac7cd43ec3ef15,0x3e78cfcc3e94a031,0x3e870ada3ea09ae5,0x3e25c58c3e5a3997,0x3e419b373e78cfcc,0x3da3308c3e09cf86,0x3de7fa9a3e2f10a2,0xbb490fc63d621469
.quad 0x3d16c32c3dc8bd36,0xbdafb680bcc90ab0,0xbd2351cb3cc90ab0,0xbe2bf804bdd53db9,0xbdee3876bd48fb30,0xbe7ee6e1be3b6ecf,0xbe44b0b9bdfab273,0xbea80b1fbe8586ce
.quad 0xbe888e93be47c5c2,0xbecf7bcabeac7cd4,0xbeadf73cbe888e93,0xbef58035bed25a09,0xbed25a09beac7cd4,0xbf0cead0bef6e0cb,0xbef58035becf7bca,0xbf1e1e22bf0cead0
.quad 0xbf0b9a6bbef15aea,0xbf2e3bdebf1d7fd1,0xbf1ba299bf08f59b,0xbf3d27b8bf2d1469,0xbf2ac082bf187fc0,0xbf4ac77fbf3b8f3b,0xbf38dd65bf273656,0xbf570348bf48d8b3
.quad 0x3f8000003f800000,0x3f8000003f800000,0x3f7efcc93f7f0e58,0x3f7ed7d43f7eea9d,0x3f7bf5313f7c3b28,0x3f7b61fc3f7baccd,0x3f76ef5b3f778bc5,0x3f75a67b3f764d97
.quad 0x3f6ff5733f710908,0x3f6db2933f6ed89e,0x3f6715993f68bf3c,0x3f6398ac3f655e0b,0x3f5c61c73f5ebe05,0x3f5770263f59f26a,0x3f4fefa83f531849,0x3f4955213f4cae79
.quad 0x3f41d8703f45e403,0x3f3968423f3daef9,0x3f3238aa3f373a23,0x3f27ce613f2d1469,0x3f212ff93f273656,0x3f14b0393f1b02c6,0x3f0ee0db3f15f6d9,0x3f003a063f07a136
.quad 0x3ef6e0cb3f039c3d,0x3ed536413ee63375,0x3ece0bea3ee0924f,0x3ea80b1f3ebb31a0,0x3ea395c53eb8442a,0x3e72b6513e8e9a22,0x3e6fa8b23e8e9a22,0x3e1324ca3e419b37
.quad 0x3e1640833e47c5c2,0x3d48fb303dc8bd36,0x3d6ea0383de1bc2e,0xbd3c6dd53bc90f88,0xbcfb49ba3cc90ab0,0xbe1008b7bdafb680,0xbdf475c0bd7b2b74,0xbe6fa8b2be354098
.quad 0xbe541501be164083,0xbea68f12be888e93,0xbe9620d2be6c9a7f,0xbed3c867beb554ec,0xbec1071ebea09ae5,0xbeff17b2bee0924f,0xbeea6681bec9b953,0xbf140c5fbf04f484
.quad 0xbf08f59bbef15aea,0xbf273656bf187fc0,0xbf1ba299bf0b9a6b,0xbf38dd65bf2ac082,0xbf2d1469bf1d7fd1,0xbf48d8b3bf3b8f3b,0xbf3d27b8bf2e3bde,0xbf570348bf4ac77f
.quad 0xbf4bbbf8bf3daef9,0xbf633c5abf584853,0xbf58b3a1bf4bbbf8,0xbf6d67a1bf63f473,0xbf63f473bf584853,0xbf756d97bf6db293,0xbf6d67a1bf633c5a,0xbf7b3babbf756d97
.quad 0x0,0x0,0x3d9cecf93d96a905,0x3da973ba3da3308c,0x3e1c76de3e164083,0x3e28defc3e22abb6,0x3e698bba3e605c13,0x3e7bdba43e72b651
.quad 0x3e9aa0863e94a031,0x3ea68f123ea09ae5,0x3ebf926f3eb8442a,0x3ece0bea3ec6d529,0x3ee363fa3edae880,0x3ef41f073eebcbbb,0x3f02ef9f3efc5d27,0x3f0c42c93f07a136
.quad 0x3f13682a3f0e39da,0x3f1d7fd13f187fc0,0x3f2302d33f1d7fd1,0x3f2da8593f286605,0x3f31a81d3f2beb4a,0x3f3ca0033f373a23,0x3f3f41fc3f396842,0x3f4a4c873f44e3f5
.quad 0x3f4bbbf83f45e403,0x3f5695e53f514d3d,0x3f5703483f514d3d,0x3f61668a3f5c61c7,0x3f6106f23f5b941a,0x3f6aab7b3f660f88,0x3f69b7e43f64aa59,0x3f7254703f6e46be
.quad 0x3f7109083f6c835e,0x3f7853f83f74fa0b,0x3f76ef5b3f731447,0x3f7c9f8a3f7a1e84,0x3f7b61fc3f7853f8,0x3f7f2f9d3f7dabcc,0x3f7e5a383f7c3b28,0x3f7fffb13f7f9c18
.quad 0x3f7fd3973f7ec46d,0x3f7f0e583f7fec43,0x3f7fcbe23f7fec43,0x3f7c5d3a3f7e9bc9,0x3f7e43233f7fb10f,0x3f77f1103f7baccd,0x3f7b3bab3f7e1324,0x3f71d19f3f772417
.quad 0x3f76ba073f7b14be,0x3f6a09a73f710908,0x3f70c5013f76ba07,0x3f60a6cf3f696591,0x3f6965913f710908,0x3f55b9933f604621,0x3f60a6cf3f6a09a7,0x3f4955213f55b993
.quad 0x3f5695e53f61c598,0x3f3b8f3b3f49d112,0x3f4b41fa3f584853,0x3f2c800f3f3ca003,0x3f3ebc1b3f4d9f02,0x3f1c420c3f2e3bde,0x3f3117223f41d870,0x3f0af1b73f1ebc12
.quad 0x0,0x0,0x3db5f8da3dafb680,0x3dc27c393dbc3ac3,0x3e3540983e2f10a2,0x3e419b373e3b6ecf,0x3e870ada3e827dc0,0x3e901c2c3e8b9507
.quad 0x3eb263ef3eac7cd4,0x3ebe1d4a3eb8442a,0x3edc53c13ed53641,0x3eea66813ee363fa,0x3f0242b13efc5d27,0x3f0a48ad3f064b82,0x3f1553b73f10d3cd,0x3f1e1e223f19c200
.quad 0x3f2736563f226799,0x3f3085bb3f2beb4a,0x3f37c6553f32c8c9,0x3f4154e13f3ca003,0x3f46e22a3f41d870,0x3f5064af3f4bbbf8,0x3f546b3b3f4f7a1f,0x3f5d924d3f591e6a
.quad 0x3f6046213f5b941a,0x3f68bf3c3f64aa59,0x3f6a5ad93f660f88,0x3f71d19f3f6e46be,0x3f7294f83f6ed89e,0x3f78b47b3f75dec6,0x3f78e3d63f75dec6,0x3f7d57de3f7b61fc
.quad 0x3f7d3aac3f7b14be,0x3f7fb10f3f7ec46d,0x3f7f90b13f7e70b0,0x3f7fba9e3f7ffec4,0x3f7fe1293f7fec43,0x3f7d74743f7f0e58,0x3f7e2b723f7f84ab,0x3f78e3d63f7bf531
.quad 0x3f7a73023f7d3aac,0x3f7213523f76ba07,0x3f74bf623f791298,0x3f6912ae3f6f6830,0x3f6d1c1d3f731447,0x3f5df6be3f660f88,0x3f6398ac3f6b4b0c,0x3f50d9373f5ac450
.quad 0x3f5848533f61c598,0x3f41d8703f4d9f02,0x3f4b41fa3f5695e5,0x3f3117223f3ebc1b,0x3f3ca0033f49d112,0x3f1ebc123f2e3bde,0x3f2c800f3f3b8f3b,0x3f0af1b73f1c420c
.quad 0x3f1b02c63f2beb4a,0x3eebcbbb3f08f59b,0x3f084b923f1b02c6,0x3ebf926f3ee900b7,0x3ee900b73f08f59b,0x3e919ddd3ebe1d4a,0x3ebf926f3eebcbbb,0x3e44b0b93e919ddd
.quad 0x3f7ec46d3f800000,0x3f74fa0b3f7b14be,0x3f7eb0693f800000,0x3f74484b3f7ac516,0x3f7e9bc93f800000,0x3f73913f3f7a7302,0x3f7e868b3f800000,0x3f72d4eb3f7a1e84
.quad 0x3f7e70b03f800000,0x3f7213523f79c79d,0x3f7e5a383f800000,0x3f714c7a3f796e4e,0x3f7e43233f800000,0x3f7080663f791298,0x3f7e2b723f800000,0x3f6faf1b3f78b47b
.quad 0x3f7e13243f800000,0x3f6ed89e3f7853f8,0x3f7dfa383f800000,0x3f6dfcf23f77f110,0x3f7de0b13f800000,0x3f6d1c1d3f778bc5,0x3f7dc68c3f800000,0x3f6c36243f772417
.quad 0x3f7dabcc3f800000,0x3f6b4b0c3f76ba07,0x3f7d906e3f800000,0x3f6a5ad93f764d97,0x3f7d74743f800000,0x3f6965913f75dec6,0x3f7d57de3f800000,0x3f686b393f756d97
.quad 0x3f7d3aac3f800000,0x3f676bd83f74fa0b,0x3f7d1cdd3f800000,0x3f6667713f748422,0x3f7cfe733f800000,0x3f655e0b3f740bdd,0x3f7cdf6c3f800000,0x3f644fac3f73913f
.quad 0x3f7cbfc93f800000,0x3f633c5a3f731447,0x3f7c9f8a3f800000,0x3f62241a3f7294f8,0x3f7c7eb03f800000,0x3f6106f23f721352,0x3f7c5d3a3f800000,0x3f5fe4e93f718f57
.quad 0x3f7c3b283f800000,0x3f5ebe053f710908,0x3f7c187a3f800000,0x3f5d924d3f708066,0x3f7bf5313f800000,0x3f5c61c73f6ff573,0x3f7bd14d3f800000,0x3f5b2c793f6f6830
.quad 0x3f7baccd3f800000,0x3f59f26a3f6ed89e,0x3f7b87b23f800000,0x3f58b3a13f6e46be,0x3f7b61fc3f800000,0x3f5770263f6db293,0x3f7b3bab3f800000,0x3f5627fe3f6d1c1d
.quad 0x3f61c5983f6c835e,0x3f45e4033f54db31,0x3f5fe4e93f6b4b0c,0x3f425b893f5233c6,0x3f5df6be3f6a09a7,0x3f3ebc1b3f4f7a1f,0x3f5bfb343f68bf3c,0x3f3b06293f4cae79
.quad 0x3f59f26a3f676bd8,0x3f373a233f49d112,0x3f57dc7f3f660f88,0x3f33587a3f46e22a,0x3f55b9933f64aa59,0x3f2f61a53f43e200,0x3f5389c73f633c5a,0x3f2b561b3f40d0da
.quad 0x3f514d3d3f61c598,0x3f2736563f3daef9,0x3f4f04173f604621,0x3f2302d33f3a7ca4,0x3f4cae793f5ebe05,0x3f1ebc123f373a23,0x3f4a4c873f5d2d53,0x3f1a62933f33e7bc
.quad 0x3f47de653f5b941a,0x3f15f6d93f3085bb,0x3f4564393f59f26a,0x3f11796b3f2d1469,0x3f42de293f584853,0x3f0cead03f299415,0x3f404c5c3f5695e5,0x3f084b923f26050a
.quad 0x3f3daef93f54db31,0x3f039c3d3f226799,0x3f3b06293f531849,0x3efdbabb3f1ebc12,0x3f3852163f514d3d,0x3ef41f073f1b02c6,0x3f3592e73f4f7a1f,0x3eea66813f173c07
.quad 0x3f32c8c93f4d9f02,0x3ee0924f3f13682a,0x3f2ff3e63f4bbbf8,0x3ed6a3993f0f8784,0x3f2d14693f49d112,0x3ecc9b8b3f0b9a6b,0x3f2a2a803f47de65,0x3ec27b553f07a136
.quad 0x3f2736563f45e403,0x3eb8442a3f039c3d,0x3f24381a3f43e200,0x3eadf73c3eff17b2,0x3f212ff93f41d870,0x3ea395c53ef6e0cb,0x3f1e1e223f3fc767,0x3e9920fe3eee9479
.quad 0x3f1b02c63f3daef9,0x3e8e9a223ee63375,0x3f17de123f3b8f3b,0x3e8402703eddbe79,0x3f14b0393f396842,0x3e72b6513ed53641,0x3f11796b3f373a23,0x3e5d4b1a3ecc9b8b
.quad 0x3dc8bd3600000000,0x3e94a0313e47c5c2,0x3dcefdb700000000,0x3e9920fe3e4dee60,0x3dd53db900000000,0x3e9d9e783e541501,0x3ddb7d3700000000,0x3ea218873e5a3997
.quad 0x3de1bc2e00000000,0x3ea68f123e605c13,0x3de7fa9a00000000,0x3eab02013e667c66,0x3dee387600000000,0x3eaf713a3e6c9a7f,0x3df475c000000000,0x3eb3dca53e72b651
.quad 0x3dfab27300000000,0x3eb8442a3e78cfcc,0x3e00774500000000,0x3ebca7af3e7ee6e1,0x3e03950200000000,0x3ec1071e3e827dc0,0x3e06b26e00000000,0x3ec5625c3e8586ce
.quad 0x3e09cf8600000000,0x3ec9b9533e888e93,0x3e0cec4a00000000,0x3ece0bea3e8b9507,0x3e1008b700000000,0x3ed25a093e8e9a22,0x3e1324ca00000000,0x3ed6a3993e919ddd
.quad 0x3e16408300000000,0x3edae8803e94a031,0x3e195be000000000,0x3edf28a93e97a117,0x3e1c76de00000000,0x3ee363fa3e9aa086,0x3e1f917b00000000,0x3ee79a5d3e9d9e78
.quad 0x3e22abb600000000,0x3eebcbbb3ea09ae5,0x3e25c58c00000000,0x3eeff7fb3ea395c5,0x3e28defc00000000,0x3ef41f073ea68f12,0x3e2bf80400000000,0x3ef840c83ea986c4
.quad 0x3e2f10a200000000,0x3efc5d273eac7cd4,0x3e3228d400000000,0x3f003a063eaf713a,0x3e35409800000000,0x3f0242b13eb263ef,0x3e3857ec00000000,0x3f0448893eb554ec
.quad 0x3e3b6ecf00000000,0x3f064b823eb8442a,0x3e3e853e00000000,0x3f084b923ebb31a0,0x3e419b3700000000,0x3f0a48ad3ebe1d4a,0x3e44b0b900000000,0x3f0c42c93ec1071e
.quad 0x3ef15aea3ec3ef15,0x3f2267993f0e39da,0x3ef840c83ec9b953,0x3f269de33f121eb0,0x3eff17b23ecf7bca,0x3f2ac0823f15f6d9,0x3f02ef9f3ed53641,0x3f2ecef73f19c200
.quad 0x3f064b823edae880,0x3f32c8c93f1d7fd1,0x3f099f4e3ee0924f,0x3f36ad7f3f212ff9,0x3f0cead03ee63375,0x3f3a7ca43f24d225,0x3f102dd53eebcbbb,0x3f3e35c53f286605
.quad 0x3f13682a3ef15aea,0x3f41d8703f2beb4a,0x3f16999f3ef6e0cb,0x3f4564393f2f61a5,0x3f19c2003efc5d27,0x3f48d8b33f32c8c9,0x3f1ce11f3f00e7e4,0x3f4c35783f36206c
.quad 0x3f1ff6cb3f039c3d,0x3f4f7a1f3f396842,0x3f2302d33f064b82,0x3f52a6493f3ca003,0x3f26050a3f08f59b,0x3f55b9933f3fc767,0x3f28fd413f0b9a6b,0x3f58b3a13f42de29
.quad 0x3f2beb4a3f0e39da,0x3f5b941a3f45e403,0x3f2ecef73f10d3cd,0x3f5e5aa63f48d8b3,0x3f31a81d3f13682a,0x3f6106f23f4bbbf8,0x3f34768f3f15f6d9,0x3f6398ac3f4e8d90
.quad 0x3f373a233f187fc0,0x3f660f883f514d3d,0x3f39f2ac3f1b02c6,0x3f686b393f53fac3,0x3f3ca0033f1d7fd1,0x3f6aab7b3f5695e5,0x3f3f41fc3f1ff6cb,0x3f6cd0073f591e6a
.quad 0x3f41d8703f226799,0x3f6ed89e3f5b941a,0x3f4463373f24d225,0x3f70c5013f5df6be,0x3f46e22a3f273656,0x3f7294f83f604621,0x3f4955213f299415,0x3f74484b3f628210
.quad 0x3f4bbbf83f2beb4a,0x3f75dec63f64aa59,0x3f4e16893f2e3bde,0x3f77583a3f66becc,0x3f5064af3f3085bb,0x3f78b47b3f68bf3c,0x3f52a6493f32c8c9,0x3f79f35e3f6aab7b
.quad 0x3f2267993f3504f3,0x3ef15aea3f0e39da,0x3f1ce11f3f3085bb,0x3ee1fb6a3f07a136,0x3f173c073f2beb4a,0x3ed25a093f00e7e4,0x3f11796b3f273656,0x3ec27b553ef41f07
.quad 0x3f0b9a6b3f226799,0x3eb263ef3ee63375,0x3f05a02c3f1d7fd1,0x3ea218873ed8106b,0x3eff17b23f187fc0,0x3e919ddd3ec9b953,0x3ef2bd433f13682a,0x3e80f8c03ebb31a0
.quad 0x3ee633753f0e39da,0x3e605c133eac7cd4,0x3ed97cb93f08f59b,0x3e3e853e3e9d9e78,0x3ecc9b8b3f039c3d,0x3e1c76de3e8e9a22,0x3ebf926f3efc5d27,0x3df475c03e7ee6e1
.quad 0x3eb263ef3ef15aea,0x3dafb6803e605c13,0x3ea5129f3ee63375,0x3d55880e3e419b37,0x3e97a1173edae880,0x3c96c9b63e22abb6,0x3e8a11f73ecf7bca,0xbc7b514b3e039502
.quad 0x3e78cfcc3ec3ef15,0xbd48fb303dc8bd36,0x3e5d4b1a3eb8442a,0xbda973ba3d8a200a,0x3e419b373eac7cd4,0xbdee38763d16c32c,0x3e25c58c3ea09ae5,0xbe195be03bc90f88
.quad 0x3e09cf863e94a031,0xbe3b6ecfbcc90ab0,0x3ddb7d373e888e93,0xbe5d4b1abd621469,0x3da3308c3e78cfcc,0xbe7ee6e1bdafb680,0x3d55880e3e605c13,0xbe901c2cbdee3876
.quad 0x3cc90ab03e47c5c2,0xbea09ae5be164083,0xbb490fc63e2f10a2,0xbeb0eacbbe354098,0xbcfb49ba3e164083,0xbec1071ebe541501,0xbd6ea0383dfab273,0xbed0eb2abe72b651
.quad 0xbdafb6803dc8bd36,0xbee0924fbe888e93,0xbde7fa9a3d96a905,0xbeeff7fbbe97a117,0xbe1008b73d48fb30,0xbeff17b2bea68f12,0xbe2bf8043cc90ab0,0xbf06f686beb554ec
.quad 0x3e94a0313ec3ef15,0x3dc8bd363e47c5c2,0x3e80f8c03eb263ef,0x3d55880e3e1c76de,0x3e5a39973ea09ae5,0x3bc90f883de1bc2e,0x3e3228d43e8e9a22,0xbd2351cb3d8a200a
.quad 0x3e09cf863e78cfcc,0xbdafb6803cc90ab0,0x3dc27c393e541501,0xbe06b26ebc96c9b6,0x3d6214693e2f10a2,0xbe354098bd7b2b74,0x3c7b514b3e09cf86,0xbe636c83bdd53db9
.quad 0xbcc90ab03dc8bd36,0xbe888e93be164083,0xbd83db0a3d7b2b74,0xbe9f1cdfbe419b37,0xbdd53db93cc90ab0,0xbeb554ecbe6c9a7f,0xbe1324cabc490e90,0xbecb2aaebe8b9507
.quad 0xbe3b6ecfbd48fb30,0xbee0924fbea09ae5,0xbe636c83bdafb680,0xbef58035beb554ec,0xbe8586cebdfab273,0xbf04f484bec9b953,0xbe9920febe22abb6,0xbf0ee0dbbeddbe79
.quad 0xbeac7cd4be47c5c2,0xbf187fc0bef15aea,0xbebf926fbe6c9a7f,0xbf21cbfbbf0242b1,0xbed25a09be888e93,0xbf2ac082bf0b9a6b,0xbee4cbfebe9aa086,0xbf33587abf14b039
.quad 0xbef6e0cbbeac7cd4,0xbf3b8f3bbf1d7fd1,0xbf044889bebe1d4a,0xbf436051bf26050a,0xbf0cead0becf7bca,0xbf4ac77fbf2e3bde,0xbf1553b7bee0924f,0xbf51c0c2bf36206c
.quad 0xbf1d7fd1bef15aea,0xbf584853bf3daef9,0xbf256bcbbf00e7e4,0xbf5e5aa6bf44e3f5,0xbf2d1469bf08f59b,0xbf63f473bf4bbbf8,0xbf34768fbf10d3cd,0xbf6912aebf5233c6
.quad 0xbf3b8f3bbf187fc0,0xbf6db293bf584853,0xbf425b89bf1ff6cb,0xbf71d19fbf5df6be,0xbf48d8b3bf273656,0xbf756d97bf633c5a,0xbf4f0417bf2e3bde,0xbf788486bf6816a8
.quad 0x3f45e4033f3504f3,0x3f61c5983f54db31,0x3f4a4c873f396842,0x3f65b7103f591e6a,0x3f4e8d903f3daef9,0x3f6965913f5d2d53,0x3f52a6493f41d870,0x3f6cd0073f6106f2
.quad 0x3f5695e53f45e403,0x3f6ff5733f64aa59,0x3f5a5ba03f49d112,0x3f72d4eb3f6816a8,0x3f5df6be3f4d9f02,0x3f756d973f6b4b0c,0x3f61668a3f514d3d,0x3f77beb73f6e46be
.quad 0x3f64aa593f54db31,0x3f79c79d3f710908,0x3f67c1873f584853,0x3f7b87b23f73913f,0x3f6aab7b3f5b941a,0x3f7cfe733f75dec6,0x3f6d67a13f5ebe05,0x3f7e2b723f77f110
.quad 0x3f6ff5733f61c598,0x3f7f0e583f79c79d,0x3f7254703f64aa59,0x3f7fa6e33f7b61fc,0x3f7484223f676bd8,0x3f7ff4e63f7cbfc9,0x3f76841b3f6a09a7,0x3f7ff84a3f7de0b1
.quad 0x3f7853f83f6c835e,0x3f7fb10f3f7ec46d,0x3f79f35e3f6ed89e,0x3f7f1f493f7f6ac7,0x3f7b61fc3f710908,0x3f7e43233f7fd397,0x3f7c9f8a3f731447,0x3f7d1cdd3f7ffec4
.quad 0x3f7dabcc3f74fa0b,0x3f7baccd3f7fec43,0x3f7e868b3f76ba07,0x3f79f35e3f7f9c18,0x3f7f2f9d3f7853f8,0x3f77f1103f7f0e58,0x3f7fa6e33f79c79d,0x3f75a67b3f7e4323
.quad 0x3f7fec433f7b14be,0x3f7314473f7d3aac,0x3f7fffb13f7c3b28,0x3f703b373f7bf531,0x3f7fe1293f7d3aac,0x3f6d1c1d3f7a7302,0x3f7f90b13f7e1324,0x3f69b7e43f78b47b
.quad 0x3f7f0e583f7ec46d,0x3f660f883f76ba07,0x3f7e5a383f7f4e6d,0x3f62241a3f748422,0x3f7d74743f7fb10f,0x3f5df6be3f721352,0x3f7c5d3a3f7fec43,0x3f5988ad3f6f6830
.quad 0x3f74fa0b3f6c835e,0x3f7ec46d3f7b14be,0x3f77beb73f6ff573,0x3f7fa6e33f7cfe73,0x3f7a1e843f731447,0x3f7ffec43f7e70b0,0x3f7c187a3f75dec6,0x3f7fcbe23f7f6ac7
.quad 0x3f7dabcc3f7853f8,0x3f7f0e583f7fec43,0x3f7ed7d43f7a7302,0x3f7dc68c3f7ff4e6,0x3f7f9c183f7c3b28,0x3f7bf5313f7f84ab,0x3f7ff84a3f7dabcc,0x3f799b433f7e9bc9
.quad 0x3f7fec433f7ec46d,0x3f76ba073f7d3aac,0x3f7f78083f7f84ab,0x3f73530e3f7b61fc,0x3f7e9bc93f7fec43,0x3f6f68303f791298,0x3f7d57de3f7ffb11,0x3f6afb8c3f764d97
.quad 0x3f7baccd3f7fb10f,0x3f660f883f731447,0x3f799b433f7f0e58,0x3f60a6cf3f6f6830,0x3f7724173f7e1324,0x3f5ac4503f6b4b0c,0x3f74484b3f7cbfc9,0x3f546b3b3f66becc
.quad 0x3f7109083f7b14be,0x3f4d9f023f61c598,0x3f6d67a13f791298,0x3f4663543f5c61c7,0x3f6965913f76ba07,0x3f3ebc1b3f5695e5,0x3f6504793f740bdd,0x3f36ad7f3f5064af
.quad 0x3f6046213f710908,0x3f2e3bde3f49d112,0x3f5b2c793f6db293,0x3f256bcb3f42de29,0x3f55b9933f6a09a7,0x3f1c420c3f3b8f3b,0x3f4fefa83f660f88,0x3f12c39a3f33e7bc
.quad 0x3f49d1123f61c598,0x3f08f59b3f2beb4a,0x3f4360513f5d2d53,0x3efdbabb3f239da9,0x3f3ca0033f584853,0x3ee900b73f1b02c6,0x3f3592e73f531849,0x3ed3c8673f121eb0
.quad 0x3f2e3bde3f4d9f02,0x3ebe1d4a3f08f59b,0x3f269de33f47de65,0x3ea80b1f3eff17b2,0x3f1ebc123f41d870,0x3e919ddd3eebcbbb,0x3f16999f3f3b8f3b,0x3e75c35a3ed8106b
.quad 0xbdc8bd36248d3132,0xbe94a031be47c5c2,0xbe195be0bd48fb30,0xbeb0eacbbe7ee6e1,0xbe4dee60bdc8bd36,0xbecc9b8bbe9aa086,0xbe80f8c0be164083,0xbee79a5dbeb554ec
.quad 0xbe9aa086be47c5c2,0xbf00e7e4becf7bca,0xbeb3dca5be78cfcc,0xbf0d9281bee900b7,0xbecc9b8bbe94a031,0xbf19c200bf00e7e4,0xbee4cbfebeac7cd4,0xbf256bcbbf0cead0
.quad 0xbefc5d27bec3ef15,0xbf3085bbbf187fc0,0xbf099f4ebedae880,0xbf3b0629bf239da9,0xbf14b039bef15aea,0xbf44e3f5bf2e3bde,0xbf1f599fbf039c3d,0xbf4e1689bf385216
.quad 0xbf299415bf0e39da,0xbf5695e5bf41d870,0xbf33587abf187fc0,0xbf5e5aa6bf4ac77f,0xbf3ca003bf226799,0xbf655e0bbf531849,0xbf456439bf2beb4a,0xbf6b99fbbf5ac450
.quad 0xbf4d9f02bf3504f3,0xbf710908bf61c598,0xbf554aa4bf3daef9,0xbf75a67bbf6816a8,0xbf5c61c7bf45e403,0xbf796e4ebf6db293,0xbf62df7bbf4d9f02,0xbf7c5d3abf7294f8
.quad 0xbf68bf3cbf54db31,0xbf7e70b0bf76ba07,0xbf6dfcf2bf5b941a,0xbf7fa6e3bf7a1e84,0xbf7294f8bf61c598,0xbf7ffec4bf7cbfc9,0xbf76841bbf676bd8,0xbf7f7808bf7e9bc9
.quad 0xbf79c79dbf6c835e,0xbf7e1324bf7fb10f,0xbf7c5d3abf710908,0xbf7bd14dbf7ffec4,0xbf7e4323bf74fa0b,0xbf78b47bbf7f84ab,0xbf7f7808bf7853f8,0xbf74bf62bf7e4323
.quad 0xbf7ffb11bf7b14be,0xbf6ff573bf7c3b28,0xbf7fcbe2bf7d3aac,0xbf6a5ad9bf796e4e,0xbf7eea9dbf7ec46d,0xbf63f473bf75dec6,0xbf7d57debf7fb10f,0xbf5cc7d1bf718f57
.quad 0xbef15aeabec3ef15,0xbf226799bf0e39da,0xbf06f686bee0924f,0xbf2ff3e6bf1c420c,0xbf14b039befc5d27,0xbf3ca003bf299415,0xbf21cbfbbf0b9a6b,0xbf485bcabf36206c
.quad 0xbf2e3bdebf187fc0,0xbf531849bf41d870,0xbf39f2acbf24d225,0xbf5cc7d1bf4cae79,0xbf44e3f5bf3085bb,0xbf655e0bbf5695e5,0xbf4f0417bf3b8f3b,0xbf6cd007bf5f8327
.quad 0xbf584853bf45e403,0xbf731447bf676bd8,0xbf60a6cfbf4f7a1f,0xbf7822d1bf6e46be,0xbf6816a8bf584853,0xbf7bf531bf740bdd,0xbf6e8ff8bf604621,0xbf7e868bbf78b47b
.quad 0xbf740bddbf676bd8,0xbf7fd397bf7c3b28,0xbf788486bf6db293,0xbf7fdaafbf7e9bc9,0xbf7bf531bf731447,0xbf7e9bc9bf7fd397,0xbf7e5a38bf778bc5,0xbf7c187abf7fe129
.quad 0xbf7fb10fbf7b14be,0xbf7853f8bf7ec46d,0xbf7ff84abf7dabcc,0xbf73530ebf7c7eb0,0xbf7f2f9dbf7f4e6d,0xbf6d1c1dbf791298,0xbf7d57debf7ffb11,0xbf65b710bf748422
.quad 0xbf7a7302bf7fb10f,0xbf5d2d53bf6ed89e,0xbf76841bbf7e70b0,0xbf5389c7bf6816a8,0xbf718f57bf7c3b28,0xbf48d8b3bf604621,0xbf6b99fbbf791298,0xbf3d27b8bf577026
.quad 0xbf64aa59bf74fa0b,0xbf3085bbbf4d9f02,0xbf5cc7d1bf6ff573,0xbf2302d3bf42de29,0xbf53fac3bf6a09a7,0xbf14b039bf373a23,0xbf4a4c87bf633c5a,0xbf05a02cbf2ac082
.quad 0xbf3fc767bf5b941a,0xbeebcbbbbf1d7fd1,0xbf34768fbf531849,0xbecb2aaebf0f8784,0xbf286605bf49d112,0xbea986c4bf00e7e4,0xbf1ba299bf3fc767,0xbe870adabee363fa
.quad 0x3f7ec46d3f800000,0x3f74fa0b3f7b14be,0x3f7d1cdd3f7fb10f,0x3f703b373f77f110,0x3f7ac5163f7ec46d,0x3f6aab7b3f740bdd,0x3f77beb73f7d3aac,0x3f644fac3f6f6830
.quad 0x3f740bdd3f7b14be,0x3f5d2d533f6a09a7,0x3f6faf1b3f7853f8,0x3f554aa43f63f473,0x3f6aab7b3f74fa0b,0x3f4cae793f5d2d53,0x3f6504793f710908,0x3f4360513f55b993
.quad 0x3f5ebe053f6c835e,0x3f3968423f4d9f02,0x3f57dc7f3f676bd8,0x3f2ecef73f44e3f5,0x3f5064af3f61c598,0x3f239da93f3b8f3b,0x3f485bca3f5b941a,0x3f17de123f31a81d
.quad 0x3f3fc7673f54db31,0x3f0b9a6b3f273656,0x3f36ad7f3f4d9f02,0x3efdbabb3f1c420c,0x3f2d14693f45e403,0x3ee363fa3f10d3cd,0x3f2302d33f3daef9,0x3ec8477c3f04f484
.quad 0x3f187fc03f3504f3,0x3eac7cd43ef15aea,0x3f0d92813f2beb4a,0x3e901c2c3ed8106b,0x3f0242b13f226799,0x3e667c663ebe1d4a,0x3eed30633f187fc0,0x3e2bf8043ea395c5
.quad 0x3ed536413f0e39da,0x3de1bc2e3e888e93,0x3ebca7af3f039c3d,0x3d55880e3e5a3997,0x3ea395c53ef15aea,0xbbc90f883e22abb6,0x3e8a11f73edae880,0xbd83db0a3dd53db9
.quad 0x3e605c133ec3ef15,0xbdfab2733d48fb30,0x3e2bf8043eac7cd4,0xbe3857ecbbc90f88,0x3dee38763e94a031,0xbe72b651bd7b2b74,0x3d83db0a3e78cfcc,0xbe9620d2bdee3876
.quad 0x3c490e903e47c5c2,0xbeb263efbe2f10a2,0xbd2351cb3e164083,0xbece0beabe667c66,0xbdbc3ac33dc8bd36,0xbee900b7be8e9a22,0xbe1324ca3d48fb30,0xbf019573bea986c4
.quad 0x3f61c5983f6c835e,0x3f45e4033f54db31,0x3f5988ad3f660f88,0x3f39f2ac3f4ac77f,0x3f5064af3f5ebe05,0x3f2d14693f3fc767,0x3f4663543f5695e5,0x3f1f599f3f33e7bc
.quad 0x3f3b8f3b3f4d9f02,0x3f10d3cd3f273656,0x3f2ff3e63f43e200,0x3f0195733f19c200,0x3f239da93f396842,0x3ee363fa3f0b9a6b,0x3f16999f3f2e3bde,0x3ec27b553ef9a02d
.quad 0x3f08f59b3f226799,0x3ea09ae53edae880,0x3ef580353f15f6d9,0x3e7bdba43ebb31a0,0x3ed8106b3f08f59b,0x3e3540983e9aa086,0x3eb9bb1e3ef6e0cb,0x3ddb7d373e72b651
.quad 0x3e9aa0863edae880,0x3d16c32c3e2f10a2,0x3e75c35a3ebe1d4a,0xbd0a342f3dd53db9,0x3e3540983ea09ae5,0xbdd53db93d16c32c,0x3de7fa9a3e827dc0,0xbe3228d4bcfb49ba
.quad 0x3d48fb303e47c5c2,0xbe78cfccbdc8bd36,0xbc7b514b3e09cf86,0xbe9f1cdfbe28defc,0xbda3308c3d96a905,0xbec1071ebe6c9a7f,0xbe1324ca3c490e90,0xbee1fb6abe97a117
.quad 0xbe541501bd48fb30,0xbf00e7e4beb8442a,0xbe8a11f7bde1bc2e,0xbf102dd5bed8106b,0xbea986c4be2f10a2,0xbf1ebc12bef6e0cb,0xbec8477cbe6c9a7f,0xbf2c800fbf0a48ad
.quad 0xbee63375be94a031,0xbf396842bf187fc0,0xbf019573beb263ef,0xbf456439bf26050a,0xbf0f8784becf7bca,0xbf5064afbf32c8c9,0xbf1ce11fbeebcbbb,0xbf5a5ba0bf3ebc1b
.quad 0xbf299415bf039c3d,0xbf633c5abf49d112,0xbf3592e7bf10d3cd,0xbf6afb8cbf53fac3,0xbf40d0dabf1d7fd1,0xbf718f57bf5d2d53,0xbf4b41fabf299415,0xbf76ef5bbf655e0b
.quad 0xbf45e403bf3504f3,0xbf61c598bf54db31,0xbf51c0c2bf41d870,0xbf6afb8cbf5f8327,0xbf5c61c7bf4d9f02,0xbf7294f8bf68bf3c,0xbf65b710bf584853,0xbf788486bf708066
.quad 0xbf6db293bf61c598,0xbf7cbfc9bf76ba07,0xbf74484bbf6a09a7,0xbf7f3f54bf7b61fc,0xbf796e4ebf710908,0xbf7ffec4bf7e70b0,0xbf7d1cddbf76ba07,0xbf7efcc9bf7fe129
.quad 0xbf7f4e6dbf7b14be,0xbf7c3b28bf7fb10f,0xbf7fffb1bf7e1324,0xbf77beb7bf7de0b1,0xbf7f2f9dbf7fb10f,0xbf718f57bf7a7302,0xbf7cdf6cbf7fec43,0xbf69b7e4bf756d97
.quad 0xbf791298bf7ec46d,0xbf604621bf6ed89e,0xbf73ced9bf7c3b28,0xbf554aa4bf66becc,0xbf6d1c1dbf7853f8,0xbf48d8b3bf5d2d53,0xbf650479bf731447,0xbf3b0629bf5233c6
.quad 0xbf5b941abf6c835e,0xbf2beb4abf45e403,0xbf50d937bf64aa59,0xbf1ba299bf385216,0xbf44e3f5bf5b941a,0xbf0a48adbf299415,0xbf37c655bf514d3d,0xbeeff7fbbf19c200
.quad 0xbf299415bf45e403,0xbec9b953bf08f59b,0xbf1a6293bf396842,0xbea21887beee9479,0xbf0a48adbf2beb4a,0xbe72b651bec9b953,0xbef2bd43bf1d7fd1,0xbe1f917bbea395c5
.quad 0xbecf7bcabf0e39da,0xbd96a905be78cfcc,0xbeab0201befc5d27,0x3c16cb58be28defc,0xbe8586cebedae880,0x3dbc3ac3bdafb680,0xbe3e853ebeb8442a,0x3e3228d4bbc90f88
.quad 0xbde1bc2ebe94a031,0x3e827dc03d96a905,0xbd0a342fbe605c13,0x3eab02013e1c76de,0x3d2fe007be164083,0x3ed25a093e6c9a7f,0x3df475c0bd96a905,0x3ef840c83e9d9e78
.quad 0xbf74fa0bbf6c835e,0xbf7ec46dbf7b14be,0xbf7a9c59bf740bdd,0xbf7fffb1bf7e9bc9,0xbf7e4323bf79c79d,0xbf7eea9dbf7ffb11,0xbf7fe705bf7dabcc,0xbf7b87b2bf7f2f9d
.quad 0xbf7f84abbf7fb10f,0xbf75dec6bf7c3b28,0xbf7d1cddbf7fd397,0xbf6dfcf2bf772417,0xbf78b47bbf7e1324,0xbf63f473bf6ff573,0xbf725470bf7a7302,0xbf57dc7fbf66becc
.quad 0xbf6a09a7bf74fa0b,0xbf49d112bf5b941a,0xbf5fe4e9bf6db293,0xbf39f2acbf4e8d90,0xbf53fac3bf64aa59,0xbf286605bf3fc767,0xbf466354bf59f26a,0xbf1553b7bf2f61a5
.quad 0xbf373a23bf4d9f02,0xbf00e7e4bf1d7fd1,0xbf269de3bf3fc767,0xbed6a399bf0a48ad,0xbf14b039bf3085bb,0xbea986c4beebcbbb,0xbf019573bf1ff6cb,0xbe75c35abec1071e
.quad 0xbedae880bf0e39da,0xbe164083be94a031,0xbeb0eacbbef6e0cb,0xbd55880ebe4dee60,0xbe8586cebecf7bca,0x3d2fe007bde1bc2e,0xbe3228d4bea68f12,0x3e0cec4abc96c9b6
.quad 0xbdafb680be78cfcc,0x3e6c9a7f3d96a905,0x3b490fc6be22abb6,0x3ea5129f3e28defc,0x3dbc3ac3bd96a905,0x3ed25a093e827dc0,0x3e3857ec3c490e90,0x3efdbabb3eaf713a
.quad 0x3e888e933dc8bd36,0x3f13682a3edae880,0x3eb3dca53e3b6ecf,0x3f269de33f0242b1,0x3eddbe793e888e93,0x3f3852163f15f6d9,0x3f02ef9f3eb263ef,0x3f485bca3f286605
.quad 0x3f15f6d93edae880,0x3f5695e53f396842,0x3f27ce613f00e7e4,0x3f62df7b3f48d8b3,0x3f3852163f13682a,0x3f6d1c1d3f5695e5,0x3f4760853f24d225,0x3f75341d3f628210
.quad 0x3f2267993f3504f3,0x3ef15aea3f0e39da,0x3f12c39a3f273656,0x3ecb2aae3ef9a02d,0x3f0242b13f187fc0,0x3ea395c53ed53641,0x3ee1fb6a3f08f59b,0x3e75c35a3eaf713a
.quad 0x3ebe1d4a3ef15aea,0x3e22abb63e888e93,0x3e9920fe3ecf7bca,0x3d9cecf93e419b37,0x3e667c663eac7cd4,0xbbc90f883de1bc2e,0x3e195be03e888e93,0xbdb5f8da3cfb49ba
.quad 0x3d96a9053e47c5c2,0xbe2f10a2bd48fb30,0xbb490fc63dfab273,0xbe80f8c0be039502,0xbda3308c3d48fb30,0xbea986c4be541501,0xbe1f917bbcc90ab0,0xbed0eb2abe919ddd
.quad 0xbe6c9a7fbdc8bd36,0xbef6e0cbbeb8442a,0xbe9c1fafbe2f10a2,0xbf0d9281beddbe79,0xbec1071ebe78cfcc,0xbf1ebc12bf00e7e4,0xbee4cbfebea09ae5,0xbf2ecef7bf121eb0
.quad 0xbf039c3dbec3ef15,0xbf3daef9bf226799,0xbf140c5fbee63375,0xbf4b41fabf31a81d,0xbf239da9bf039c3d,0xbf577026bf3fc767,0xbf3238aabf13682a,0xbf62241abf4cae79
.quad 0xbf3fc767bf226799,0xbf6b4b0cbf584853,0xbf4c3578bf3085bb,0xbf72d4ebbf628210,0xbf577026bf3daef9,0xbf78b47bbf6b4b0c,0xbf61668abf49d112,0xbf7cdf6cbf7294f8
.quad 0xbf6a09a7bf54db31,0xbf7f4e6dbf7853f8,0xbf714c7abf5ebe05,0xbf7ffd39bf7c7eb0,0xbf772417bf676bd8,0xbf7eea9dbf7f0e58,0xbf7b87b2bf6ed89e,0xbf7c187abf7ffec4
.quad 0xbf7e70b0bf74fa0b,0xbf778bc5bf7f4e6d,0xbf7fdaafbf79c79d,0xbf714c7abf7cfe73,0xbf7fc38fbf7d3aac,0xbf696591bf791298,0xbf7e2b72bf7f4e6d,0xbf5fe4e9bf73913f
.quad 0x3e94a0313ec3ef15,0x3dc8bd363e47c5c2,0x3e5101f13e9aa086,0x3b490fc63dd53db9,0x3dee38763e605c13,0xbdbc3ac33c490e90,0x3ce22a7a3e09cf86,0xbe3e853ebda3308c
.quad 0xbd7b2b743d48fb30,0xbe8e9a22be2f10a2,0xbe195be0bd16c32c,0xbebca7afbe8586ce,0xbe72b651bdfab273,0xbee900b7beb263ef,0xbea5129fbe541501,0xbf099f4ebeddbe79
.quad 0xbecf7bcabe94a031,0xbf1d7fd1bf039c3d,0xbef840c8bebe1d4a,0xbf2ff3e6bf173c07,0xbf0f8784bee63375,0xbf40d0dabf299415,0xbf21cbfbbf064b82,0xbf4fefa8bf3a7ca4
.quad 0xbf32c8c9bf187fc0,0xbf5d2d53bf49d112,0xbf425b89bf299415,0xbf686b39bf577026,0xbf5064afbf396842,0xbf718f57bf633c5a,0xbf5cc7d1bf47de65,0xbf788486bf6d1c1d
.quad 0xbf676bd8bf54db31,0xbf7d3aacbf74fa0b,0xbf703b37bf604621,0xbf7fa6e3bf7ac516,0xbf772417bf6a09a7,0xbf7fc38fbf7e70b0,0xbf7c187abf721352,0xbf7d906ebf7ff4e6
.quad 0xbf7f0e58bf7853f8,0xbf791298bf7f4e6d,0xbf7fffb1bf7cbfc9,0xbf725470bf7c7eb0,0xbf7eea9dbf7f4e6d,0xbf696591bf778bc5,0xbf7bd14dbf7ffb11,0xbf5e5aa6bf708066
.quad 0xbf76ba07bf7ec46d,0xbf514d3dbf676bd8,0xbf6faf1bbf7baccd,0xbf425b89bf5c61c7,0xbf66beccbf76ba07,0xbf31a81dbf4f7a1f,0xbf5bfb34bf6ff573,0xbf1f599fbf40d0da
.quad 0xbf4f7a1fbf676bd8,0xbf0b9a6bbf3085bb,0xbf4154e1bf5d2d53,0xbeed3063bf1ebc12,0xbf31a81dbf514d3d,0xbec1071ebf0b9a6b,0xbf209393bf43e200,0xbe931f35beee9479
.quad 0x3400340034003400,0x3400340034003400,0x32a7336433d93400,0xb072ae1faa3e0000,0x2e1f31a833643400,0xae1fb1a8b364b400,0xaa3e2e1f32a73400,0x33d9336430728000
.quad 0xb1a8000031a83400,0xb1a8000031a83400,0xb3d9ae1f30723400,0xaa3eb364b2a70000,0xb364b1a82e1f3400,0x336431a8ae1fb400,0xb072b3642a3e3400,0xb2a72e1f33d98000
.quad 0x8000b40000003400,0x8000b40000003400,0x3072b364aa3e3400,0x32a72e1fb3d90000,0x3364b1a8ae1f3400,0xb36431a82e1fb400,0x33d9ae1fb0723400,0x2a3eb36432a78000
.quad 0x31a88000b1a83400,0x31a88000b1a83400,0x2a3e2e1fb2a73400,0xb3d93364b0720000,0xae1f31a8b3643400,0x2e1fb1a83364b400,0xb2a73364b3d93400,0x3072ae1f2a3e8000
.quad 0xb4003400b4003400,0xb4003400b4003400,0xb2a73364b3d93400,0x3072ae1f2a3e0000,0xae1f31a8b3643400,0x2e1fb1a83364b400,0x2a3e2e1fb2a73400,0xb3d93364b0728000
.quad 0x31a80000b1a83400,0x31a80000b1a83400,0x33d9ae1fb0723400,0x2a3eb36432a70000,0x3364b1a8ae1f3400,0xb36431a82e1fb400,0x3072b364aa3e3400,0x32a72e1fb3d98000
.quad 0xb40080003400,0xb40080003400,0xb072b3642a3e3400,0xb2a72e1f33d90000,0xb364b1a82e1f3400,0x336431a8ae1fb400,0xb3d9ae1f30723400,0xaa3eb364b2a78000
.quad 0xb1a8800031a83400,0xb1a8800031a83400,0xaa3e2e1f32a73400,0x33d9336430720000,0x2e1f31a833643400,0xae1fb1a8b364b400,0x32a7336433d93400,0xb072ae1faa3e8000
.quad 0x3400340034003400,0x3400340034003400,0x2a3e2e1f307231a8,0xb3d9b364b2a7b1a8,0xb364b1a8ae1f0000,0x336431a82e1f8000,0xb072b364b3d9b1a8,0xb2a7ae1f2a3e31a8
.quad 0x31a88000b1a8b400,0x31a88000b1a8b400,0x32a733642a3eb1a8,0xb0722e1f33d931a8,0xae1f31a833648000,0x2e1fb1a8b3640000,0xb3d9ae1f32a731a8,0xaa3e33643072b1a8
.quad 0x8000b40000003400,0x8000b40000003400,0x33d9ae1fb2a731a8,0x2a3e3364b072b1a8,0x2e1f31a8b3640000,0xae1fb1a833648000,0xb2a73364aa3eb1a8,0x30722e1fb3d931a8
.quad 0xb1a8000031a8b400,0xb1a8000031a8b400,0x3072b36433d9b1a8,0x32a7ae1faa3e31a8,0x3364b1a82e1f8000,0xb36431a8ae1f0000,0xaa3e2e1fb07231a8,0x33d9b36432a7b1a8
.quad 0xb4003400b4003400,0xb4003400b4003400,0xaa3e2e1fb07231a8,0x33d9b36432a7b1a8,0x3364b1a82e1f0000,0xb36431a8ae1f8000,0x3072b36433d9b1a8,0x32a7ae1faa3e31a8
.quad 0xb1a8800031a8b400,0xb1a8800031a8b400,0xb2a73364aa3eb1a8,0x30722e1fb3d931a8,0x2e1f31a8b3648000,0xae1fb1a833640000,0x33d9ae1fb2a731a8,0x2a3e3364b072b1a8
.quad 0xb40080003400,0xb40080003400,0xb3d9ae1f32a731a8,0xaa3e33643072b1a8,0xae1f31a833640000,0x2e1fb1a8b3648000,0x32a733642a3eb1a8,0xb0722e1f33d931a8
.quad 0x31a80000b1a8b400,0x31a80000b1a8b400,0xb072b364b3d9b1a8,0xb2a7ae1f2a3e31a8,0xb364b1a8ae1f8000,0x336431a82e1f0000,0x2a3e2e1f307231a8,0xb3d9b364b2a7b1a8
.quad 0x3400340034003400,0x3400340034003400,0xb2a7b364b3d9b400,0x30722e1f2a3e8000,0x2e1f31a833643400,0xae1fb1a8b364b400,0x2a3eae1fb2a7b400,0xb3d9b364b0720000
.quad 0xb1a8000031a83400,0xb1a8000031a83400,0x33d92e1fb072b400,0x2a3e336432a78000,0xb364b1a82e1f3400,0x336431a8ae1fb400,0x30723364aa3eb400,0x32a7ae1fb3d90000
.quad 0x8000b40000003400,0x8000b40000003400,0xb07233642a3eb400,0xb2a7ae1f33d98000,0x3364b1a8ae1f3400,0xb36431a82e1fb400,0xb3d92e1f3072b400,0xaa3e3364b2a70000
.quad 0x31a88000b1a83400,0x31a88000b1a83400,0xaa3eae1f32a7b400,0x33d9b36430728000,0xae1f31a8b3643400,0x2e1fb1a83364b400,0x32a7b36433d9b400,0xb0722e1faa3e0000
.quad 0xb4003400b4003400,0xb4003400b4003400,0x32a7b36433d9b400,0xb0722e1faa3e8000,0xae1f31a8b3643400,0x2e1fb1a83364b400,0xaa3eae1f32a7b400,0x33d9b36430720000
.quad 0x31a80000b1a83400,0x31a80000b1a83400,0xb3d92e1f3072b400,0xaa3e3364b2a78000,0x3364b1a8ae1f3400,0xb36431a82e1fb400,0xb07233642a3eb400,0xb2a7ae1f33d90000
.quad 0xb40080003400,0xb40080003400,0x30723364aa3eb400,0x32a7ae1fb3d98000,0xb364b1a82e1f3400,0x336431a8ae1fb400,0x33d92e1fb072b400,0x2a3e336432a70000
.quad 0xb1a8800031a83400,0xb1a8800031a83400,0x2a3eae1fb2a7b400,0xb3d9b364b0728000,0x2e1f31a833643400,0xae1fb1a8b364b400,0xb2a7b364b3d9b400,0x30722e1f2a3e0000
.quad 0x3400340034003400,0x3400340034003400,0xaa3eae1fb072b1a8,0x33d9336432a731a8,0xb364b1a8ae1f0000,0x336431a82e1f8000,0x3072336433d931a8,0x32a72e1faa3eb1a8
.quad 0x31a88000b1a8b400,0x31a88000b1a8b400,0xb2a7b364aa3e31a8,0x3072ae1fb3d9b1a8,0xae1f31a833648000,0x2e1fb1a8b3640000,0x33d92e1fb2a7b1a8,0x2a3eb364b07231a8
.quad 0x8000b40000003400,0x8000b40000003400,0xb3d92e1f32a7b1a8,0xaa3eb364307231a8,0x2e1f31a8b3640000,0xae1fb1a833648000,0x32a7b3642a3e31a8,0xb072ae1f33d9b1a8
.quad 0xb1a8000031a8b400,0xb1a8000031a8b400,0xb0723364b3d931a8,0xb2a72e1f2a3eb1a8,0x3364b1a82e1f8000,0xb36431a8ae1f0000,0x2a3eae1f3072b1a8,0xb3d93364b2a731a8
.quad 0xb4003400b4003400,0xb4003400b4003400,0x2a3eae1f3072b1a8,0xb3d93364b2a731a8,0x3364b1a82e1f0000,0xb36431a8ae1f8000,0xb0723364b3d931a8,0xb2a72e1f2a3eb1a8
.quad 0xb1a8800031a8b400,0xb1a8800031a8b400,0x32a7b3642a3e31a8,0xb072ae1f33d9b1a8,0x2e1f31a8b3648000,0xae1fb1a833640000,0xb3d92e1f32a7b1a8,0xaa3eb364307231a8
.quad 0xb40080003400,0xb40080003400,0x33d92e1fb2a7b1a8,0x2a3eb364b07231a8,0xae1f31a833640000,0x2e1fb1a8b3648000,0xb2a7b364aa3e31a8,0x3072ae1fb3d9b1a8
.quad 0x31a80000b1a8b400,0x31a80000b1a8b400,0x3072336433d931a8,0x32a72e1faa3eb1a8,0xb364b1a8ae1f8000,0x336431a82e1f0000,0xaa3eae1fb072b1a8,0x33d9336432a731a8
.quad 0x8000800080008000,0x8000800080008000,0xb072ae1faa3e8000,0xb2a7b364b3d9b400,0xb364b1a8ae1f8000,0x336431a82e1f8000,0xb3d9b364b0728000,0xaa3e2e1f32a73400
.quad 0xb1a8b400b1a88000,0xb1a8b400b1a88000,0xaa3eb364b2a78000,0x33d92e1fb072b400,0x2e1fb1a8b3648000,0xae1f31a833648000,0x32a7ae1fb3d98000,0xb072b3642a3e3400
.quad 0x34008000b4008000,0x34008000b4008000,0x32a72e1fb3d98000,0xb07233642a3eb400,0x2e1f31a8b3648000,0xae1fb1a833648000,0xaa3e3364b2a78000,0x33d9ae1fb0723400
.quad 0xb1a83400b1a88000,0xb1a83400b1a88000,0xb3d93364b0728000,0xaa3eae1f32a7b400,0xb36431a8ae1f8000,0x3364b1a82e1f8000,0xb0722e1faa3e8000,0xb2a73364b3d93400
.quad 0x8000800080008000,0x8000800080008000,0x3072ae1f2a3e8000,0x32a7b36433d9b400,0x3364b1a82e1f8000,0xb36431a8ae1f8000,0x33d9b36430728000,0x2a3e2e1fb2a73400
.quad 0x31a8b40031a88000,0x31a8b40031a88000,0x2a3eb36432a78000,0xb3d92e1f3072b400,0xae1fb1a833648000,0x2e1f31a8b3648000,0xb2a7ae1f33d98000,0x3072b364aa3e3400
.quad 0xb400800034008000,0xb400800034008000,0xb2a72e1f33d98000,0x30723364aa3eb400,0xae1f31a833648000,0x2e1fb1a8b3648000,0x2a3e336432a78000,0xb3d9ae1f30723400
.quad 0x31a8340031a88000,0x31a8340031a88000,0x33d9336430728000,0x2a3eae1fb2a7b400,0x336431a82e1f8000,0xb364b1a8ae1f8000,0x30722e1f2a3e8000,0x32a7336433d93400
.quad 0x8000800080008000,0x8000800080008000,0xb3d9b364b2a7b1a8,0xaa3eae1fb072b1a8,0xae1fb1a8b364b400,0x2e1f31a833643400,0x32a72e1faa3eb1a8,0xb072b364b3d9b1a8
.quad 0x31a8340031a88000,0x31a8340031a88000,0xb0722e1f33d931a8,0xb2a7b364aa3e31a8,0xb364b1a82e1f3400,0x336431a8ae1fb400,0x2a3eb364b07231a8,0xb3d9ae1f32a731a8
.quad 0x34008000b4008000,0x34008000b4008000,0x2a3e3364b072b1a8,0xb3d92e1f32a7b1a8,0xb36431a82e1fb400,0x3364b1a8ae1f3400,0xb072ae1f33d9b1a8,0xb2a73364aa3eb1a8
.quad 0x31a8b40031a88000,0x31a8b40031a88000,0x32a7ae1faa3e31a8,0xb0723364b3d931a8,0xae1f31a8b3643400,0x2e1fb1a83364b400,0xb3d93364b2a731a8,0xaa3e2e1fb07231a8
.quad 0x8000800080008000,0x8000800080008000,0x33d9b36432a7b1a8,0x2a3eae1f3072b1a8,0x2e1fb1a83364b400,0xae1f31a8b3643400,0xb2a72e1f2a3eb1a8,0x3072b36433d9b1a8
.quad 0xb1a83400b1a88000,0xb1a83400b1a88000,0x30722e1fb3d931a8,0x32a7b3642a3e31a8,0x3364b1a8ae1f3400,0xb36431a82e1fb400,0xaa3eb364307231a8,0x33d9ae1fb2a731a8
.quad 0xb400800034008000,0xb400800034008000,0xaa3e33643072b1a8,0x33d92e1fb2a7b1a8,0x336431a8ae1fb400,0xb364b1a82e1f3400,0x3072ae1fb3d9b1a8,0x32a733642a3eb1a8
.quad 0xb1a8b400b1a88000,0xb1a8b400b1a88000,0xb2a7ae1f2a3e31a8,0x3072336433d931a8,0x2e1f31a833643400,0xae1fb1a8b364b400,0x33d9336432a731a8,0x2a3e2e1f307231a8
.quad 0x8000800080008000,0x8000800080008000,0x30722e1f2a3e8000,0x32a7336433d93400,0xb364b1a8ae1f8000,0x336431a82e1f8000,0x33d9336430728000,0x2a3eae1fb2a7b400
.quad 0xb1a8b400b1a88000,0xb1a8b400b1a88000,0x2a3e336432a78000,0xb3d9ae1f30723400,0x2e1fb1a8b3648000,0xae1f31a833648000,0xb2a72e1f33d98000,0x30723364aa3eb400
.quad 0x34008000b4008000,0x34008000b4008000,0xb2a7ae1f33d98000,0x3072b364aa3e3400,0x2e1f31a8b3648000,0xae1fb1a833648000,0x2a3eb36432a78000,0xb3d92e1f3072b400
.quad 0xb1a83400b1a88000,0xb1a83400b1a88000,0x33d9b36430728000,0x2a3e2e1fb2a73400,0xb36431a8ae1f8000,0x3364b1a82e1f8000,0x3072ae1f2a3e8000,0x32a7b36433d9b400
.quad 0x8000800080008000,0x8000800080008000,0xb0722e1faa3e8000,0xb2a73364b3d93400,0x3364b1a82e1f8000,0xb36431a8ae1f8000,0xb3d93364b0728000,0xaa3eae1f32a7b400
.quad 0x31a8b40031a88000,0x31a8b40031a88000,0xaa3e3364b2a78000,0x33d9ae1fb0723400,0xae1fb1a833648000,0x2e1f31a8b3648000,0x32a72e1fb3d98000,0xb07233642a3eb400
.quad 0xb400800034008000,0xb400800034008000,0x32a7ae1fb3d98000,0xb072b3642a3e3400,0xae1f31a833648000,0x2e1fb1a8b3648000,0xaa3eb364b2a78000,0x33d92e1fb072b400
.quad 0x31a8340031a88000,0x31a8340031a88000,0xb3d9b364b0728000,0xaa3e2e1f32a73400,0x336431a82e1f8000,0xb364b1a8ae1f8000,0xb072ae1faa3e8000,0xb2a7b364b3d9b400
.quad 0x8000800080008000,0x8000800080008000,0x33d9336432a731a8,0x2a3e2e1f307231a8,0xae1fb1a8b364b400,0x2e1f31a833643400,0xb2a7ae1f2a3e31a8,0x3072336433d931a8
.quad 0x31a8340031a88000,0x31a8340031a88000,0x3072ae1fb3d9b1a8,0x32a733642a3eb1a8,0xb364b1a82e1f3400,0x336431a8ae1fb400,0xaa3e33643072b1a8,0x33d92e1fb2a7b1a8
.quad 0x34008000b4008000,0x34008000b4008000,0xaa3eb364307231a8,0x33d9ae1fb2a731a8,0xb36431a82e1fb400,0x3364b1a8ae1f3400,0x30722e1fb3d931a8,0x32a7b3642a3e31a8
.quad 0x31a8b40031a88000,0x31a8b40031a88000,0xb2a72e1f2a3eb1a8,0x3072b36433d9b1a8,0xae1f31a8b3643400,0x2e1fb1a83364b400,0x33d9b36432a7b1a8,0x2a3eae1f3072b1a8
.quad 0x8000800080008000,0x8000800080008000,0xb3d93364b2a731a8,0xaa3e2e1fb07231a8,0x2e1fb1a83364b400,0xae1f31a8b3643400,0x32a7ae1faa3e31a8,0xb0723364b3d931a8
.quad 0xb1a83400b1a88000,0xb1a83400b1a88000,0xb072ae1f33d9b1a8,0xb2a73364aa3eb1a8,0x3364b1a8ae1f3400,0xb36431a82e1fb400,0x2a3e3364b072b1a8,0xb3d92e1f32a7b1a8
.quad 0xb400800034008000,0xb400800034008000,0x2a3eb364b07231a8,0xb3d9ae1f32a731a8,0x336431a8ae1fb400,0xb364b1a82e1f3400,0xb0722e1f33d931a8,0xb2a7b364aa3e31a8
.quad 0xb1a8b400b1a88000,0xb1a8b400b1a88000,0x32a72e1faa3eb1a8,0xb072b364b3d9b1a8,0x2e1f31a833643400,0xae1fb1a8b364b400,0xb3d9b364b2a7b1a8,0xaa3eae1fb072b1a8
.quad 0x0,0x0,0x30722e1f2a3e0000,0x32a7336433d93400,0x336431a82e1f0000,0xb364b1a8ae1f0000,0x33d9336430720000,0x2a3eae1fb2a7b400
.quad 0x31a8340031a80000,0x31a8340031a80000,0x2a3e336432a70000,0xb3d9ae1f30723400,0xae1f31a833640000,0x2e1fb1a8b3640000,0xb2a72e1f33d90000,0x30723364aa3eb400
.quad 0xb400000034000000,0xb400000034000000,0xb2a7ae1f33d90000,0x3072b364aa3e3400,0xae1fb1a833640000,0x2e1f31a8b3640000,0x2a3eb36432a70000,0xb3d92e1f3072b400
.quad 0x31a8b40031a80000,0x31a8b40031a80000,0x33d9b36430720000,0x2a3e2e1fb2a73400,0x3364b1a82e1f0000,0xb36431a8ae1f0000,0x3072ae1f2a3e0000,0x32a7b36433d9b400
.quad 0x0,0x0,0xb0722e1faa3e0000,0xb2a73364b3d93400,0xb36431a8ae1f0000,0x3364b1a82e1f0000,0xb3d93364b0720000,0xaa3eae1f32a7b400
.quad 0xb1a83400b1a80000,0xb1a83400b1a80000,0xaa3e3364b2a70000,0x33d9ae1fb0723400,0x2e1f31a8b3640000,0xae1fb1a833640000,0x32a72e1fb3d90000,0xb07233642a3eb400
.quad 0x34000000b4000000,0x34000000b4000000,0x32a7ae1fb3d90000,0xb072b3642a3e3400,0x2e1fb1a8b3640000,0xae1f31a833640000,0xaa3eb364b2a70000,0x33d92e1fb072b400
.quad 0xb1a8b400b1a80000,0xb1a8b400b1a80000,0xb3d9b364b0720000,0xaa3e2e1f32a73400,0xb364b1a8ae1f0000,0x336431a82e1f0000,0xb072ae1faa3e0000,0xb2a7b364b3d9b400
.quad 0x0,0x0,0x33d9336432a731a8,0x2a3e2e1f307231a8,0x2e1f31a833643400,0xae1fb1a8b364b400,0xb2a7ae1f2a3e31a8,0x3072336433d931a8
.quad 0xb1a8b400b1a80000,0xb1a8b400b1a80000,0x3072ae1fb3d9b1a8,0x32a733642a3eb1a8,0x336431a8ae1fb400,0xb364b1a82e1f3400,0xaa3e33643072b1a8,0x33d92e1fb2a7b1a8
.quad 0xb400000034000000,0xb400000034000000,0xaa3eb364307231a8,0x33d9ae1fb2a731a8,0x3364b1a8ae1f3400,0xb36431a82e1fb400,0x30722e1fb3d931a8,0x32a7b3642a3e31a8
.quad 0xb1a83400b1a80000,0xb1a83400b1a80000,0xb2a72e1f2a3eb1a8,0x3072b36433d9b1a8,0x2e1fb1a83364b400,0xae1f31a8b3643400,0x33d9b36432a7b1a8,0x2a3eae1f3072b1a8
.quad 0x0,0x0,0xb3d93364b2a731a8,0xaa3e2e1fb07231a8,0xae1f31a8b3643400,0x2e1fb1a83364b400,0x32a7ae1faa3e31a8,0xb0723364b3d931a8
.quad 0x31a8b40031a80000,0x31a8b40031a80000,0xb072ae1f33d9b1a8,0xb2a73364aa3eb1a8,0xb36431a82e1fb400,0x3364b1a8ae1f3400,0x2a3e3364b072b1a8,0xb3d92e1f32a7b1a8
.quad 0x34000000b4000000,0x34000000b4000000,0x2a3eb364b07231a8,0xb3d9ae1f32a731a8,0xb364b1a82e1f3400,0x336431a8ae1fb400,0xb0722e1f33d931a8,0xb2a7b364aa3e31a8
.quad 0x31a8340031a80000,0x31a8340031a80000,0x32a72e1faa3eb1a8,0xb072b364b3d9b1a8,0xae1fb1a8b364b400,0x2e1f31a833643400,0xb3d9b364b2a7b1a8,0xaa3eae1fb072b1a8
.quad 0x0,0x0,0xb072ae1faa3e0000,0xb2a7b364b3d9b400,0x336431a82e1f0000,0xb364b1a8ae1f0000,0xb3d9b364b0720000,0xaa3e2e1f32a73400
.quad 0x31a8340031a80000,0x31a8340031a80000,0xaa3eb364b2a70000,0x33d92e1fb072b400,0xae1f31a833640000,0x2e1fb1a8b3640000,0x32a7ae1fb3d90000,0xb072b3642a3e3400
.quad 0xb400000034000000,0xb400000034000000,0x32a72e1fb3d90000,0xb07233642a3eb400,0xae1fb1a833640000,0x2e1f31a8b3640000,0xaa3e3364b2a70000,0x33d9ae1fb0723400
.quad 0x31a8b40031a80000,0x31a8b40031a80000,0xb3d93364b0720000,0xaa3eae1f32a7b400,0x3364b1a82e1f0000,0xb36431a8ae1f0000,0xb0722e1faa3e0000,0xb2a73364b3d93400
.quad 0x0,0x0,0x3072ae1f2a3e0000,0x32a7b36433d9b400,0xb36431a8ae1f0000,0x3364b1a82e1f0000,0x33d9b36430720000,0x2a3e2e1fb2a73400
.quad 0xb1a83400b1a80000,0xb1a83400b1a80000,0x2a3eb36432a70000,0xb3d92e1f3072b400,0x2e1f31a8b3640000,0xae1fb1a833640000,0xb2a7ae1f33d90000,0x3072b364aa3e3400
.quad 0x34000000b4000000,0x34000000b4000000,0xb2a72e1f33d90000,0x30723364aa3eb400,0x2e1fb1a8b3640000,0xae1f31a833640000,0x2a3e336432a70000,0xb3d9ae1f30723400
.quad 0xb1a8b400b1a80000,0xb1a8b400b1a80000,0x33d9336430720000,0x2a3eae1fb2a7b400,0xb364b1a8ae1f0000,0x336431a82e1f0000,0x30722e1f2a3e0000,0x32a7336433d93400
.quad 0x0,0x0,0xb3d9b364b2a7b1a8,0xaa3eae1fb072b1a8,0x2e1f31a833643400,0xae1fb1a8b364b400,0x32a72e1faa3eb1a8,0xb072b364b3d9b1a8
.quad 0xb1a8b400b1a80000,0xb1a8b400b1a80000,0xb0722e1f33d931a8,0xb2a7b364aa3e31a8,0x336431a8ae1fb400,0xb364b1a82e1f3400,0x2a3eb364b07231a8,0xb3d9ae1f32a731a8
.quad 0xb400000034000000,0xb400000034000000,0x2a3e3364b072b1a8,0xb3d92e1f32a7b1a8,0x3364b1a8ae1f3400,0xb36431a82e1fb400,0xb072ae1f33d9b1a8,0xb2a73364aa3eb1a8
.quad 0xb1a83400b1a80000,0xb1a83400b1a80000,0x32a7ae1faa3e31a8,0xb0723364b3d931a8,0x2e1fb1a83364b400,0xae1f31a8b3643400,0xb3d93364b2a731a8,0xaa3e2e1fb07231a8
.quad 0x0,0x0,0x33d9b36432a7b1a8,0x2a3eae1f3072b1a8,0xae1f31a8b3643400,0x2e1fb1a83364b400,0xb2a72e1f2a3eb1a8,0x3072b36433d9b1a8
.quad 0x31a8b40031a80000,0x31a8b40031a80000,0x30722e1fb3d931a8,0x32a7b3642a3e31a8,0xb36431a82e1fb400,0x3364b1a8ae1f3400,0xaa3eb364307231a8,0x33d9ae1fb2a731a8
.quad 0x34000000b4000000,0x34000000b4000000,0xaa3e33643072b1a8,0x33d92e1fb2a7b1a8,0xb364b1a82e1f3400,0x336431a8ae1fb400,0x3072ae1fb3d9b1a8,0x32a733642a3eb1a8
.quad 0x31a8340031a80000,0x31a8340031a80000,0xb2a7ae1f2a3e31a8,0x3072336433d931a8,0xae1fb1a8b364b400,0x2e1f31a833643400,0x33d9336432a731a8,0x2a3e2e1f307231a8
.quad 0x0,0x0,0x0,0x0,0x0,0x0,0x0,0x0
.quad 0x0,0x0,0x0,0x0,0x0,0x0,0x0,0x0
.quad 0x0,0x0,0x0,0x0,0x0,0x0,0x0,0x0
.quad 0x0,0x0,0x0,0x0,0x0,0x0,0x0,0x0
.quad 0x0,0x0,0x0,0x0,0x0,0x0,0x0,0x0
.quad 0x0,0x0,0x0,0x0,0x0,0x0,0x0,0x0
.quad 0x0,0x0,0x0,0x0,0x0,0x0,0x0,0x0
.quad 0x0,0x0,0x0,0x0,0x0,0x0,0x0,0x0
.quad 0x0,0x0,0x0,0x0,0x0,0x0,0x0,0x0
.quad 0x0,0x0,0x0,0x0,0x0,0x0,0x0,0x0
.quad 0x0,0x0,0x0,0x0,0x0,0x0,0x0,0x0
.quad 0x0,0x0,0x0,0x0,0x0,0x0,0x0,0x0
.quad 0x0,0x0,0x0,0x0,0x0,0x0,0x0,0x0
.quad 0x0,0x0,0x0,0x0,0x0,0x0,0x0,0x0
.quad 0x0,0x0,0x0,0x0,0x0,0x0,0x0,0x0
.quad 0x0,0x0,0x0,0x0,0x0,0x0,0x0,0x0
.quad 0x0,0x0,0x0,0x0,0x0,0x0,0x0,0x0
.quad 0x0,0x0,0x0,0x0,0x0,0x0,0x0,0x0
.quad 0x0,0x0,0x0,0x0,0x0,0x0,0x0,0x0
.quad 0x0,0x0,0x0,0x0,0x0,0x0,0x0,0x0
.quad 0x0,0x0,0x0,0x0,0x0,0x0,0x0,0x0
.quad 0x0,0x0,0x0,0x0,0x0,0x0,0x0,0x0
.quad 0x0,0x0,0x0,0x0,0x0,0x0,0x0,0x0
.quad 0x0,0x0,0x0,0x0,0x0,0x0,0x0,0x0
.quad 0x0,0x0,0x0,0x0,0x0,0x0,0x0,0x0
.quad 0x0,0x0,0x0,0x0,0x0,0x0,0x0,0x0
.quad 0x0,0x0,0x0,0x0,0x0,0x0,0x0,0x0
.quad 0x0,0x0,0x0,0x0,0x0,0x0,0x0,0x0
.quad 0x0,0x0,0x0,0x0,0x0,0x0,0x0,0x0
.quad 0x0,0x0,0x0,0x0,0x0,0x0,0x0,0x0
.quad 0x0,0x0,0x0,0x0,0x0,0x0,0x0,0x0
.quad 0x0,0x0,0x0,0x0,0x0,0x0,0x0,0x0
.section .rodata,"a"
.set TH0,15360
.set TH1,15360
.set TH2,15359
.set TH3,15358
.set TH4,15357
.set TH5,15355
.set TH6,15353
.set TH7,15350
.set TH8,15347
.set TH9,15344
.set TH10,15340
.set TH11,15336
.set TH12,15331
.set TH13,15326
.set TH14,15321
.set TH15,15315
.set TH16,15309
.set TH17,15302
.set TH18,15295
.set TH19,15288
.set TH20,15280
.set TH21,15272
.set TH22,15263
.set TH23,15254
.set TH24,15245
.set TH25,15235
.set TH26,15225
.set TH27,15215
.set TH28,15204
.set TH29,15193
.set TH30,15181
.set TH31,15169
.set TH32,15157
.set TH33,15145
.set TH34,15132
.set TH35,15118
.set TH36,15104
.set TH37,15090
.set TH38,15076
.set TH39,15061
.set TH40,15046
.set TH41,15031
.set TH42,15015
.set TH43,14999
.set TH44,14982
.set TH45,14965
.set TH46,14948
.set TH47,14931
.set TH48,14913
.set TH49,14895
.set TH50,14877
.set TH51,14858
.set TH52,14839
.set TH53,14820
.set TH54,14800
.set TH55,14780
.set TH56,14760
.set TH57,14740
.set TH58,14719
.set TH59,14698
.set TH60,14677
.set TH61,14655
.set TH62,14633
.set TH63,14611
.set TH64,14589
.set TH65,14566
.set TH66,14543
.set TH67,14520
.set TH68,14497
.set TH69,14474
.set TH70,14450
.set TH71,14426
.set TH72,14402
.set TH73,14377
.set TH74,14353
.set TH75,14319
.set TH76,14269
.set TH77,14219
.set TH78,14168
.set TH79,14117
.set TH80,14065
.set TH81,14013
.set TH82,13961
.set TH83,13908
.set TH84,13855
.set TH85,13802
.set TH86,13749
.set TH87,13695
.set TH88,13641
.set TH89,13586
.set TH90,13532
.set TH91,13477
.set TH92,13422
.set TH93,13367
.set TH94,13310
.set TH95,13199
.set TH96,13087
.set TH97,12975
.set TH98,12862
.set TH99,12749
.set TH100,12636
.set TH101,12523
.set TH102,12409
.set TH103,12295
.set TH104,12074
.set TH105,11846
.set TH106,11617
.set TH107,11388
.set TH108,11053
.set TH109,10594
.set TH110,10030
.set TH111,9006
.set TH112,0
.set TH113,41774
.set TH114,42798
.set TH115,43362
.set TH116,43821
.set TH117,44156
.set TH118,44385
.set TH119,44614
.set TH120,44842
.set TH121,45063
.set TH122,45177
.set TH123,45291
.set TH124,45404
.set TH125,45517
.set TH126,45630
.set TH127,45743
.set TH128,45855
.set TH129,45967
.set TH130,46078
.set TH131,46135
.set TH132,46190
.set TH133,46245
.set TH134,46300
.set TH135,46354
.set TH136,46409
.set TH137,46463
.set TH138,46517
.set TH139,46570
.set TH140,46623
.set TH141,46676
.set TH142,46729
.set TH143,46781
.set TH144,46833
.set TH145,46885
.set TH146,46936
.set TH147,46987
.set TH148,47037
.set TH149,47087
.set TH150,47121
.set TH151,47145
.set TH152,47170
.set TH153,47194
.set TH154,47218
.set TH155,47242
.set TH156,47265
.set TH157,47288
.set TH158,47311
.set TH159,47334
.set TH160,47357
.set TH161,47379
.set TH162,47401
.set TH163,47423
.set TH164,47445
.set TH165,47466
.set TH166,47487
.set TH167,47508
.set TH168,47528
.set TH169,47548
.set TH170,47568
.set TH171,47588
.set TH172,47607
.set TH173,47626
.set TH174,47645
.set TH175,47663
.set TH176,47681
.set TH177,47699
.set TH178,47716
.set TH179,47733
.set TH180,47750
.set TH181,47767
.set TH182,47783
.set TH183,47799
.set TH184,47814
.set TH185,47829
.set TH186,47844
.set TH187,47858
.set TH188,47872
.set TH189,47886
.set TH190,47900
.set TH191,47913
.set TH192,47925
.set TH193,47937
.set TH194,47949
.set TH195,47961
.set TH196,47972
.set TH197,47983
.set TH198,47993
.set TH199,48003
.set TH200,48013
.set TH201,48022
.set TH202,48031
.set TH203,48040
.set TH204,48048
.set TH205,48056
.set TH206,48063
.set TH207,48070
.set TH208,48077
.set TH209,48083
.set TH210,48089
.set TH211,48094
.set TH212,48099
.set TH213,48104
.set TH214,48108
.set TH215,48112
.set TH216,48115
.set TH217,48118
.set TH218,48121
.set TH219,48123
.set TH220,48125
.set TH221,48126
.set TH222,48127
.set TH223,48128
.set TH224,48128
.set TH225,48128
.set TH226,48127
.set TH227,48126
.set TH228,48125
.set TH229,48123
.set TH230,48121
.set TH231,48118
.set TH232,48115
.set TH233,48112
.set TH234,48108
.set TH235,48104
.set TH236,48099
.set TH237,48094
.set TH238,48089
.set TH239,48083
.set TH240,48077
.set TH241,48070
.set TH242,48063
.set TH243,48056
.set TH244,48048
.set TH245,48040
.set TH246,48031
.set TH247,48022
.set TH248,48013
.set TH249,48003
.set TH250,47993
.set TH251,47983
.set TH252,47972
.set TH253,47961
.set TH254,47949
.set TH255,47937
.set TH256,47925
.set TH257,47913
.set TH258,47900
.set TH259,47886
.set TH260,47872
.set TH261,47858
.set TH262,47844
.set TH263,47829
.set TH264,47814
.set TH265,47799
.set TH266,47783
.set TH267,47767
.set TH268,47750
.set TH269,47733
.set TH270,47716
.set TH271,47699
.set TH272,47681
.set TH273,47663
.set TH274,47645
.set TH275,47626
.set TH276,47607
.set TH277,47588
.set TH278,47568
.set TH279,47548
.set TH280,47528
.set TH281,47508
.set TH282,47487
.set TH283,47466
.set TH284,47445
.set TH285,47423
.set TH286,47401
.set TH287,47379
.set TH288,47357
.set TH289,47334
.set TH290,47311
.set TH291,47288
.set TH292,47265
.set TH293,47242
.set TH294,47218
.set TH295,47194
.set TH296,47170
.set TH297,47145
.set TH298,47121
.set TH299,47087
.set TH300,47037
.set TH301,46987
.set TH302,46936
.set TH303,46885
.set TH304,46833
.set TH305,46781
.set TH306,46729
.set TH307,46676
.set TH308,46623
.set TH309,46570
.set TH310,46517
.set TH311,46463
.set TH312,46409
.set TH313,46354
.set TH314,46300
.set TH315,46245
.set TH316,46190
.set TH317,46135
.set TH318,46078
.set TH319,45967
.set TH320,45855
.set TH321,45743
.set TH322,45630
.set TH323,45517
.set TH324,45404
.set TH325,45291
.set TH326,45177
.set TH327,45063
.set TH328,44842
.set TH329,44614
.set TH330,44385
.set TH331,44156
.set TH332,43821
.set TH333,43362
.set TH334,42798
.set TH335,41774
.set TH336,0
.set TH337,9006
.set TH338,10030
.set TH339,10594
.set TH340,11053
.set TH341,11388
.set TH342,11617
.set TH343,11846
.set TH344,12074
.set TH345,12295
.set TH346,12409
.set TH347,12523
.set TH348,12636
.set TH349,12749
.set TH350,12862
.set TH351,12975
.set TH352,13087
.set TH353,13199
.set TH354,13310
.set TH355,13367
.set TH356,13422
.set TH357,13477
.set TH358,13532
.set TH359,13586
.set TH360,13641
.set TH361,13695
.set TH362,13749
.set TH363,13802
.set TH364,13855
.set TH365,13908
.set TH366,13961
.set TH367,14013
.set TH368,14065
.set TH369,14117
.set TH370,14168
.set TH371,14219
.set TH372,14269
.set TH373,14319
.set TH374,14353
.set TH375,14377
.set TH376,14402
.set TH377,14426
.set TH378,14450
.set TH379,14474
.set TH380,14497
.set TH381,14520
.set TH382,14543
.set TH383,14566
.set TH384,14589
.set TH385,14611
.set TH386,14633
.set TH387,14655
.set TH388,14677
.set TH389,14698
.set TH390,14719
.set TH391,14740
.set TH392,14760
.set TH393,14780
.set TH394,14800
.set TH395,14820
.set TH396,14839
.set TH397,14858
.set TH398,14877
.set TH399,14895
.set TH400,14913
.set TH401,14931
.set TH402,14948
.set TH403,14965
.set TH404,14982
.set TH405,14999
.set TH406,15015
.set TH407,15031
.set TH408,15046
.set TH409,15061
.set TH410,15076
.set TH411,15090
.set TH412,15104
.set TH413,15118
.set TH414,15132
.set TH415,15145
.set TH416,15157
.set TH417,15169
.set TH418,15181
.set TH419,15193
.set TH420,15204
.set TH421,15215
.set TH422,15225
.set TH423,15235
.set TH424,15245
.set TH425,15254
.set TH426,15263
.set TH427,15272
.set TH428,15280
.set TH429,15288
.set TH430,15295
.set TH431,15302
.set TH432,15309
.set TH433,15315
.set TH434,15321
.set TH435,15326
.set TH436,15331
.set TH437,15336
.set TH438,15340
.set TH439,15344
.set TH440,15347
.set TH441,15350
.set TH442,15353
.set TH443,15355
.set TH444,15357
.set TH445,15358
.set TH446,15359
.set TH447,15360
.altmacro
.macro EMT q0_,q1_,q2_,q3_,q4_,q5_,q6_,q7_
.long TH\q0_|(TH\q1_<<16),TH\q2_|(TH\q3_<<16),TH\q4_|(TH\q5_<<16),TH\q6_|(TH\q7_<<16)
.endm
.p2align 8
TAB_TT:
.set ff, 0
.rept 392
.set ll, 0
.rept 64
.set dd, (ff/56)*64+(ff&1)*32+(ll&31)
.set k0, (((ff%56)>>1)*16+(ll>>5)*8)>>1
.set bb, dd*k0
.set b1, bb+112
.if k0==0
.set b1, dd*224
.endif
EMT %(bb%448),%(b1%448),%((bb+dd)%448),%((bb+dd+112)%448),%((bb+2*dd)%448),%((bb+2*dd+112)%448),%((bb+3*dd)%448),%((bb+3*dd+112)%448)
.set ll, ll+1
.endr
.set ff, ff+1
.endr
.noaltmacro
```
